```python
import torch

def _softmax(x, axis=-1):
    return torch.softmax(x, dim=axis)
def _gelu(x):
    return torch.nn.functional.gelu(x, approximate="tanh")
def _silu(x):
    return torch.nn.functional.silu(x)
def _sigmoid(x):
    return torch.sigmoid(x)
def _layernorm(x, axis=-1, eps=1e-5):
    m = x.mean(dim=axis, keepdim=True)
    v = x.var(dim=axis, keepdim=True, unbiased=False)
    return (x - m) / torch.sqrt(v + eps)
def _scatter_add(tgt, idx, src, axis=0):
    return tgt.clone().index_add_(axis, idx, src)
def _segment_sum(src, seg, n):
    out = torch.zeros((n,) + src.shape[1:], dtype=src.dtype)
    return out.index_add_(0, seg, src)
def _pad(x, pw):
    flat = tuple(v for pair in reversed(pw) for v in pair)
    return torch.nn.functional.pad(x, flat)

kernel_name = 'interleave_layers__ssm_conv_h3__glu_gated_geglu__prompt'

def setup_inputs():

    _w = (lambda a: (lambda t: t.to(torch.bfloat16) if t.is_floating_point() else t)(torch.as_tensor(a)))
    def _A_setup():
        B, S, D = 1, 2048, 1024
        ks = 4
        return {
            "q": _w((lambda *s: torch.randn(*s, dtype=torch.bfloat16) * 0.05)(B, S, D)),
            "k": _w((lambda *s: torch.randn(*s, dtype=torch.bfloat16) * 0.2)(B, S, D)),
            "v": _w((lambda *s: torch.randn(*s, dtype=torch.bfloat16) * 0.2)(B, S, D)),
            "shift_k": _w((lambda *s: torch.randn(*s, dtype=torch.bfloat16) * 0.2)(D, ks) * 0.5),
            "ssm_k": _w((lambda *s: torch.randn(*s, dtype=torch.bfloat16) * 0.4)(D, S) * (1.0 / S ** 0.5)),
            "ssm_D": _w((lambda *s: torch.randn(*s, dtype=torch.bfloat16) * 0.2)(D)),
        }
    _A_in = _A_setup()

    def _B_setup():
        B, S, Dm, Df = 1, 2048, 1024, 3584
        return {
            "x": _w((lambda *s: torch.randn(*s, dtype=torch.bfloat16) * 0.05)(B, S, Dm)),
            "w_gate": _w((lambda *s: torch.randn(*s, dtype=torch.bfloat16) * 0.4)(Dm, Df) * (Dm ** -0.5)),
            "w_up": _w((lambda *s: torch.randn(*s, dtype=torch.bfloat16) * 0.4)(Dm, Df) * (Dm ** -0.5)),
            "w_down": _w((lambda *s: torch.randn(*s, dtype=torch.bfloat16) * 0.4)(Df, Dm) * (Df ** -0.5)),
        }
    _B_in = _B_setup()

    return {
        "A_q": _A_in["q"],
        "A_k": _A_in["k"],
        "A_v": _A_in["v"],
        "A_shift_k": _A_in["shift_k"],
        "A_ssm_k": _A_in["ssm_k"],
        "A_ssm_D": _A_in["ssm_D"],
        "B_x": _B_in["x"],
        "B_w_gate": _B_in["w_gate"],
        "B_w_up": _B_in["w_up"],
        "B_w_down": _B_in["w_down"],
    }

def reference(A_q, A_k, A_v, A_shift_k, A_ssm_k, A_ssm_D, B_x, B_w_gate, B_w_up, B_w_down):
    def _A_ref(q, k, v, shift_k, ssm_k, ssm_D):
        B, S, D = q.shape
        ks = shift_k.shape[-1]
        k_pad = _pad(k, ((0, 0), (ks - 1, 0), (0, 0)))
        k_shift = torch.zeros_like(k)
        for t in range(ks):
            k_shift = k_shift + k_pad[:, t:t + S, :] * shift_k[:, ks - 1 - t][None, None, :]
        kv = k_shift * v
        L = 2 * S
        kv_pad = _pad(kv, ((0, 0), (0, S), (0, 0)))
        kf_pad = _pad(ssm_k, ((0, 0), (0, S)))
        kv_f = (lambda x, axes=(-2,-1): torch.fft.rfft2(x.float(), dim=axes))(kv_pad[:, None, :, :], axes=(1, 2))
        kf_f = (lambda x, axes=(-2,-1): torch.fft.rfft2(x.float(), dim=axes))(kf_pad[:, None, :], axes=(1, 2))
        kf_f = (lambda x, *d: x.permute(*d))(kf_f, 1, 2, 0)
        y_f = kv_f * kf_f[None, :, :, :]
        y = (lambda x, s, axes=(-2,-1): torch.fft.irfft2(x, s=s, dim=axes).to(torch.bfloat16))(y_f, (1, L), axes=(1, 2))[:, 0, :S, :]
        y = y + kv * ssm_D[None, None, :]
        return q * y

    def _B_ref(x, w_gate, w_up, w_down):
        g = torch.einsum("bsd,df->bsf", x, w_gate)
        u = torch.einsum("bsd,df->bsf", x, w_up)
        h = _gelu(g) * u
        return torch.einsum("bsf,fd->bsd", h, w_down)

    x = A_q
    x = x + _A_ref(_layernorm(x, axis=-1), A_k, A_v, A_shift_k, A_ssm_k, A_ssm_D)
    x = x + _B_ref(_layernorm(x, axis=-1), B_w_gate, B_w_up, B_w_down)
    x = x + _A_ref(_layernorm(x, axis=-1), A_k, A_v, A_shift_k, A_ssm_k, A_ssm_D)
    x = x + _B_ref(_layernorm(x, axis=-1), B_w_gate, B_w_up, B_w_down)
    return x
```

```asm
; @launch grid=(256,1,1) block=(256,1,1) lds=154624
.amdgcn_target "amdgcn-amd-amdhsa--gfx950"
.text
.globl interleave_layers__ssm_conv_h3__glu_gated_geglu__prompt_kernel
.p2align 8
.type interleave_layers__ssm_conv_h3__glu_gated_geglu__prompt_kernel,@function
interleave_layers__ssm_conv_h3__glu_gated_geglu__prompt_kernel:
    s_cmp_ge_u32 s2, 256
    s_cbranch_scc1 Lend
    s_load_dwordx4 s[60:63], s[0:1], 8
    s_load_dwordx4 s[64:67], s[0:1], 24
    s_load_dwordx4 s[76:79], s[0:1], 88
    s_memrealtime s[100:101]
    s_bfe_u32 s18, s2, 0x30003
    s_and_b32 s19, s2, 7
    s_lshl_b32 s19, s19, 2
    s_lshr_b32 s28, s2, 6
    s_add_u32 s19, s19, s28
    v_and_b32 v1, 31, v0
    v_lshrrev_b32 v2, 5, v0
    s_lshl_b32 s28, s19, 17
    s_lshl_b32 s29, s18, 8
    s_add_u32 s28, s28, s29
    v_lshlrev_b32 v3, 14, v2
    v_lshl_add_u32 v3, v1, 3, v3
    v_add_u32 v3, s28, v3
    v_subrev_u32 v4, 6144, v3
    v_subrev_u32 v5, 2048, v3
    v_lshlrev_b32 v6, 5, v1
    v_lshrrev_b32 v11, 6, v0
    v_and_b32 v12, 63, v0
    v_readfirstlane_b32 s3, v11
    s_lshl_b32 s29, s18, 10
    s_movk_i32 s24, 4096
    s_movk_i32 s25, 8192
    s_movk_i32 s26, 12288
    s_mov_b32 s27, 0xffff0000
    s_waitcnt lgkmcnt(0)
    s_mov_b32 s4, s60
    s_mov_b32 s5, s61
    s_mov_b32 s6, 4194304
    s_mov_b32 s7, 0x20000
    s_mov_b32 s36, s64
    s_mov_b32 s37, s65
    s_mov_b32 s38, 8192
    s_mov_b32 s39, 0x20000
    buffer_load_dwordx4 v[56:59], v6, s[36:39], s29 offen
    buffer_load_dwordx4 v[60:63], v6, s[36:39], s29 offen offset:16
    buffer_load_dwordx2 v[16:17], v4, s[4:7], 0 offen nt
    buffer_load_dwordx2 v[18:19], v4, s[4:7], 0 offen offset:2048 nt
    buffer_load_dwordx2 v[20:21], v5, s[4:7], 0 offen nt
    buffer_load_dwordx2 v[22:23], v3, s[4:7], 0 offen offset:0 nt
    buffer_load_dwordx2 v[24:25], v3, s[4:7], 0 offen offset:2048 nt
    buffer_load_dwordx2 v[26:27], v3, s[4:7], s24 offen offset:0 nt
    buffer_load_dwordx2 v[28:29], v3, s[4:7], s24 offen offset:2048 nt
    buffer_load_dwordx2 v[30:31], v3, s[4:7], s25 offen offset:0 nt
    buffer_load_dwordx2 v[32:33], v3, s[4:7], s25 offen offset:2048 nt
    buffer_load_dwordx2 v[34:35], v3, s[4:7], s26 offen offset:0 nt
    buffer_load_dwordx2 v[36:37], v3, s[4:7], s26 offen offset:2048 nt
    s_mov_b32 s8, s62
    s_mov_b32 s9, s63
    s_mov_b32 s10, 4194304
    s_mov_b32 s11, 0x20000
    buffer_load_dwordx2 v[40:41], v3, s[8:11], 0 offen offset:0 nt
    buffer_load_dwordx2 v[42:43], v3, s[8:11], 0 offen offset:2048 nt
    buffer_load_dwordx2 v[44:45], v3, s[8:11], s24 offen offset:0 nt
    buffer_load_dwordx2 v[46:47], v3, s[8:11], s24 offen offset:2048 nt
    buffer_load_dwordx2 v[48:49], v3, s[8:11], s25 offen offset:0 nt
    buffer_load_dwordx2 v[50:51], v3, s[8:11], s25 offen offset:2048 nt
    buffer_load_dwordx2 v[52:53], v3, s[8:11], s26 offen offset:0 nt
    buffer_load_dwordx2 v[54:55], v3, s[8:11], s26 offen offset:2048 nt
    s_mov_b32 s16, s78
    s_mov_b32 s17, s79
    s_add_u32 s20, s16, 54525952
    s_addc_u32 s21, s17, 0
    s_mov_b32 s22, 4325376
    s_mov_b32 s23, 0x20000
    v_sub_u32 v7, 7, v2
    v_and_b32 v9, 7, v1
    v_xor_b32 v7, v7, v9
    v_lshlrev_b32 v7, 4, v7
    v_lshl_add_u32 v7, v1, 9, v7
    v_add_u32 v7, 137728, v7
    v_lshlrev_b32 v189, 4, v0
    v_add_u32 v8, 137728, v189
    v_lshrrev_b32 v9, 3, v0
    s_movk_i32 s30, 4224
    v_mul_u32_u24 v9, s30, v9
    v_and_b32 v10, 7, v0
    v_xor_b32 v10, v10, v2
    v_lshl_add_u32 v9, v10, 4, v9
    s_mul_i32 s30, s18, 540672
    s_lshl_b32 s31, s19, 7
    s_sub_u32 s31, 3968, s31
    s_add_u32 s30, s30, s31
    s_add_u32 s31, s30, 135168
    s_add_u32 s32, s30, 270336
    s_add_u32 s33, s30, 405504
    s_or_b32 s34, s100, 1
    s_or_b32 s35, s101, 0x80000000
    v_mov_b32 v14, s34
    v_mov_b32 v15, s35
    v_mov_b32 v188, 0
    s_cmp_eq_u32 s2, 0
    s_cselect_b32 s78, 8, 0
    s_mov_b32 s79, 0x20000
    s_getpc_b64 s[68:69]
Lpf1:
    s_add_u32 s68, s68, (Lconv-Lpf1)&0xffffffff
    s_addc_u32 s69, s69, ((Lconv-Lpf1)>>32)&0xffffffff
    s_lshr_b32 s70, s2, 3
    s_lshl_b32 s70, s70, 2
    s_add_u32 s70, s70, s3
    s_lshl_b32 s70, s70, 10
    v_lshrrev_b32 v11, 3, v12
    v_lshl_add_u32 v11, v11, 7, s70
    v_min_u32 v11, Lend-Lconv-4, v11
    v_add_co_u32 v10, vcc, s68, v11
    v_mov_b32 v11, s69
    s_nop 0
    v_addc_co_u32 v11, vcc, 0, v11, vcc
    s_lshl_b32 s34, s2, 14
    s_add_u32 s72, s66, s34
    s_addc_u32 s73, s67, 0
    s_mov_b32 s74, 16384
    s_mov_b32 s75, 0x20000
    v_lshlrev_b32 v13, 6, v0
    buffer_store_dwordx2 v[14:15], v189, s[76:79], 0 offen sc1
    s_mov_b32 s78, 8
    s_lshl_b32 s34, s19, 3
    s_add_u32 s34, s34, s18
    s_lshl_b32 s34, s34, 7
    s_add_u32 s34, s34, 28639232
    s_add_u32 s80, s16, s34
    s_addc_u32 s81, s17, 0
    s_mov_b32 s82, 8
    s_mov_b32 s83, 0x20000
    v_lshlrev_b32 v191, 2, v0
    s_waitcnt vmcnt(20)
    v_lshlrev_b32 v64, 16, v56
    v_lshlrev_b32 v65, 16, v58
    v_and_b32 v66, s27, v56
    v_and_b32 v67, s27, v58
    v_lshlrev_b32 v68, 16, v57
    v_lshlrev_b32 v69, 16, v59
    v_and_b32 v70, s27, v57
    v_and_b32 v71, s27, v59
    v_lshlrev_b32 v72, 16, v60
    v_lshlrev_b32 v73, 16, v62
    v_and_b32 v74, s27, v60
    v_and_b32 v75, s27, v62
    v_lshlrev_b32 v76, 16, v61
    v_lshlrev_b32 v77, 16, v63
    v_and_b32 v78, s27, v61
    v_and_b32 v79, s27, v63
    s_waitcnt vmcnt(19)
    v_lshlrev_b32 v80, 16, v16
    v_and_b32 v81, s27, v16
    v_lshlrev_b32 v82, 16, v17
    v_and_b32 v83, s27, v17
    v_pk_mul_f32 v[124:125], v[80:81], v[70:71]
    v_pk_mul_f32 v[126:127], v[82:83], v[78:79]
    s_waitcnt vmcnt(18)
    v_lshlrev_b32 v84, 16, v18
    v_and_b32 v85, s27, v18
    v_lshlrev_b32 v86, 16, v19
    v_and_b32 v87, s27, v19
    v_pk_fma_f32 v[124:125], v[84:85], v[68:69], v[124:125]
    v_pk_fma_f32 v[126:127], v[86:87], v[76:77], v[126:127]
    v_pk_mul_f32 v[128:129], v[84:85], v[70:71]
    v_pk_mul_f32 v[130:131], v[86:87], v[78:79]
    buffer_store_dword v188, v191, s[80:83], 0 offen sc1
    s_waitcnt vmcnt(18)
    v_lshlrev_b32 v88, 16, v20
    v_and_b32 v89, s27, v20
    v_lshlrev_b32 v90, 16, v21
    v_and_b32 v91, s27, v21
    v_pk_fma_f32 v[124:125], v[88:89], v[66:67], v[124:125]
    v_pk_fma_f32 v[126:127], v[90:91], v[74:75], v[126:127]
    v_pk_fma_f32 v[128:129], v[88:89], v[68:69], v[128:129]
    v_pk_fma_f32 v[130:131], v[90:91], v[76:77], v[130:131]
    v_pk_mul_f32 v[132:133], v[88:89], v[70:71]
    v_pk_mul_f32 v[134:135], v[90:91], v[78:79]
    s_waitcnt vmcnt(17)
    v_lshlrev_b32 v92, 16, v22
    v_and_b32 v93, s27, v22
    v_lshlrev_b32 v94, 16, v23
    v_and_b32 v95, s27, v23
    v_pk_fma_f32 v[124:125], v[92:93], v[64:65], v[124:125]
    v_pk_fma_f32 v[126:127], v[94:95], v[72:73], v[126:127]
    v_pk_fma_f32 v[128:129], v[92:93], v[66:67], v[128:129]
    v_pk_fma_f32 v[130:131], v[94:95], v[74:75], v[130:131]
    v_pk_fma_f32 v[132:133], v[92:93], v[68:69], v[132:133]
    v_pk_fma_f32 v[134:135], v[94:95], v[76:77], v[134:135]
    v_pk_mul_f32 v[136:137], v[92:93], v[70:71]
    v_pk_mul_f32 v[138:139], v[94:95], v[78:79]
    buffer_load_dword v190, v188, s[20:23], s30 offen sc1
    s_waitcnt vmcnt(17)
    v_lshlrev_b32 v96, 16, v24
    v_and_b32 v97, s27, v24
    v_lshlrev_b32 v98, 16, v25
    v_and_b32 v99, s27, v25
    v_pk_fma_f32 v[128:129], v[96:97], v[64:65], v[128:129]
    v_pk_fma_f32 v[130:131], v[98:99], v[72:73], v[130:131]
    v_pk_fma_f32 v[132:133], v[96:97], v[66:67], v[132:133]
    v_pk_fma_f32 v[134:135], v[98:99], v[74:75], v[134:135]
    v_pk_fma_f32 v[136:137], v[96:97], v[68:69], v[136:137]
    v_pk_fma_f32 v[138:139], v[98:99], v[76:77], v[138:139]
    v_pk_mul_f32 v[140:141], v[96:97], v[70:71]
    v_pk_mul_f32 v[142:143], v[98:99], v[78:79]
    s_waitcnt vmcnt(16)
    v_lshlrev_b32 v100, 16, v26
    v_and_b32 v101, s27, v26
    v_lshlrev_b32 v102, 16, v27
    v_and_b32 v103, s27, v27
    v_pk_fma_f32 v[132:133], v[100:101], v[64:65], v[132:133]
    v_pk_fma_f32 v[134:135], v[102:103], v[72:73], v[134:135]
    v_pk_fma_f32 v[136:137], v[100:101], v[66:67], v[136:137]
    v_pk_fma_f32 v[138:139], v[102:103], v[74:75], v[138:139]
    v_pk_fma_f32 v[140:141], v[100:101], v[68:69], v[140:141]
    v_pk_fma_f32 v[142:143], v[102:103], v[76:77], v[142:143]
    v_pk_mul_f32 v[144:145], v[100:101], v[70:71]
    v_pk_mul_f32 v[146:147], v[102:103], v[78:79]
    global_load_dword v11, v[10:11], off
    s_waitcnt vmcnt(16)
    v_lshlrev_b32 v104, 16, v28
    v_and_b32 v105, s27, v28
    v_lshlrev_b32 v106, 16, v29
    v_and_b32 v107, s27, v29
    v_pk_fma_f32 v[136:137], v[104:105], v[64:65], v[136:137]
    v_pk_fma_f32 v[138:139], v[106:107], v[72:73], v[138:139]
    v_pk_fma_f32 v[140:141], v[104:105], v[66:67], v[140:141]
    v_pk_fma_f32 v[142:143], v[106:107], v[74:75], v[142:143]
    v_pk_fma_f32 v[144:145], v[104:105], v[68:69], v[144:145]
    v_pk_fma_f32 v[146:147], v[106:107], v[76:77], v[146:147]
    v_pk_mul_f32 v[148:149], v[104:105], v[70:71]
    v_pk_mul_f32 v[150:151], v[106:107], v[78:79]
    s_waitcnt vmcnt(15)
    v_lshlrev_b32 v108, 16, v30
    v_and_b32 v109, s27, v30
    v_lshlrev_b32 v110, 16, v31
    v_and_b32 v111, s27, v31
    v_pk_fma_f32 v[140:141], v[108:109], v[64:65], v[140:141]
    v_pk_fma_f32 v[142:143], v[110:111], v[72:73], v[142:143]
    v_pk_fma_f32 v[144:145], v[108:109], v[66:67], v[144:145]
    v_pk_fma_f32 v[146:147], v[110:111], v[74:75], v[146:147]
    v_pk_fma_f32 v[148:149], v[108:109], v[68:69], v[148:149]
    v_pk_fma_f32 v[150:151], v[110:111], v[76:77], v[150:151]
    v_pk_mul_f32 v[152:153], v[108:109], v[70:71]
    v_pk_mul_f32 v[154:155], v[110:111], v[78:79]
    buffer_load_dword v13, v13, s[72:75], 0 offen
    s_waitcnt vmcnt(15)
    v_lshlrev_b32 v112, 16, v32
    v_and_b32 v113, s27, v32
    v_lshlrev_b32 v114, 16, v33
    v_and_b32 v115, s27, v33
    v_pk_fma_f32 v[144:145], v[112:113], v[64:65], v[144:145]
    v_pk_fma_f32 v[146:147], v[114:115], v[72:73], v[146:147]
    v_pk_fma_f32 v[148:149], v[112:113], v[66:67], v[148:149]
    v_pk_fma_f32 v[150:151], v[114:115], v[74:75], v[150:151]
    v_pk_fma_f32 v[152:153], v[112:113], v[68:69], v[152:153]
    v_pk_fma_f32 v[154:155], v[114:115], v[76:77], v[154:155]
    s_waitcnt vmcnt(14)
    v_lshlrev_b32 v116, 16, v34
    v_and_b32 v117, s27, v34
    v_lshlrev_b32 v118, 16, v35
    v_and_b32 v119, s27, v35
    v_pk_fma_f32 v[148:149], v[116:117], v[64:65], v[148:149]
    v_pk_fma_f32 v[150:151], v[118:119], v[72:73], v[150:151]
    v_pk_fma_f32 v[152:153], v[116:117], v[66:67], v[152:153]
    v_pk_fma_f32 v[154:155], v[118:119], v[74:75], v[154:155]
    s_waitcnt vmcnt(13)
    v_lshlrev_b32 v120, 16, v36
    v_and_b32 v121, s27, v36
    v_lshlrev_b32 v122, 16, v37
    v_and_b32 v123, s27, v37
    v_pk_fma_f32 v[152:153], v[120:121], v[64:65], v[152:153]
    v_pk_fma_f32 v[154:155], v[122:123], v[72:73], v[154:155]
    s_waitcnt vmcnt(12)
    v_lshlrev_b32 v156, 16, v40
    v_and_b32 v157, s27, v40
    v_lshlrev_b32 v158, 16, v41
    v_and_b32 v159, s27, v41
    s_waitcnt vmcnt(11)
    v_lshlrev_b32 v160, 16, v42
    v_and_b32 v161, s27, v42
    v_lshlrev_b32 v162, 16, v43
    v_and_b32 v163, s27, v43
    s_waitcnt vmcnt(10)
    v_lshlrev_b32 v164, 16, v44
    v_and_b32 v165, s27, v44
    v_lshlrev_b32 v166, 16, v45
    v_and_b32 v167, s27, v45
    s_waitcnt vmcnt(9)
    v_lshlrev_b32 v168, 16, v46
    v_and_b32 v169, s27, v46
    v_lshlrev_b32 v170, 16, v47
    v_and_b32 v171, s27, v47
    s_waitcnt vmcnt(8)
    v_lshlrev_b32 v172, 16, v48
    v_and_b32 v173, s27, v48
    v_lshlrev_b32 v174, 16, v49
    v_and_b32 v175, s27, v49
    s_waitcnt vmcnt(7)
    v_lshlrev_b32 v176, 16, v50
    v_and_b32 v177, s27, v50
    v_lshlrev_b32 v178, 16, v51
    v_and_b32 v179, s27, v51
    s_waitcnt vmcnt(6)
    v_lshlrev_b32 v180, 16, v52
    v_and_b32 v181, s27, v52
    v_lshlrev_b32 v182, 16, v53
    v_and_b32 v183, s27, v53
    s_waitcnt vmcnt(5)
    v_lshlrev_b32 v184, 16, v54
    v_and_b32 v185, s27, v54
    v_lshlrev_b32 v186, 16, v55
    v_and_b32 v187, s27, v55
    buffer_load_dwordx2 v[14:15], v188, s[76:79], 0 offen sc1
    v_pk_mul_f32 v[124:125], v[124:125], v[156:157]
    v_pk_mul_f32 v[126:127], v[126:127], v[158:159]
    v_pk_mul_f32 v[128:129], v[128:129], v[160:161]
    v_pk_mul_f32 v[130:131], v[130:131], v[162:163]
    v_pk_mul_f32 v[132:133], v[132:133], v[164:165]
    v_pk_mul_f32 v[134:135], v[134:135], v[166:167]
    v_pk_mul_f32 v[136:137], v[136:137], v[168:169]
    v_pk_mul_f32 v[138:139], v[138:139], v[170:171]
    v_pk_mul_f32 v[140:141], v[140:141], v[172:173]
    v_pk_mul_f32 v[142:143], v[142:143], v[174:175]
    v_pk_mul_f32 v[144:145], v[144:145], v[176:177]
    v_pk_mul_f32 v[146:147], v[146:147], v[178:179]
    v_pk_mul_f32 v[148:149], v[148:149], v[180:181]
    v_pk_mul_f32 v[150:151], v[150:151], v[182:183]
    v_pk_mul_f32 v[152:153], v[152:153], v[184:185]
    v_pk_mul_f32 v[154:155], v[154:155], v[186:187]
    v_cvt_pk_bf16_f32 v16, v152, v148
    v_cvt_pk_bf16_f32 v17, v144, v140
    v_cvt_pk_bf16_f32 v18, v136, v132
    v_cvt_pk_bf16_f32 v19, v128, v124
    ds_write_b128 v7, v[16:19] offset:0
    v_cvt_pk_bf16_f32 v20, v153, v149
    v_cvt_pk_bf16_f32 v21, v145, v141
    v_cvt_pk_bf16_f32 v22, v137, v133
    v_cvt_pk_bf16_f32 v23, v129, v125
    ds_write_b128 v7, v[20:23] offset:128
    v_cvt_pk_bf16_f32 v24, v154, v150
    v_cvt_pk_bf16_f32 v25, v146, v142
    v_cvt_pk_bf16_f32 v26, v138, v134
    v_cvt_pk_bf16_f32 v27, v130, v126
    ds_write_b128 v7, v[24:27] offset:256
    v_cvt_pk_bf16_f32 v28, v155, v151
    v_cvt_pk_bf16_f32 v29, v147, v143
    v_cvt_pk_bf16_f32 v30, v139, v135
    v_cvt_pk_bf16_f32 v31, v131, v127
    ds_write_b128 v7, v[28:31] offset:384
    s_waitcnt lgkmcnt(0)
    s_barrier
    ds_read_b128 v[32:35], v8 offset:0
    ds_read_b128 v[36:39], v8 offset:4096
    ds_read_b128 v[40:43], v8 offset:8192
    ds_read_b128 v[44:47], v8 offset:12288
    s_waitcnt lgkmcnt(3)
    buffer_store_dwordx4 v[32:35], v9, s[20:23], s30 offen sc1
    s_waitcnt lgkmcnt(2)
    buffer_store_dwordx4 v[36:39], v9, s[20:23], s31 offen sc1
    s_waitcnt lgkmcnt(1)
    buffer_store_dwordx4 v[40:43], v9, s[20:23], s32 offen sc1
    s_waitcnt lgkmcnt(0)
    buffer_store_dwordx4 v[44:47], v9, s[20:23], s33 offen sc1
    s_mov_b32 s34, 1048576
    s_waitcnt vmcnt(4)
Ltag:
    v_readfirstlane_b32 s100, v14
    v_readfirstlane_b32 s101, v15
    s_nop 1
    s_min_u32 s35, s100, s101
    s_cmp_lg_u32 s35, 0
    s_cbranch_scc1 Ltag_ok
    buffer_load_dwordx2 v[14:15], v188, s[76:79], 0 offen sc1
    s_waitcnt vmcnt(0)
    s_sub_u32 s34, s34, 1
    s_cbranch_scc0 Ltag
Ltag_ok:
    s_lshl_b32 s30, s18, 5
    s_add_u32 s30, s30, s19
    s_add_u32 s30, s30, 1280
    s_mov_b32 s97, s30
    s_mov_b32 s88, s66
    s_mov_b32 s89, s67
Lconv:
    s_load_dwordx2 s[70:71], s[0:1], 40
    s_load_dwordx2 s[64:65], s[0:1], 0
    s_load_dwordx4 s[12:15], s[0:1], 56
    s_load_dwordx2 s[98:99], s[0:1], 80
    v_mov_b32 v1, v0
    v_and_b32 v0, 63, v0
    v_lshlrev_b32 v6, 4, v0
    s_lshl_b32 s18, s2, 2
    s_add_u32 s18, s18, s3
    s_mul_i32 s25, s18, 4224
    s_mul_i32 s24, s3, 12928
    s_add_u32 s24, s24, 86016
    s_lshl_b32 s62, s97, 7
    s_add_u32 s62, s62, 28442624
    s_add_u32 s60, s16, s62
    s_addc_u32 s61, s17, 0
    s_cmp_eq_u32 s3, 0
    s_cselect_b32 s62, 8, 0
    s_mov_b32 s63, 0x20000
    v_mov_b32 v178, s100
    v_mov_b32 v179, s101
    v_lshlrev_b32 v180, 4, v0
    s_waitcnt vmcnt(0)
    s_barrier
    buffer_store_dwordx2 v[178:179], v180, s[60:63], 0 offen sc1
    s_lshl_b32 s30, s18, 12
    s_add_u32 s31, s30, 2
    s_mov_b32 s90, 4194304
    s_mov_b32 s91, 0x20000
    s_add_u32 m0, s24, 32
    s_nop 0
    buffer_load_dwordx4 v6, s[88:91], s30 offen offset:0 lds
    buffer_load_dwordx4 v6, s[88:91], s30 offen offset:1024 lds
    buffer_load_dwordx4 v6, s[88:91], s30 offen offset:2048 lds
    buffer_load_dwordx4 v6, s[88:91], s30 offen offset:3072 lds
    s_add_u32 m0, s24, 4192
    s_nop 0
    buffer_load_dwordx4 v6, s[88:91], s31 offen offset:0 lds
    buffer_load_dwordx4 v6, s[88:91], s31 offen offset:1024 lds
    buffer_load_dwordx4 v6, s[88:91], s31 offen offset:2048 lds
    buffer_load_dwordx4 v6, s[88:91], s31 offen offset:3072 lds
    s_add_u32 s8, s16, 54525952
    s_addc_u32 s9, s17, 0
    s_mov_b32 s10, 4325376
    s_mov_b32 s11, 0x20000
    s_mov_b32 s36, s16
    s_mov_b32 s37, s17
    s_mov_b32 s38, 4194304
    s_mov_b32 s39, 0x20000
    v_lshrrev_b32 v9, 4, v0
    v_and_b32 v8, 15, v0
    v_subrev_u32 v3, 480, v6
    v_add_u32 v4, 3648, v6
    v_cmp_gt_u32 vcc, 32, v0
    v_add_u32 v5, 12416, v6
    v_mov_b32 v16, 0
    v_cndmask_b32 v3, v4, v3, vcc
    v_cmp_gt_u32 vcc, 30, v0
    v_mov_b32 v17, 0
    v_mov_b32 v18, 0
    v_cndmask_b32 v3, v3, v5, vcc
    v_add_u32 v3, s24, v3
    v_mov_b32 v19, 0
    s_mov_b32 exec_hi, 3
    ds_write_b128 v3, v[16:19]
    s_mov_b32 exec_hi, -1
    s_waitcnt lgkmcnt(0)
    v_lshlrev_b32 v10, 4, v9
    v_lshl_add_u32 v3, v8, 1, v10
    v_and_b32 v4, 1, v8
    v_cmp_eq_u32 vcc, 1, v4
    v_add_u32 v4, 2, v3
    v_add_u32 v3, 4160, v3
    v_cndmask_b32 v3, v3, v4, vcc
    v_add_u32 v11, s24, v3
    v_add_u32 v12, 1024, v11
    v_add_u32 v13, 2048, v11
    v_add_u32 v14, 3072, v11
    s_add_u32 s19, s24, 8800
    v_lshlrev_b32 v3, 5, v8
    v_sub_u32 v5, v10, v3
    v_add_u32 v5, s19, v5
    s_and_b32 s33, s2, 0xe0
    s_add_u32 s33, s33, 1280
    s_cmp_lg_u32 s3, 0
    s_cbranch_scc1 Lcw_join
    s_lshl_b32 s30, s33, 7
    s_add_u32 s30, s30, 28442624
    s_add_u32 s28, s16, s30
    s_addc_u32 s29, s17, 0
    s_movk_i32 s30, 4096
    s_mov_b32 s31, 0x20000
    v_and_b32 v180, 31, v0
    v_lshlrev_b32 v180, 7, v180
    s_mov_b32 s32, 1048576
Lcw_poll:
    buffer_load_dwordx2 v[178:179], v180, s[28:31], 0 offen sc1
    s_sub_u32 s32, s32, 1
    s_cbranch_scc1 Lcw_join
    s_waitcnt vmcnt(0)
    v_cmp_ne_u64 vcc, s[100:101], v[178:179]
    s_nop 1
    s_cmp_lg_u64 vcc, 0
    s_cbranch_scc1 Lcw_poll
Lcw_join:
    s_barrier
    s_add_u32 m0, s24, 8320
    s_nop 0
    buffer_load_dwordx4 v6, s[8:11], s25 offen offset:0 sc1 lds
    buffer_load_dwordx4 v6, s[8:11], s25 offen offset:1024 sc1 lds
    buffer_load_dwordx4 v6, s[8:11], s25 offen offset:2048 sc1 lds
    buffer_load_dwordx4 v6, s[8:11], s25 offen offset:3072 sc1 lds
    v_mov_b32 v3, s24
    s_waitcnt vmcnt(4)
    ds_read_u16 v4, v3 offset:32
    s_waitcnt lgkmcnt(0)
    ds_write_b16 v3, v4 offset:4190
    ds_read2_b32 v[48:49], v11 offset0:0 offset1:1
    ds_read2_b32 v[50:51], v11 offset0:2 offset1:3
    ds_read2_b32 v[52:53], v11 offset0:128 offset1:129
    ds_read2_b32 v[54:55], v11 offset0:130 offset1:131
    ds_read2_b32 v[56:57], v12 offset0:0 offset1:1
    ds_read2_b32 v[58:59], v12 offset0:2 offset1:3
    ds_read2_b32 v[60:61], v12 offset0:128 offset1:129
    ds_read2_b32 v[62:63], v12 offset0:130 offset1:131
    ds_read2_b32 v[64:65], v13 offset0:0 offset1:1
    ds_read2_b32 v[66:67], v13 offset0:2 offset1:3
    ds_read2_b32 v[68:69], v13 offset0:128 offset1:129
    ds_read2_b32 v[70:71], v13 offset0:130 offset1:131
    ds_read2_b32 v[72:73], v14 offset0:0 offset1:1
    ds_read2_b32 v[74:75], v14 offset0:2 offset1:3
    ds_read2_b32 v[76:77], v14 offset0:128 offset1:129
    ds_read2_b32 v[78:79], v14 offset0:130 offset1:131
    s_lshr_b32 s26, s18, 1
    s_lshl_b32 s26, s26, 2
    s_mov_b32 s76, s70
    s_mov_b32 s77, s71
    s_mov_b32 s78, 2048
    s_mov_b32 s79, 0x20000
    v_mov_b32 v176, 0
    s_mov_b32 s66, 4194304
    s_mov_b32 s67, 0x20000
    v_and_b32 v3, 7, v0
    v_lshlrev_b32 v2, 11, v3
    v_bfe_u32 v3, v0, 3, 1
    v_lshl_add_u32 v2, v3, 6, v2
    v_lshl_add_u32 v2, v9, 3, v2
    s_and_b32 s34, s2, 7
    s_lshr_b32 s33, s2, 3
    s_lshl_b32 s68, s34, 5
    s_add_u32 s68, s68, s33
    s_lshl_b32 s68, s68, 14
    s_lshl_b32 s32, s3, 9
    s_add_u32 s68, s68, s32
    s_movk_i32 s32, 9363
    v_mul_u32_u24 v3, s32, v0
    v_lshrrev_b32 v3, 16, v3
    s_mov_b32 s32, 457856
    v_mul_u32_u24 v3, s32, v3
    v_lshl_add_u32 v3, v0, 7, v3
    s_lshl_b32 s32, s33, 1
    s_lshr_b32 s35, s3, 1
    s_add_u32 s32, s32, s35
    s_mul_i32 s32, s32, 7168
    s_mul_i32 s35, s34, 896
    s_add_u32 s32, s32, s35
    v_cmp_gt_u32 vcc, 21, v0
    v_add_u32 v3, s32, v3
    v_bfrev_b32 v4, 1
    v_cndmask_b32 v7, v4, v3, vcc
    v_mov_b32 v211, v7
    s_and_b32 s23, s2, 7
    s_lshl_b32 s23, s23, 2
    s_lshr_b32 s28, s2, 6
    s_add_u32 s23, s23, s28
    s_mul_i32 s23, s23, 224
    s_lshr_b32 s29, s3, 1
    s_mul_i32 s29, s29, 229376
    s_add_u32 s29, s29, s23
    s_movk_i32 s23, 4682
    s_movk_i32 s28, 6944
    v_mul_u32_u24 v207, s23, v0
    v_lshl_add_u32 v208, v0, 4, s29
    v_add_u32 v209, 4096, v208
    v_lshrrev_b32 v210, 16, v207
    v_mad_u32_u24 v200, v210, s28, v208
    v_add_u32 v210, 299648, v207
    v_lshrrev_b32 v210, 16, v210
    v_mad_u32_u24 v201, v210, s28, v208
    v_add_u32 v210, 599296, v207
    v_lshrrev_b32 v210, 16, v210
    v_mad_u32_u24 v202, v210, s28, v208
    v_add_u32 v210, 898944, v207
    v_lshrrev_b32 v210, 16, v210
    v_mad_u32_u24 v203, v210, s28, v208
    v_add_u32 v210, 1198592, v207
    v_lshrrev_b32 v210, 16, v210
    v_mad_u32_u24 v204, v210, s28, v209
    v_add_u32 v210, 1498240, v207
    v_lshrrev_b32 v210, 16, v210
    v_mad_u32_u24 v205, v210, s28, v209
    v_add_u32 v210, 1797888, v207
    v_lshrrev_b32 v210, 16, v210
    v_mad_u32_u24 v206, v210, s28, v209
    s_mul_i32 s94, s3, 7168
    s_mov_b32 s95, 0
    s_and_b32 s23, s3, 1
    s_cmp_eq_u32 s23, 1
    s_cselect_b32 s72, s14, s12
    s_cselect_b32 s73, s15, s13
    s_mov_b32 s74, 7340032
    s_mov_b32 s75, 0x20000
    s_mov_b32 s69, 0
    v_and_b32 v3, 7, v0
    v_lshlrev_b32 v177, 11, v3
    v_bfe_u32 v3, v0, 3, 2
    v_lshl_add_u32 v177, v3, 7, v177
    s_add_u32 s4, s16, 28385280
    s_addc_u32 s5, s17, 0
    s_mov_b32 s6, 2048
    s_mov_b32 s7, 0x20000
    s_add_u32 s20, s16, 28442624
    s_addc_u32 s21, s17, 0
    s_mov_b32 s22, 393216
    s_mov_b32 s23, 0x20000
    v_lshlrev_b32 v181, 7, v1
    v_add_u32 v182, 3, v1
    v_cmp_gt_u32 vcc, 5, v1
    s_cmp_eq_u32 s2, 0
    s_cselect_b32 s6, s6, 0
    v_cndmask_b32 v182, v182, v1, vcc
    v_lshlrev_b32 v182, 15, v182
    s_lshl_b32 s92, s2, 7
    s_waitcnt vmcnt(0)
    ds_read_b128 v[80:83], v5 offset:3584
    ds_read_b128 v[84:87], v5 offset:3072
    ds_read_b128 v[88:91], v5 offset:2560
    ds_read_b128 v[92:95], v5 offset:2048
    ds_read_b128 v[96:99], v5 offset:1536
    ds_read_b128 v[100:103], v5 offset:1024
    ds_read_b128 v[104:107], v5 offset:512
    ds_read_b128 v[108:111], v5 offset:0
    s_waitcnt lgkmcnt(0)
    v_mfma_f32_16x16x32_bf16 v[16:19], v[48:51], v[80:83], 0
    ds_read2_b32 v[112:113], v11 offset0:16 offset1:17
    v_mfma_f32_16x16x32_bf16 v[20:23], v[48:51], v[84:87], 0
    ds_read2_b32 v[114:115], v11 offset0:18 offset1:19
    v_mfma_f32_16x16x32_bf16 v[20:23], v[52:55], v[80:83], v[20:23]
    ds_read_b128 v[144:147], v5 offset:3648
    v_mfma_f32_16x16x32_bf16 v[24:27], v[48:51], v[88:91], 0
    ds_read2_b32 v[116:117], v11 offset0:144 offset1:145
    buffer_load_dword v176, v176, s[76:79], s26 offen
    v_mfma_f32_16x16x32_bf16 v[24:27], v[52:55], v[84:87], v[24:27]
    ds_read2_b32 v[118:119], v11 offset0:146 offset1:147
    v_mfma_f32_16x16x32_bf16 v[24:27], v[56:59], v[80:83], v[24:27]
    ds_read_b128 v[148:151], v5 offset:3136
    v_mfma_f32_16x16x32_bf16 v[28:31], v[48:51], v[92:95], 0
    ds_read2_b32 v[120:121], v12 offset0:16 offset1:17
    v_mfma_f32_16x16x32_bf16 v[28:31], v[52:55], v[88:91], v[28:31]
    ds_read2_b32 v[122:123], v12 offset0:18 offset1:19
    v_mfma_f32_16x16x32_bf16 v[28:31], v[56:59], v[84:87], v[28:31]
    ds_read_b128 v[152:155], v5 offset:2624
    v_mfma_f32_16x16x32_bf16 v[28:31], v[60:63], v[80:83], v[28:31]
    ds_read2_b32 v[124:125], v12 offset0:144 offset1:145
    buffer_load_dword v15, v177, s[64:67], s68 offen
    v_mfma_f32_16x16x32_bf16 v[32:35], v[48:51], v[96:99], 0
    ds_read2_b32 v[126:127], v12 offset0:146 offset1:147
    v_mfma_f32_16x16x32_bf16 v[32:35], v[52:55], v[92:95], v[32:35]
    ds_read_b128 v[156:159], v5 offset:2112
    v_mfma_f32_16x16x32_bf16 v[32:35], v[56:59], v[88:91], v[32:35]
    ds_read2_b32 v[128:129], v13 offset0:16 offset1:17
    v_mfma_f32_16x16x32_bf16 v[32:35], v[60:63], v[84:87], v[32:35]
    ds_read2_b32 v[130:131], v13 offset0:18 offset1:19
    v_mfma_f32_16x16x32_bf16 v[32:35], v[64:67], v[80:83], v[32:35]
    ds_read_b128 v[160:163], v5 offset:1600
    v_mfma_f32_16x16x32_bf16 v[36:39], v[48:51], v[100:103], 0
    ds_read2_b32 v[132:133], v13 offset0:144 offset1:145
    buffer_load_dword v15, v7, s[72:75], s69 offen
    v_mfma_f32_16x16x32_bf16 v[36:39], v[52:55], v[96:99], v[36:39]
    ds_read2_b32 v[134:135], v13 offset0:146 offset1:147
    v_mfma_f32_16x16x32_bf16 v[36:39], v[56:59], v[92:95], v[36:39]
    ds_read_b128 v[164:167], v5 offset:1088
    v_mfma_f32_16x16x32_bf16 v[36:39], v[60:63], v[88:91], v[36:39]
    ds_read2_b32 v[136:137], v14 offset0:16 offset1:17
    v_mfma_f32_16x16x32_bf16 v[36:39], v[64:67], v[84:87], v[36:39]
    ds_read2_b32 v[138:139], v14 offset0:18 offset1:19
    v_mfma_f32_16x16x32_bf16 v[36:39], v[68:71], v[80:83], v[36:39]
    ds_read_b128 v[168:171], v5 offset:576
    v_mfma_f32_16x16x32_bf16 v[40:43], v[48:51], v[104:107], 0
    ds_read2_b32 v[140:141], v14 offset0:144 offset1:145
    buffer_store_dword v188, v181, s[4:7], 0 offen sc1
    v_mfma_f32_16x16x32_bf16 v[40:43], v[52:55], v[100:103], v[40:43]
    ds_read2_b32 v[142:143], v14 offset0:146 offset1:147
    v_mfma_f32_16x16x32_bf16 v[40:43], v[56:59], v[96:99], v[40:43]
    ds_read_b128 v[172:175], v5 offset:64
    v_mfma_f32_16x16x32_bf16 v[40:43], v[60:63], v[92:95], v[40:43]
    v_mfma_f32_16x16x32_bf16 v[40:43], v[64:67], v[88:91], v[40:43]
    v_mfma_f32_16x16x32_bf16 v[40:43], v[68:71], v[84:87], v[40:43]
    buffer_store_dword v188, v182, s[20:23], s92 offen sc1
    v_mfma_f32_16x16x32_bf16 v[40:43], v[72:75], v[80:83], v[40:43]
    v_mfma_f32_16x16x32_bf16 v[44:47], v[48:51], v[108:111], 0
    v_mfma_f32_16x16x32_bf16 v[44:47], v[52:55], v[104:107], v[44:47]
    v_mfma_f32_16x16x32_bf16 v[44:47], v[56:59], v[100:103], v[44:47]
    v_mfma_f32_16x16x32_bf16 v[44:47], v[60:63], v[96:99], v[44:47]
    v_mfma_f32_16x16x32_bf16 v[44:47], v[64:67], v[92:95], v[44:47]
    v_mfma_f32_16x16x32_bf16 v[44:47], v[68:71], v[88:91], v[44:47]
    v_mfma_f32_16x16x32_bf16 v[44:47], v[72:75], v[84:87], v[44:47]
    v_mfma_f32_16x16x32_bf16 v[44:47], v[76:79], v[80:83], v[44:47]
    s_waitcnt lgkmcnt(0)
    v_mfma_f32_16x16x32_bf16 v[16:19], v[112:115], v[144:147], v[16:19]
    ds_read2_b32 v[48:49], v11 offset0:32 offset1:33
    v_lshlrev_b32 v3, 5, v8
    v_mfma_f32_16x16x32_bf16 v[20:23], v[112:115], v[148:151], v[20:23]
    ds_read2_b32 v[50:51], v11 offset0:34 offset1:35
    v_lshl_add_u32 v3, v9, 3, v3
    v_mfma_f32_16x16x32_bf16 v[20:23], v[116:119], v[144:147], v[20:23]
    ds_read_b128 v[80:83], v5 offset:3712
    s_add_u32 s26, s19, 24
    v_mfma_f32_16x16x32_bf16 v[24:27], v[112:115], v[152:155], v[24:27]
    ds_read2_b32 v[52:53], v11 offset0:160 offset1:161
    v_sub_u32 v4, s26, v3
    v_mfma_f32_16x16x32_bf16 v[24:27], v[116:119], v[148:151], v[24:27]
    ds_read2_b32 v[54:55], v11 offset0:162 offset1:163
    s_lshl_b32 s26, s3, 12
    v_mfma_f32_16x16x32_bf16 v[24:27], v[120:123], v[144:147], v[24:27]
    ds_read_b128 v[84:87], v5 offset:3200
    s_add_u32 s26, s26, 137728
    v_mfma_f32_16x16x32_bf16 v[28:31], v[112:115], v[156:159], v[28:31]
    ds_read2_b32 v[56:57], v12 offset0:32 offset1:33
    v_add_u32 v3, s26, v3
    v_mfma_f32_16x16x32_bf16 v[28:31], v[116:119], v[152:155], v[28:31]
    ds_read2_b32 v[58:59], v12 offset0:34 offset1:35
    v_mfma_f32_16x16x32_bf16 v[28:31], v[120:123], v[148:151], v[28:31]
    ds_read_b128 v[88:91], v5 offset:2688
    v_mfma_f32_16x16x32_bf16 v[28:31], v[124:127], v[144:147], v[28:31]
    ds_read2_b32 v[60:61], v12 offset0:160 offset1:161
    v_mfma_f32_16x16x32_bf16 v[32:35], v[112:115], v[160:163], v[32:35]
    ds_read2_b32 v[62:63], v12 offset0:162 offset1:163
    v_mfma_f32_16x16x32_bf16 v[32:35], v[116:119], v[156:159], v[32:35]
    ds_read_b128 v[92:95], v5 offset:2176
    v_mfma_f32_16x16x32_bf16 v[32:35], v[120:123], v[152:155], v[32:35]
    ds_read2_b32 v[64:65], v13 offset0:32 offset1:33
    v_mfma_f32_16x16x32_bf16 v[32:35], v[124:127], v[148:151], v[32:35]
    ds_read2_b32 v[66:67], v13 offset0:34 offset1:35
    v_mfma_f32_16x16x32_bf16 v[32:35], v[128:131], v[144:147], v[32:35]
    ds_read_b128 v[96:99], v5 offset:1664
    v_mfma_f32_16x16x32_bf16 v[36:39], v[112:115], v[164:167], v[36:39]
    ds_read2_b32 v[68:69], v13 offset0:160 offset1:161
    v_mfma_f32_16x16x32_bf16 v[36:39], v[116:119], v[160:163], v[36:39]
    ds_read2_b32 v[70:71], v13 offset0:162 offset1:163
    v_mfma_f32_16x16x32_bf16 v[36:39], v[120:123], v[156:159], v[36:39]
    ds_read_b128 v[100:103], v5 offset:1152
    v_mfma_f32_16x16x32_bf16 v[36:39], v[124:127], v[152:155], v[36:39]
    ds_read2_b32 v[72:73], v14 offset0:32 offset1:33
    v_mfma_f32_16x16x32_bf16 v[36:39], v[128:131], v[148:151], v[36:39]
    ds_read2_b32 v[74:75], v14 offset0:34 offset1:35
    v_mfma_f32_16x16x32_bf16 v[36:39], v[132:135], v[144:147], v[36:39]
    ds_read_b128 v[104:107], v5 offset:640
    v_mfma_f32_16x16x32_bf16 v[40:43], v[112:115], v[168:171], v[40:43]
    ds_read2_b32 v[76:77], v14 offset0:160 offset1:161
    v_mfma_f32_16x16x32_bf16 v[40:43], v[116:119], v[164:167], v[40:43]
    ds_read2_b32 v[78:79], v14 offset0:162 offset1:163
    v_mfma_f32_16x16x32_bf16 v[40:43], v[120:123], v[160:163], v[40:43]
    ds_read_b128 v[108:111], v5 offset:128
    v_mfma_f32_16x16x32_bf16 v[40:43], v[124:127], v[156:159], v[40:43]
    ds_read_b64 v[214:215], v4 offset:3584
    v_mfma_f32_16x16x32_bf16 v[40:43], v[128:131], v[152:155], v[40:43]
    ds_read_b64 v[218:219], v4 offset:3072
    v_mfma_f32_16x16x32_bf16 v[40:43], v[132:135], v[148:151], v[40:43]
    ds_read_b64 v[222:223], v4 offset:2560
    v_mfma_f32_16x16x32_bf16 v[40:43], v[136:139], v[144:147], v[40:43]
    ds_read_b64 v[226:227], v4 offset:2048
    v_mfma_f32_16x16x32_bf16 v[44:47], v[112:115], v[172:175], v[44:47]
    ds_read_b64 v[230:231], v4 offset:1536
    v_mfma_f32_16x16x32_bf16 v[44:47], v[116:119], v[168:171], v[44:47]
    ds_read_b64 v[234:235], v4 offset:1024
    v_mfma_f32_16x16x32_bf16 v[44:47], v[120:123], v[164:167], v[44:47]
    ds_read_b64 v[238:239], v4 offset:512
    v_mfma_f32_16x16x32_bf16 v[44:47], v[124:127], v[160:163], v[44:47]
    ds_read_b64 v[242:243], v4 offset:0
    v_mfma_f32_16x16x32_bf16 v[44:47], v[128:131], v[156:159], v[44:47]
    v_mfma_f32_16x16x32_bf16 v[44:47], v[132:135], v[152:155], v[44:47]
    v_mfma_f32_16x16x32_bf16 v[44:47], v[136:139], v[148:151], v[44:47]
    v_mfma_f32_16x16x32_bf16 v[44:47], v[140:143], v[144:147], v[44:47]
    s_waitcnt lgkmcnt(0)
    v_mfma_f32_16x16x32_bf16 v[16:19], v[48:51], v[80:83], v[16:19]
    ds_read2_b32 a[0:1], v11 offset0:48 offset1:49
    v_and_b32 v212, s27, v215
    v_mfma_f32_16x16x32_bf16 v[20:23], v[48:51], v[84:87], v[20:23]
    ds_read2_b32 a[2:3], v11 offset0:50 offset1:51
    v_lshlrev_b32 v213, 16, v215
    v_mfma_f32_16x16x32_bf16 v[20:23], v[52:55], v[80:83], v[20:23]
    ds_read_b128 a[16:19], v5 offset:3776
    v_lshlrev_b32 v215, 16, v214
    v_mfma_f32_16x16x32_bf16 v[24:27], v[48:51], v[88:91], v[24:27]
    ds_read2_b32 a[4:5], v11 offset0:176 offset1:177
    v_and_b32 v214, s27, v214
    v_mfma_f32_16x16x32_bf16 v[24:27], v[52:55], v[84:87], v[24:27]
    ds_read2_b32 a[6:7], v11 offset0:178 offset1:179
    v_and_b32 v216, s27, v219
    v_mfma_f32_16x16x32_bf16 v[24:27], v[56:59], v[80:83], v[24:27]
    ds_read_b128 a[20:23], v5 offset:3264
    v_lshlrev_b32 v217, 16, v219
    v_mfma_f32_16x16x32_bf16 v[28:31], v[48:51], v[92:95], v[28:31]
    ds_read2_b32 a[8:9], v12 offset0:48 offset1:49
    v_lshlrev_b32 v219, 16, v218
    v_mfma_f32_16x16x32_bf16 v[28:31], v[52:55], v[88:91], v[28:31]
    ds_read2_b32 a[10:11], v12 offset0:50 offset1:51
    v_and_b32 v218, s27, v218
    v_mfma_f32_16x16x32_bf16 v[28:31], v[56:59], v[84:87], v[28:31]
    ds_read_b128 a[24:27], v5 offset:2752
    v_and_b32 v220, s27, v223
    v_mfma_f32_16x16x32_bf16 v[28:31], v[60:63], v[80:83], v[28:31]
    ds_read2_b32 a[12:13], v12 offset0:176 offset1:177
    v_lshlrev_b32 v221, 16, v223
    v_mfma_f32_16x16x32_bf16 v[32:35], v[48:51], v[96:99], v[32:35]
    ds_read2_b32 a[14:15], v12 offset0:178 offset1:179
    v_lshlrev_b32 v223, 16, v222
    v_mfma_f32_16x16x32_bf16 v[32:35], v[52:55], v[92:95], v[32:35]
    ds_read_b128 a[28:31], v5 offset:2240
    v_and_b32 v222, s27, v222
    v_mfma_f32_16x16x32_bf16 v[32:35], v[56:59], v[88:91], v[32:35]
    ds_read2_b32 v[128:129], v13 offset0:48 offset1:49
    v_and_b32 v224, s27, v227
    v_mfma_f32_16x16x32_bf16 v[32:35], v[60:63], v[84:87], v[32:35]
    ds_read2_b32 v[130:131], v13 offset0:50 offset1:51
    v_lshlrev_b32 v225, 16, v227
    v_mfma_f32_16x16x32_bf16 v[32:35], v[64:67], v[80:83], v[32:35]
    ds_read_b128 v[160:163], v5 offset:1728
    v_lshlrev_b32 v227, 16, v226
    v_mfma_f32_16x16x32_bf16 v[36:39], v[48:51], v[100:103], v[36:39]
    ds_read2_b32 v[132:133], v13 offset0:176 offset1:177
    v_and_b32 v226, s27, v226
    v_mfma_f32_16x16x32_bf16 v[36:39], v[52:55], v[96:99], v[36:39]
    ds_read2_b32 v[134:135], v13 offset0:178 offset1:179
    v_and_b32 v228, s27, v231
    v_mfma_f32_16x16x32_bf16 v[36:39], v[56:59], v[92:95], v[36:39]
    ds_read_b128 v[164:167], v5 offset:1216
    v_lshlrev_b32 v229, 16, v231
    v_mfma_f32_16x16x32_bf16 v[36:39], v[60:63], v[88:91], v[36:39]
    ds_read2_b32 v[136:137], v14 offset0:48 offset1:49
    v_lshlrev_b32 v231, 16, v230
    v_mfma_f32_16x16x32_bf16 v[36:39], v[64:67], v[84:87], v[36:39]
    ds_read2_b32 v[138:139], v14 offset0:50 offset1:51
    v_and_b32 v230, s27, v230
    v_mfma_f32_16x16x32_bf16 v[36:39], v[68:71], v[80:83], v[36:39]
    ds_read_b128 v[168:171], v5 offset:704
    v_and_b32 v232, s27, v235
    v_mfma_f32_16x16x32_bf16 v[40:43], v[48:51], v[104:107], v[40:43]
    ds_read2_b32 v[140:141], v14 offset0:176 offset1:177
    v_lshlrev_b32 v233, 16, v235
    v_mfma_f32_16x16x32_bf16 v[40:43], v[52:55], v[100:103], v[40:43]
    ds_read2_b32 v[142:143], v14 offset0:178 offset1:179
    v_lshlrev_b32 v235, 16, v234
    v_mfma_f32_16x16x32_bf16 v[40:43], v[56:59], v[96:99], v[40:43]
    ds_read_b128 v[172:175], v5 offset:192
    v_and_b32 v234, s27, v234
    v_mfma_f32_16x16x32_bf16 v[40:43], v[60:63], v[92:95], v[40:43]
    v_and_b32 v236, s27, v239
    v_mfma_f32_16x16x32_bf16 v[40:43], v[64:67], v[88:91], v[40:43]
    v_lshlrev_b32 v237, 16, v239
    v_mfma_f32_16x16x32_bf16 v[40:43], v[68:71], v[84:87], v[40:43]
    v_lshlrev_b32 v239, 16, v238
    v_mfma_f32_16x16x32_bf16 v[40:43], v[72:75], v[80:83], v[40:43]
    v_and_b32 v238, s27, v238
    v_mfma_f32_16x16x32_bf16 v[44:47], v[48:51], v[108:111], v[44:47]
    v_and_b32 v240, s27, v243
    v_mfma_f32_16x16x32_bf16 v[44:47], v[52:55], v[104:107], v[44:47]
    v_lshlrev_b32 v241, 16, v243
    v_mfma_f32_16x16x32_bf16 v[44:47], v[56:59], v[100:103], v[44:47]
    v_lshlrev_b32 v243, 16, v242
    v_mfma_f32_16x16x32_bf16 v[44:47], v[60:63], v[96:99], v[44:47]
    v_and_b32 v242, s27, v242
    v_mfma_f32_16x16x32_bf16 v[44:47], v[64:67], v[92:95], v[44:47]
    v_mfma_f32_16x16x32_bf16 v[44:47], v[68:71], v[88:91], v[44:47]
    v_mfma_f32_16x16x32_bf16 v[44:47], v[72:75], v[84:87], v[44:47]
    v_mfma_f32_16x16x32_bf16 v[44:47], v[76:79], v[80:83], v[44:47]
    s_waitcnt lgkmcnt(0)
    v_mfma_f32_16x16x32_bf16 v[32:35], a[0:3], v[160:163], v[32:35]
    ds_read2_b32 a[32:33], v11 offset0:64 offset1:65
    v_mfma_f32_16x16x32_bf16 v[32:35], a[4:7], a[28:31], v[32:35]
    ds_read2_b32 a[34:35], v11 offset0:66 offset1:67
    v_mfma_f32_16x16x32_bf16 v[32:35], a[8:11], a[24:27], v[32:35]
    ds_read_b128 a[48:51], v5 offset:3840
    ds_read2_b32 a[36:37], v11 offset0:192 offset1:193
    v_mfma_f32_16x16x32_bf16 v[32:35], a[12:15], a[20:23], v[32:35]
    ds_read2_b32 a[38:39], v11 offset0:194 offset1:195
    v_mfma_f32_16x16x32_bf16 v[32:35], v[128:131], a[16:19], v[32:35]
    ds_read_b128 a[52:55], v5 offset:3328
    v_mfma_f32_16x16x32_bf16 v[36:39], a[0:3], v[164:167], v[36:39]
    ds_read2_b32 a[40:41], v12 offset0:64 offset1:65
    v_mfma_f32_16x16x32_bf16 v[36:39], a[4:7], v[160:163], v[36:39]
    ds_read2_b32 a[42:43], v12 offset0:66 offset1:67
    v_mfma_f32_16x16x32_bf16 v[36:39], a[8:11], a[28:31], v[36:39]
    ds_read_b128 a[56:59], v5 offset:2816
    ds_read2_b32 a[44:45], v12 offset0:192 offset1:193
    v_mfma_f32_16x16x32_bf16 v[36:39], a[12:15], a[24:27], v[36:39]
    ds_read2_b32 a[46:47], v12 offset0:194 offset1:195
    v_mfma_f32_16x16x32_bf16 v[36:39], v[128:131], a[20:23], v[36:39]
    ds_read_b128 a[60:63], v5 offset:2304
    v_mfma_f32_16x16x32_bf16 v[36:39], v[132:135], a[16:19], v[36:39]
    ds_read2_b32 v[64:65], v13 offset0:64 offset1:65
    v_mfma_f32_16x16x32_bf16 v[40:43], a[0:3], v[168:171], v[40:43]
    ds_read2_b32 v[66:67], v13 offset0:66 offset1:67
    v_mfma_f32_16x16x32_bf16 v[40:43], a[4:7], v[164:167], v[40:43]
    ds_read_b128 v[96:99], v5 offset:1792
    ds_read2_b32 v[68:69], v13 offset0:192 offset1:193
    v_mfma_f32_16x16x32_bf16 v[40:43], a[8:11], v[160:163], v[40:43]
    ds_read2_b32 v[70:71], v13 offset0:194 offset1:195
    v_mfma_f32_16x16x32_bf16 v[40:43], a[12:15], a[28:31], v[40:43]
    ds_read_b128 v[100:103], v5 offset:1280
    v_mfma_f32_16x16x32_bf16 v[40:43], v[128:131], a[24:27], v[40:43]
    ds_read2_b32 v[72:73], v14 offset0:64 offset1:65
    v_mfma_f32_16x16x32_bf16 v[40:43], v[132:135], a[20:23], v[40:43]
    ds_read2_b32 v[74:75], v14 offset0:66 offset1:67
    v_mfma_f32_16x16x32_bf16 v[40:43], v[136:139], a[16:19], v[40:43]
    ds_read_b128 v[104:107], v5 offset:768
    ds_read2_b32 v[76:77], v14 offset0:192 offset1:193
    v_mfma_f32_16x16x32_bf16 v[44:47], a[0:3], v[172:175], v[44:47]
    ds_read2_b32 v[78:79], v14 offset0:194 offset1:195
    v_mfma_f32_16x16x32_bf16 v[44:47], a[4:7], v[168:171], v[44:47]
    ds_read_b128 v[108:111], v5 offset:256
    v_mfma_f32_16x16x32_bf16 v[44:47], a[8:11], v[164:167], v[44:47]
    v_mfma_f32_16x16x32_bf16 v[44:47], a[12:15], v[160:163], v[44:47]
    v_mfma_f32_16x16x32_bf16 v[44:47], v[128:131], a[28:31], v[44:47]
    v_mfma_f32_16x16x32_bf16 v[44:47], v[132:135], a[24:27], v[44:47]
    v_mfma_f32_16x16x32_bf16 v[44:47], v[136:139], a[20:23], v[44:47]
    v_mfma_f32_16x16x32_bf16 v[44:47], v[140:143], a[16:19], v[44:47]
    s_waitcnt lgkmcnt(0)
    v_mfma_f32_16x16x32_bf16 v[32:35], a[32:35], v[96:99], v[32:35]
    ds_read2_b32 a[64:65], v11 offset0:80 offset1:81
    v_mfma_f32_16x16x32_bf16 v[32:35], a[36:39], a[60:63], v[32:35]
    ds_read2_b32 a[66:67], v11 offset0:82 offset1:83
    v_mfma_f32_16x16x32_bf16 v[32:35], a[40:43], a[56:59], v[32:35]
    ds_read_b128 a[80:83], v5 offset:3904
    ds_read2_b32 a[68:69], v11 offset0:208 offset1:209
    v_mfma_f32_16x16x32_bf16 v[32:35], a[44:47], a[52:55], v[32:35]
    ds_read2_b32 a[70:71], v11 offset0:210 offset1:211
    v_mfma_f32_16x16x32_bf16 v[32:35], v[64:67], a[48:51], v[32:35]
    ds_read_b128 a[84:87], v5 offset:3392
    v_mfma_f32_16x16x32_bf16 v[36:39], a[32:35], v[100:103], v[36:39]
    ds_read2_b32 a[72:73], v12 offset0:80 offset1:81
    v_mfma_f32_16x16x32_bf16 v[36:39], a[36:39], v[96:99], v[36:39]
    ds_read2_b32 a[74:75], v12 offset0:82 offset1:83
    v_mfma_f32_16x16x32_bf16 v[36:39], a[40:43], a[60:63], v[36:39]
    ds_read_b128 a[88:91], v5 offset:2880
    ds_read2_b32 a[76:77], v12 offset0:208 offset1:209
    v_mfma_f32_16x16x32_bf16 v[36:39], a[44:47], a[56:59], v[36:39]
    ds_read2_b32 a[78:79], v12 offset0:210 offset1:211
    v_mfma_f32_16x16x32_bf16 v[36:39], v[64:67], a[52:55], v[36:39]
    ds_read_b128 a[92:95], v5 offset:2368
    v_mfma_f32_16x16x32_bf16 v[36:39], v[68:71], a[48:51], v[36:39]
    ds_read2_b32 v[128:129], v13 offset0:80 offset1:81
    v_mfma_f32_16x16x32_bf16 v[40:43], a[32:35], v[104:107], v[40:43]
    ds_read2_b32 v[130:131], v13 offset0:82 offset1:83
    v_mfma_f32_16x16x32_bf16 v[40:43], a[36:39], v[100:103], v[40:43]
    ds_read_b128 v[160:163], v5 offset:1856
    ds_read2_b32 v[132:133], v13 offset0:208 offset1:209
    v_mfma_f32_16x16x32_bf16 v[40:43], a[40:43], v[96:99], v[40:43]
    ds_read2_b32 v[134:135], v13 offset0:210 offset1:211
    v_mfma_f32_16x16x32_bf16 v[40:43], a[44:47], a[60:63], v[40:43]
    ds_read_b128 v[164:167], v5 offset:1344
    v_mfma_f32_16x16x32_bf16 v[40:43], v[64:67], a[56:59], v[40:43]
    ds_read2_b32 v[136:137], v14 offset0:80 offset1:81
    v_mfma_f32_16x16x32_bf16 v[40:43], v[68:71], a[52:55], v[40:43]
    ds_read2_b32 v[138:139], v14 offset0:82 offset1:83
    v_mfma_f32_16x16x32_bf16 v[40:43], v[72:75], a[48:51], v[40:43]
    ds_read_b128 v[168:171], v5 offset:832
    ds_read2_b32 v[140:141], v14 offset0:208 offset1:209
    v_mfma_f32_16x16x32_bf16 v[44:47], a[32:35], v[108:111], v[44:47]
    ds_read2_b32 v[142:143], v14 offset0:210 offset1:211
    v_mfma_f32_16x16x32_bf16 v[44:47], a[36:39], v[104:107], v[44:47]
    ds_read_b128 v[172:175], v5 offset:320
    v_mfma_f32_16x16x32_bf16 v[44:47], a[40:43], v[100:103], v[44:47]
    v_mfma_f32_16x16x32_bf16 v[44:47], a[44:47], v[96:99], v[44:47]
    v_mfma_f32_16x16x32_bf16 v[44:47], v[64:67], a[60:63], v[44:47]
    v_mfma_f32_16x16x32_bf16 v[44:47], v[68:71], a[56:59], v[44:47]
    v_mfma_f32_16x16x32_bf16 v[44:47], v[72:75], a[52:55], v[44:47]
    v_mfma_f32_16x16x32_bf16 v[44:47], v[76:79], a[48:51], v[44:47]
    s_waitcnt lgkmcnt(0)
    v_mfma_f32_16x16x32_bf16 v[32:35], a[64:67], v[160:163], v[32:35]
    ds_read2_b32 a[96:97], v11 offset0:96 offset1:97
    v_mfma_f32_16x16x32_bf16 v[32:35], a[68:71], a[92:95], v[32:35]
    ds_read2_b32 a[98:99], v11 offset0:98 offset1:99
    v_mfma_f32_16x16x32_bf16 v[32:35], a[72:75], a[88:91], v[32:35]
    ds_read_b128 a[112:115], v5 offset:3968
    ds_read2_b32 a[100:101], v11 offset0:224 offset1:225
    v_mfma_f32_16x16x32_bf16 v[32:35], a[76:79], a[84:87], v[32:35]
    ds_read2_b32 a[102:103], v11 offset0:226 offset1:227
    v_mfma_f32_16x16x32_bf16 v[32:35], v[128:131], a[80:83], v[32:35]
    ds_read_b128 a[116:119], v5 offset:3456
    v_mfma_f32_16x16x32_bf16 v[36:39], a[64:67], v[164:167], v[36:39]
    ds_read2_b32 a[104:105], v12 offset0:96 offset1:97
    v_mfma_f32_16x16x32_bf16 v[36:39], a[68:71], v[160:163], v[36:39]
    ds_read2_b32 a[106:107], v12 offset0:98 offset1:99
    v_mfma_f32_16x16x32_bf16 v[36:39], a[72:75], a[92:95], v[36:39]
    ds_read_b128 a[120:123], v5 offset:2944
    ds_read2_b32 a[108:109], v12 offset0:224 offset1:225
    v_mfma_f32_16x16x32_bf16 v[36:39], a[76:79], a[88:91], v[36:39]
    ds_read2_b32 a[110:111], v12 offset0:226 offset1:227
    v_mfma_f32_16x16x32_bf16 v[36:39], v[128:131], a[84:87], v[36:39]
    ds_read_b128 a[124:127], v5 offset:2432
    v_mfma_f32_16x16x32_bf16 v[36:39], v[132:135], a[80:83], v[36:39]
    ds_read2_b32 v[64:65], v13 offset0:96 offset1:97
    v_mfma_f32_16x16x32_bf16 v[40:43], a[64:67], v[168:171], v[40:43]
    ds_read2_b32 v[66:67], v13 offset0:98 offset1:99
    v_mfma_f32_16x16x32_bf16 v[40:43], a[68:71], v[164:167], v[40:43]
    ds_read_b128 v[96:99], v5 offset:1920
    ds_read2_b32 v[68:69], v13 offset0:224 offset1:225
    v_mfma_f32_16x16x32_bf16 v[40:43], a[72:75], v[160:163], v[40:43]
    ds_read2_b32 v[70:71], v13 offset0:226 offset1:227
    v_mfma_f32_16x16x32_bf16 v[40:43], a[76:79], a[92:95], v[40:43]
    ds_read_b128 v[100:103], v5 offset:1408
    v_mfma_f32_16x16x32_bf16 v[40:43], v[128:131], a[88:91], v[40:43]
    ds_read2_b32 v[72:73], v14 offset0:96 offset1:97
    v_mfma_f32_16x16x32_bf16 v[40:43], v[132:135], a[84:87], v[40:43]
    ds_read2_b32 v[74:75], v14 offset0:98 offset1:99
    v_mfma_f32_16x16x32_bf16 v[40:43], v[136:139], a[80:83], v[40:43]
    ds_read_b128 v[104:107], v5 offset:896
    ds_read2_b32 v[76:77], v14 offset0:224 offset1:225
    v_mfma_f32_16x16x32_bf16 v[44:47], a[64:67], v[172:175], v[44:47]
    ds_read2_b32 v[78:79], v14 offset0:226 offset1:227
    v_mfma_f32_16x16x32_bf16 v[44:47], a[68:71], v[168:171], v[44:47]
    ds_read_b128 v[108:111], v5 offset:384
    v_mfma_f32_16x16x32_bf16 v[44:47], a[72:75], v[164:167], v[44:47]
    v_mfma_f32_16x16x32_bf16 v[44:47], a[76:79], v[160:163], v[44:47]
    v_mfma_f32_16x16x32_bf16 v[44:47], v[128:131], a[92:95], v[44:47]
    v_mfma_f32_16x16x32_bf16 v[44:47], v[132:135], a[88:91], v[44:47]
    v_mfma_f32_16x16x32_bf16 v[44:47], v[136:139], a[84:87], v[44:47]
    v_mfma_f32_16x16x32_bf16 v[44:47], v[140:143], a[80:83], v[44:47]
    s_waitcnt lgkmcnt(0)
    v_mfma_f32_16x16x32_bf16 v[32:35], a[96:99], v[96:99], v[32:35]
    ds_read2_b32 a[128:129], v11 offset0:112 offset1:113
    v_mfma_f32_16x16x32_bf16 v[32:35], a[100:103], a[124:127], v[32:35]
    ds_read2_b32 a[130:131], v11 offset0:114 offset1:115
    v_mfma_f32_16x16x32_bf16 v[32:35], a[104:107], a[120:123], v[32:35]
    ds_read_b128 a[144:147], v5 offset:4032
    ds_read2_b32 a[132:133], v11 offset0:240 offset1:241
    v_mfma_f32_16x16x32_bf16 v[32:35], a[108:111], a[116:119], v[32:35]
    ds_read2_b32 a[134:135], v11 offset0:242 offset1:243
    v_mfma_f32_16x16x32_bf16 v[32:35], v[64:67], a[112:115], v[32:35]
    ds_read_b128 a[148:151], v5 offset:3520
    v_mfma_f32_16x16x32_bf16 v[36:39], a[96:99], v[100:103], v[36:39]
    ds_read2_b32 a[136:137], v12 offset0:112 offset1:113
    v_mfma_f32_16x16x32_bf16 v[36:39], a[100:103], v[96:99], v[36:39]
    ds_read2_b32 a[138:139], v12 offset0:114 offset1:115
    v_mfma_f32_16x16x32_bf16 v[36:39], a[104:107], a[124:127], v[36:39]
    ds_read_b128 a[152:155], v5 offset:3008
    ds_read2_b32 a[140:141], v12 offset0:240 offset1:241
    v_mfma_f32_16x16x32_bf16 v[36:39], a[108:111], a[120:123], v[36:39]
    ds_read2_b32 a[142:143], v12 offset0:242 offset1:243
    v_mfma_f32_16x16x32_bf16 v[36:39], v[64:67], a[116:119], v[36:39]
    ds_read_b128 a[156:159], v5 offset:2496
    v_mfma_f32_16x16x32_bf16 v[36:39], v[68:71], a[112:115], v[36:39]
    ds_read2_b32 v[128:129], v13 offset0:112 offset1:113
    v_mfma_f32_16x16x32_bf16 v[40:43], a[96:99], v[104:107], v[40:43]
    ds_read2_b32 v[130:131], v13 offset0:114 offset1:115
    v_mfma_f32_16x16x32_bf16 v[40:43], a[100:103], v[100:103], v[40:43]
    ds_read_b128 v[160:163], v5 offset:1984
    ds_read2_b32 v[132:133], v13 offset0:240 offset1:241
    v_mfma_f32_16x16x32_bf16 v[40:43], a[104:107], v[96:99], v[40:43]
    ds_read2_b32 v[134:135], v13 offset0:242 offset1:243
    v_mfma_f32_16x16x32_bf16 v[40:43], a[108:111], a[124:127], v[40:43]
    ds_read_b128 v[164:167], v5 offset:1472
    v_mfma_f32_16x16x32_bf16 v[40:43], v[64:67], a[120:123], v[40:43]
    ds_read2_b32 v[136:137], v14 offset0:112 offset1:113
    v_mfma_f32_16x16x32_bf16 v[40:43], v[68:71], a[116:119], v[40:43]
    ds_read2_b32 v[138:139], v14 offset0:114 offset1:115
    v_mfma_f32_16x16x32_bf16 v[40:43], v[72:75], a[112:115], v[40:43]
    ds_read_b128 v[168:171], v5 offset:960
    ds_read2_b32 v[140:141], v14 offset0:240 offset1:241
    v_mfma_f32_16x16x32_bf16 v[44:47], a[96:99], v[108:111], v[44:47]
    ds_read2_b32 v[142:143], v14 offset0:242 offset1:243
    v_mfma_f32_16x16x32_bf16 v[44:47], a[100:103], v[104:107], v[44:47]
    ds_read_b128 v[172:175], v5 offset:448
    v_mfma_f32_16x16x32_bf16 v[44:47], a[104:107], v[100:103], v[44:47]
    v_mfma_f32_16x16x32_bf16 v[44:47], a[108:111], v[96:99], v[44:47]
    v_mfma_f32_16x16x32_bf16 v[44:47], v[64:67], a[124:127], v[44:47]
    v_mfma_f32_16x16x32_bf16 v[44:47], v[68:71], a[120:123], v[44:47]
    v_mfma_f32_16x16x32_bf16 v[44:47], v[72:75], a[116:119], v[44:47]
    v_mfma_f32_16x16x32_bf16 v[44:47], v[76:79], a[112:115], v[44:47]
    s_waitcnt lgkmcnt(0)
    v_mfma_f32_16x16x32_bf16 v[44:47], a[128:131], v[172:175], v[44:47]
    s_waitcnt vmcnt(4)
    v_readfirstlane_b32 s31, v176
    v_mfma_f32_16x16x32_bf16 v[44:47], a[132:135], v[168:171], v[44:47]
    v_lshlrev_b32 v13, 2, v1
    v_add_u32 v13, 137728, v13
    v_mfma_f32_16x16x32_bf16 v[44:47], a[136:139], v[164:167], v[44:47]
    s_and_b32 s26, s18, 1
    s_lshl_b32 s30, s31, 16
    v_mfma_f32_16x16x32_bf16 v[44:47], a[140:143], v[160:163], v[44:47]
    s_and_b32 s31, s31, s27
    s_cmp_eq_u32 s26, 1
    v_mfma_f32_16x16x32_bf16 v[44:47], v[128:131], a[156:159], v[44:47]
    s_cselect_b32 s30, s31, s30
    v_lshlrev_b32 v14, 4, v1
    v_mfma_f32_16x16x32_bf16 v[44:47], v[132:135], a[152:155], v[44:47]
    s_mul_i32 s32, s2, 16384
    s_add_u32 s33, s32, 4096
    v_mfma_f32_16x16x32_bf16 v[44:47], v[136:139], a[148:151], v[44:47]
    s_add_u32 s34, s32, 8192
    s_add_u32 s35, s32, 12288
    v_mfma_f32_16x16x32_bf16 v[44:47], v[140:143], a[144:147], v[44:47]
    s_mov_b32 s24, 0x05040100
    s_mov_b32 s25, 0x07060302
    v_mfma_f32_16x16x32_bf16 v[40:43], a[128:131], v[168:171], v[40:43]
    v_fmac_f32 v36, s30, v232
    v_fmac_f32 v37, s30, v233
    v_mfma_f32_16x16x32_bf16 v[40:43], a[132:135], v[164:167], v[40:43]
    v_fmac_f32 v38, s30, v234
    v_fmac_f32 v39, s30, v235
    v_mfma_f32_16x16x32_bf16 v[40:43], a[136:139], v[160:163], v[40:43]
    v_fmac_f32 v32, s30, v228
    v_fmac_f32 v33, s30, v229
    v_mfma_f32_16x16x32_bf16 v[40:43], a[140:143], a[156:159], v[40:43]
    v_fmac_f32 v34, s30, v230
    v_fmac_f32 v35, s30, v231
    v_mfma_f32_16x16x32_bf16 v[40:43], v[128:131], a[152:155], v[40:43]
    v_fmac_f32 v28, s30, v224
    v_fmac_f32 v29, s30, v225
    v_mfma_f32_16x16x32_bf16 v[40:43], v[132:135], a[148:151], v[40:43]
    v_fmac_f32 v30, s30, v226
    v_fmac_f32 v31, s30, v227
    v_mfma_f32_16x16x32_bf16 v[40:43], v[136:139], a[144:147], v[40:43]
    buffer_load_dwordx2 a[224:225], v2, s[64:67], s68 offen offset:0
    v_mfma_f32_16x16x32_bf16 v[36:39], a[128:131], v[164:167], v[36:39]
    v_fmac_f32 v44, s30, v240
    v_fmac_f32 v45, s30, v241
    v_mfma_f32_16x16x32_bf16 v[36:39], a[132:135], v[160:163], v[36:39]
    v_fmac_f32 v46, s30, v242
    v_fmac_f32 v47, s30, v243
    v_mfma_f32_16x16x32_bf16 v[36:39], a[136:139], a[156:159], v[36:39]
    v_cvt_pk_bf16_f32 v62, v44, v45
    v_cvt_pk_bf16_f32 v63, v46, v47
    v_mfma_f32_16x16x32_bf16 v[36:39], a[140:143], a[152:155], v[36:39]
    ds_write_b64 v3, v[62:63] offset:3584
    v_mfma_f32_16x16x32_bf16 v[36:39], v[128:131], a[148:151], v[36:39]
    v_fmac_f32 v24, s30, v220
    v_fmac_f32 v25, s30, v221
    v_mfma_f32_16x16x32_bf16 v[36:39], v[132:135], a[144:147], v[36:39]
    v_fmac_f32 v26, s30, v222
    v_fmac_f32 v27, s30, v223
    v_mfma_f32_16x16x32_bf16 v[32:35], a[128:131], v[160:163], v[32:35]
    buffer_load_dwordx2 a[226:227], v2, s[64:67], s68 offen offset:32
    v_mfma_f32_16x16x32_bf16 v[32:35], a[132:135], a[156:159], v[32:35]
    v_fmac_f32 v40, s30, v236
    v_fmac_f32 v41, s30, v237
    v_mfma_f32_16x16x32_bf16 v[32:35], a[136:139], a[152:155], v[32:35]
    v_fmac_f32 v42, s30, v238
    v_fmac_f32 v43, s30, v239
    v_mfma_f32_16x16x32_bf16 v[32:35], a[140:143], a[148:151], v[32:35]
    v_cvt_pk_bf16_f32 v60, v40, v41
    v_cvt_pk_bf16_f32 v61, v42, v43
    v_mfma_f32_16x16x32_bf16 v[32:35], v[128:131], a[144:147], v[32:35]
    ds_write_b64 v3, v[60:61] offset:3072
    v_mfma_f32_16x16x32_bf16 v[28:31], a[0:3], a[28:31], v[28:31]
    v_fmac_f32 v20, s30, v216
    v_fmac_f32 v21, s30, v217
    v_mfma_f32_16x16x32_bf16 v[28:31], a[4:7], a[24:27], v[28:31]
    v_fmac_f32 v22, s30, v218
    v_fmac_f32 v23, s30, v219
    v_mfma_f32_16x16x32_bf16 v[28:31], a[8:11], a[20:23], v[28:31]
    v_cvt_pk_bf16_f32 v58, v36, v37
    v_cvt_pk_bf16_f32 v59, v38, v39
    v_mfma_f32_16x16x32_bf16 v[28:31], a[12:15], a[16:19], v[28:31]
    ds_write_b64 v3, v[58:59] offset:2560
    v_mfma_f32_16x16x32_bf16 v[28:31], a[32:35], a[60:63], v[28:31]
    buffer_load_dwordx2 a[228:229], v2, s[64:67], s68 offen offset:128
    v_mfma_f32_16x16x32_bf16 v[28:31], a[36:39], a[56:59], v[28:31]
    v_fmac_f32 v16, s30, v212
    v_fmac_f32 v17, s30, v213
    v_mfma_f32_16x16x32_bf16 v[28:31], a[40:43], a[52:55], v[28:31]
    v_fmac_f32 v18, s30, v214
    v_fmac_f32 v19, s30, v215
    v_mfma_f32_16x16x32_bf16 v[28:31], a[44:47], a[48:51], v[28:31]
    v_cvt_pk_bf16_f32 v56, v32, v33
    v_cvt_pk_bf16_f32 v57, v34, v35
    v_mfma_f32_16x16x32_bf16 v[28:31], a[64:67], a[92:95], v[28:31]
    ds_write_b64 v3, v[56:57] offset:2048
    v_mfma_f32_16x16x32_bf16 v[28:31], a[68:71], a[88:91], v[28:31]
    buffer_load_dwordx2 a[230:231], v2, s[64:67], s68 offen offset:160
    v_mfma_f32_16x16x32_bf16 v[28:31], a[72:75], a[84:87], v[28:31]
    buffer_load_dwordx2 a[232:233], v2, s[64:67], s68 offen offset:256
    v_mfma_f32_16x16x32_bf16 v[28:31], a[76:79], a[80:83], v[28:31]
    buffer_load_dwordx2 a[234:235], v2, s[64:67], s68 offen offset:288
    v_mfma_f32_16x16x32_bf16 v[28:31], a[96:99], a[124:127], v[28:31]
    buffer_load_dwordx2 a[236:237], v2, s[64:67], s68 offen offset:384
    v_mfma_f32_16x16x32_bf16 v[28:31], a[100:103], a[120:123], v[28:31]
    s_waitcnt lgkmcnt(0)
    s_barrier
    v_mfma_f32_16x16x32_bf16 v[28:31], a[104:107], a[116:119], v[28:31]
    ds_read_b32 v72, v13 offset:2048
    v_mfma_f32_16x16x32_bf16 v[28:31], a[108:111], a[112:115], v[28:31]
    ds_read_b32 v73, v13 offset:6144
    v_mfma_f32_16x16x32_bf16 v[28:31], a[128:131], a[156:159], v[28:31]
    ds_read_b32 v74, v13 offset:10240
    v_mfma_f32_16x16x32_bf16 v[28:31], a[132:135], a[152:155], v[28:31]
    ds_read_b32 v75, v13 offset:14336
    v_mfma_f32_16x16x32_bf16 v[28:31], a[136:139], a[148:151], v[28:31]
    ds_read_b32 v76, v13 offset:3072
    v_mfma_f32_16x16x32_bf16 v[28:31], a[140:143], a[144:147], v[28:31]
    ds_read_b32 v77, v13 offset:7168
    v_mfma_f32_16x16x32_bf16 v[24:27], a[0:3], a[24:27], v[24:27]
    ds_read_b32 v78, v13 offset:11264
    v_mfma_f32_16x16x32_bf16 v[24:27], a[4:7], a[20:23], v[24:27]
    ds_read_b32 v79, v13 offset:15360
    v_mfma_f32_16x16x32_bf16 v[24:27], a[8:11], a[16:19], v[24:27]
    buffer_load_dwordx2 a[238:239], v2, s[64:67], s68 offen offset:416
    v_mfma_f32_16x16x32_bf16 v[24:27], a[32:35], a[56:59], v[24:27]
    v_mfma_f32_16x16x32_bf16 v[24:27], a[36:39], a[52:55], v[24:27]
    v_mfma_f32_16x16x32_bf16 v[24:27], a[40:43], a[48:51], v[24:27]
    v_mfma_f32_16x16x32_bf16 v[24:27], a[64:67], a[88:91], v[24:27]
    v_mfma_f32_16x16x32_bf16 v[24:27], a[68:71], a[84:87], v[24:27]
    v_cvt_pk_bf16_f32 v54, v28, v29
    v_cvt_pk_bf16_f32 v55, v30, v31
    v_mfma_f32_16x16x32_bf16 v[24:27], a[72:75], a[80:83], v[24:27]
    ds_write_b64 v3, v[54:55] offset:1536
    v_mfma_f32_16x16x32_bf16 v[24:27], a[96:99], a[120:123], v[24:27]
    s_waitcnt lgkmcnt(1)
    v_mfma_f32_16x16x32_bf16 v[24:27], a[100:103], a[116:119], v[24:27]
    v_perm_b32 v88, v73, v72, s24
    v_perm_b32 v89, v75, v74, s24
    v_mfma_f32_16x16x32_bf16 v[24:27], a[104:107], a[112:115], v[24:27]
    v_perm_b32 v90, v73, v72, s25
    v_perm_b32 v91, v75, v74, s25
    v_mfma_f32_16x16x32_bf16 v[24:27], a[128:131], a[152:155], v[24:27]
    buffer_store_dwordx4 v[88:91], v14, s[36:39], s34 offen sc1
    v_mfma_f32_16x16x32_bf16 v[24:27], a[132:135], a[148:151], v[24:27]
    v_mfma_f32_16x16x32_bf16 v[24:27], a[136:139], a[144:147], v[24:27]
    v_perm_b32 v92, v77, v76, s24
    v_perm_b32 v93, v79, v78, s24
    v_mfma_f32_16x16x32_bf16 v[20:23], a[0:3], a[20:23], v[20:23]
    v_perm_b32 v94, v77, v76, s25
    v_perm_b32 v95, v79, v78, s25
    v_mfma_f32_16x16x32_bf16 v[20:23], a[4:7], a[16:19], v[20:23]
    buffer_store_dwordx4 v[92:95], v14, s[36:39], s35 offen sc1
    v_mfma_f32_16x16x32_bf16 v[20:23], a[32:35], a[52:55], v[20:23]
    v_mfma_f32_16x16x32_bf16 v[20:23], a[36:39], a[48:51], v[20:23]
    v_mfma_f32_16x16x32_bf16 v[20:23], a[64:67], a[84:87], v[20:23]
    v_mfma_f32_16x16x32_bf16 v[20:23], a[68:71], a[80:83], v[20:23]
    v_mfma_f32_16x16x32_bf16 v[20:23], a[96:99], a[116:119], v[20:23]
    v_mfma_f32_16x16x32_bf16 v[20:23], a[100:103], a[112:115], v[20:23]
    v_cvt_pk_bf16_f32 v52, v24, v25
    v_cvt_pk_bf16_f32 v53, v26, v27
    v_mfma_f32_16x16x32_bf16 v[20:23], a[128:131], a[148:151], v[20:23]
    ds_write_b64 v3, v[52:53] offset:1024
    v_mfma_f32_16x16x32_bf16 v[20:23], a[132:135], a[144:147], v[20:23]
    v_mfma_f32_16x16x32_bf16 v[16:19], a[0:3], a[16:19], v[16:19]
    v_mfma_f32_16x16x32_bf16 v[16:19], a[32:35], a[48:51], v[16:19]
    v_mfma_f32_16x16x32_bf16 v[16:19], a[64:67], a[80:83], v[16:19]
    v_mfma_f32_16x16x32_bf16 v[16:19], a[96:99], a[112:115], v[16:19]
    v_mfma_f32_16x16x32_bf16 v[16:19], a[128:131], a[144:147], v[16:19]
    s_nop 2
    v_cvt_pk_bf16_f32 v50, v20, v21
    v_cvt_pk_bf16_f32 v51, v22, v23
    ds_write_b64 v3, v[50:51] offset:512
    s_nop 1
    v_cvt_pk_bf16_f32 v48, v16, v17
    v_cvt_pk_bf16_f32 v49, v18, v19
    ds_write_b64 v3, v[48:49] offset:0
    s_waitcnt lgkmcnt(0)
    s_barrier
    ds_read_b32 v64, v13 offset:0
    ds_read_b32 v65, v13 offset:4096
    ds_read_b32 v66, v13 offset:8192
    ds_read_b32 v67, v13 offset:12288
    ds_read_b32 v68, v13 offset:1024
    ds_read_b32 v69, v13 offset:5120
    ds_read_b32 v70, v13 offset:9216
    ds_read_b32 v71, v13 offset:13312
    s_waitcnt lgkmcnt(4)
    v_perm_b32 v80, v65, v64, s24
    v_perm_b32 v81, v67, v66, s24
    v_perm_b32 v82, v65, v64, s25
    v_perm_b32 v83, v67, v66, s25
    buffer_store_dwordx4 v[80:83], v14, s[36:39], s32 offen sc1
    s_waitcnt lgkmcnt(0)
    v_perm_b32 v84, v69, v68, s24
    v_perm_b32 v85, v71, v70, s24
    v_perm_b32 v86, v69, v68, s25
    v_perm_b32 v87, v71, v70, s25
    buffer_store_dwordx4 v[84:87], v14, s[36:39], s33 offen sc1
    s_waitcnt vmcnt(4)
    s_mov_b32 s96, 0
Lln1:
    s_and_b32 s32, s2, 7
    s_lshl_b32 s32, s32, 5
    s_lshr_b32 s33, s2, 3
    s_add_u32 s32, s32, s33
    v_and_b32 v1, 7, v0
    v_bfe_u32 v2, v0, 3, 1
    v_lshrrev_b32 v3, 4, v0
    v_lshlrev_b32 v4, 12, v2
    v_lshl_add_u32 v4, v3, 8, v4
    v_lshl_add_u32 v4, v1, 4, v4
    v_lshl_add_u32 v5, v2, 3, v3
    s_mov_b32 s24, 16384
    v_mul_u32_u24 v5, s24, v5
    v_lshl_add_u32 v5, v1, 3, v5
    v_mov_b32 v147, v5
    s_lshr_b32 s60, s32, 3
    s_lshl_b32 s60, s60, 17
    s_bfe_u32 s26, s32, 0x20001
    s_lshl_b32 s26, s26, 10
    s_add_u32 s60, s60, s26
    s_and_b32 s26, s32, 1
    s_lshl_b32 s26, s26, 7
    s_add_u32 s60, s60, s26
    s_lshl_b32 s26, s3, 15
    s_add_u32 s60, s60, s26
    s_add_u32 s61, s60, 8192
    s_add_u32 s62, s60, 16384
    s_add_u32 s63, s60, 24576
    s_mul_i32 s64, s3, 1048576
    s_lshl_b32 s26, s32, 6
    s_add_u32 s64, s64, s26
    s_add_u32 s65, s64, 65536
    s_add_u32 s66, s64, 262144
    s_add_u32 s67, s64, 327680
    s_add_u32 s68, s64, 524288
    s_add_u32 s69, s64, 589824
    s_add_u32 s70, s64, 786432
    s_add_u32 s71, s64, 851968
    s_load_dwordx2 s[76:77], s[0:1], 88
    s_mov_b32 s8, s16
    s_mov_b32 s9, s17
    s_mov_b32 s10, 4194304
    s_mov_b32 s11, 0x20000
    s_add_u32 s20, s16, 8388608
    s_addc_u32 s21, s17, 0
    s_mov_b32 s22, 4194304
    s_mov_b32 s23, 0x20000
    v_lshrrev_b32 v7, 4, v0
    v_bfe_u32 v8, v0, 2, 2
    v_cmp_eq_u32 vcc, v7, v8
    v_and_b32 v7, 1, v0
    v_lshlrev_b32 v7, 4, v7
    v_mov_b32 v9, 0x3f80
    v_lshlrev_b32 v7, v7, v9
    v_cndmask_b32 v7, 0, v7, vcc
    v_and_b32 v8, 2, v0
    v_cmp_eq_u32 vcc, 0, v8
    v_mov_b32 v12, 0
    v_mov_b32 v13, 0
    v_cndmask_b32 v10, 0, v7, vcc
    v_cndmask_b32 v11, v7, v12, vcc
    v_mov_b32 v14, v10
    v_mov_b32 v15, v11
    v_lshlrev_b32 v6, 5, v1
    v_add_u32 v6, 154112, v6
    s_lshl_b32 s26, s3, 3
    v_add_u32 v5, s26, v6
    s_mov_b32 s27, 0xffff0000
    s_lshr_b32 s90, s2, 5
    s_lshl_b32 s90, s90, 7
    s_add_u32 s90, s90, 28639232
    s_add_u32 s88, s16, s90
    s_addc_u32 s89, s17, 0
    s_cmp_eq_u32 s3, 0
    s_cselect_b32 s90, 31752, 0
    s_mov_b32 s91, 0x20000
    v_mov_b32 v144, s100
    v_mov_b32 v145, s101
    v_lshlrev_b32 v146, 10, v0
    s_waitcnt vmcnt(0)
    s_barrier
    buffer_atomic_add_x2 v[144:145], v146, s[88:91], 0 offen sc1
    s_add_u32 m0, s94, 0
    s_nop 0
    buffer_load_dwordx4 v200, s[72:75], s95 offen offset:0 lds
    buffer_load_dwordx4 v201, s[72:75], s95 offen offset:1024 lds
    buffer_load_dwordx4 v202, s[72:75], s95 offen offset:2048 lds
    buffer_load_dwordx4 v203, s[72:75], s95 offen offset:3072 lds
    s_add_u32 m0, s94, 4096
    s_nop 0
    buffer_load_dwordx4 v204, s[72:75], s95 offen offset:0 lds
    buffer_load_dwordx4 v205, s[72:75], s95 offen offset:1024 lds
    buffer_load_dwordx4 v206, s[72:75], s95 offen offset:2048 lds
    s_add_u32 s95, s95, 458752
    v_mfma_f32_16x16x32_bf16 v[80:83], v[10:13], a[224:227], 0
    v_mfma_f32_16x16x32_bf16 v[84:87], v[12:15], a[224:227], 0
    v_mfma_f32_16x16x32_bf16 v[88:91], v[10:13], a[228:231], 0
    v_mfma_f32_16x16x32_bf16 v[92:95], v[12:15], a[228:231], 0
    v_mfma_f32_16x16x32_bf16 v[96:99], v[10:13], a[232:235], 0
    v_mfma_f32_16x16x32_bf16 v[100:103], v[12:15], a[232:235], 0
    v_mfma_f32_16x16x32_bf16 v[104:107], v[10:13], a[236:239], 0
    v_mfma_f32_16x16x32_bf16 v[108:111], v[12:15], a[236:239], 0
    s_nop 1
    v_pk_add_f32 v[2:3], v[80:81], v[82:83]
    v_pk_mul_f32 v[8:9], v[80:81], v[80:81]
    v_pk_fma_f32 v[8:9], v[82:83], v[82:83], v[8:9]
    v_pk_add_f32 v[2:3], v[2:3], v[84:85]
    v_pk_fma_f32 v[8:9], v[84:85], v[84:85], v[8:9]
    v_pk_add_f32 v[2:3], v[2:3], v[86:87]
    v_pk_fma_f32 v[8:9], v[86:87], v[86:87], v[8:9]
    v_pk_add_f32 v[2:3], v[2:3], v[88:89]
    v_pk_fma_f32 v[8:9], v[88:89], v[88:89], v[8:9]
    v_pk_add_f32 v[2:3], v[2:3], v[90:91]
    v_pk_fma_f32 v[8:9], v[90:91], v[90:91], v[8:9]
    v_pk_add_f32 v[2:3], v[2:3], v[92:93]
    v_pk_fma_f32 v[8:9], v[92:93], v[92:93], v[8:9]
    v_pk_add_f32 v[2:3], v[2:3], v[94:95]
    v_pk_fma_f32 v[8:9], v[94:95], v[94:95], v[8:9]
    v_pk_add_f32 v[2:3], v[2:3], v[96:97]
    v_pk_fma_f32 v[8:9], v[96:97], v[96:97], v[8:9]
    v_pk_add_f32 v[2:3], v[2:3], v[98:99]
    v_pk_fma_f32 v[8:9], v[98:99], v[98:99], v[8:9]
    v_pk_add_f32 v[2:3], v[2:3], v[100:101]
    v_pk_fma_f32 v[8:9], v[100:101], v[100:101], v[8:9]
    v_pk_add_f32 v[2:3], v[2:3], v[102:103]
    v_pk_fma_f32 v[8:9], v[102:103], v[102:103], v[8:9]
    v_pk_add_f32 v[2:3], v[2:3], v[104:105]
    v_pk_fma_f32 v[8:9], v[104:105], v[104:105], v[8:9]
    v_pk_add_f32 v[2:3], v[2:3], v[106:107]
    v_pk_fma_f32 v[8:9], v[106:107], v[106:107], v[8:9]
    v_pk_add_f32 v[2:3], v[2:3], v[108:109]
    v_pk_fma_f32 v[8:9], v[108:109], v[108:109], v[8:9]
    v_pk_add_f32 v[2:3], v[2:3], v[110:111]
    v_pk_fma_f32 v[8:9], v[110:111], v[110:111], v[8:9]
    v_add_f32 v2, v2, v3
    v_add_f32 v3, v8, v9
    s_nop 0
    v_add_f32_dpp v2, v2, v2 row_ror:8 row_mask:0xf bank_mask:0xf
    v_add_f32_dpp v3, v3, v3 row_ror:8 row_mask:0xf bank_mask:0xf
    v_mov_b32 v8, v2
    v_mov_b32 v9, v3
    s_nop 0
    v_permlane16_swap_b32 v2, v8
    v_permlane16_swap_b32 v3, v9
    s_nop 0
    v_pk_add_f32 v[2:3], v[2:3], v[8:9]
    v_mov_b32 v8, v2
    v_mov_b32 v9, v3
    s_nop 0
    v_permlane32_swap_b32 v2, v8
    v_permlane32_swap_b32 v3, v9
    s_nop 0
    v_pk_add_f32 v[2:3], v[2:3], v[8:9]
    ds_write_b64 v5, v[2:3] offset:0
    s_waitcnt lgkmcnt(0)
    s_barrier
    ds_read_b128 v[32:35], v6 offset:0
    ds_read_b128 v[36:39], v6 offset:16
    s_waitcnt lgkmcnt(0)
    v_pk_add_f32 v[2:3], v[32:33], v[34:35]
    v_pk_add_f32 v[8:9], v[36:37], v[38:39]
    v_pk_add_f32 v[2:3], v[2:3], v[8:9]
    v_mul_f32 v8, 0xba800000, v2
    v_mul_f32 v3, 0x3a800000, v3
    v_fma_f32 v3, -v8, v8, v3
    v_max_f32 v3, 0, v3
    v_cvt_pk_bf16_f32 v3, v3, v3
    v_and_b32 v3, s27, v3
    v_add_f32 v3, 0x3727c5ac, v3
    v_cvt_pk_bf16_f32 v3, v3, v3
    v_and_b32 v3, s27, v3
    v_sqrt_f32 v3, v3
    v_cvt_pk_bf16_f32 v8, v8, v8
    v_and_b32 v8, s27, v8
    v_cvt_pk_bf16_f32 v3, v3, v3
    v_and_b32 v3, s27, v3
    v_rcp_f32 v2, v3
    s_nop 0
    v_mov_b32 v3, v2
    v_mul_f32 v8, v8, v2
    v_mov_b32 v9, v8
    v_pk_fma_f32 v[32:33], v[80:81], v[2:3], v[8:9]
    v_pk_fma_f32 v[34:35], v[82:83], v[2:3], v[8:9]
    v_pk_fma_f32 v[36:37], v[84:85], v[2:3], v[8:9]
    v_pk_fma_f32 v[38:39], v[86:87], v[2:3], v[8:9]
    v_pk_fma_f32 v[40:41], v[88:89], v[2:3], v[8:9]
    v_pk_fma_f32 v[42:43], v[90:91], v[2:3], v[8:9]
    v_pk_fma_f32 v[44:45], v[92:93], v[2:3], v[8:9]
    v_pk_fma_f32 v[46:47], v[94:95], v[2:3], v[8:9]
    v_pk_fma_f32 v[48:49], v[96:97], v[2:3], v[8:9]
    v_pk_fma_f32 v[50:51], v[98:99], v[2:3], v[8:9]
    v_pk_fma_f32 v[52:53], v[100:101], v[2:3], v[8:9]
    v_pk_fma_f32 v[54:55], v[102:103], v[2:3], v[8:9]
    v_pk_fma_f32 v[56:57], v[104:105], v[2:3], v[8:9]
    v_pk_fma_f32 v[58:59], v[106:107], v[2:3], v[8:9]
    v_pk_fma_f32 v[60:61], v[108:109], v[2:3], v[8:9]
    v_pk_fma_f32 v[62:63], v[110:111], v[2:3], v[8:9]
    s_and_b32 s90, s2, 31
    s_lshl_b32 s90, s90, 2
    s_add_u32 s90, s90, s3
    s_lshl_b32 s90, s90, 8
    s_add_u32 s90, s90, 28639232
    s_add_u32 s88, s16, s90
    s_addc_u32 s89, s17, 0
    s_movk_i32 s90, 256
    s_mov_b32 s91, 0x20000
    v_lshlrev_b32 v146, 7, v0
    s_mov_b32 s92, 1048576
    s_lshl_b64 s[28:29], s[100:101], 5
    s_mov_b64 exec, 3
Lyw_poll:
    v_mov_b64 v[144:145], 0
    buffer_atomic_or_x2 v[144:145], v146, s[88:91], 0 offen sc0 sc1
    s_sub_u32 s92, s92, 1
    s_cbranch_scc1 Lyw_join
    s_waitcnt vmcnt(0)
    v_cmp_ne_u64 vcc, s[28:29], v[144:145]
    s_nop 1
    s_cmp_lg_u64 vcc, 0
    s_cbranch_scc1 Lyw_poll
Lyw_join:
    s_mov_b64 exec, -1
    buffer_load_dwordx2 a[208:209], v147, s[8:11], s64 offen sc1
    buffer_load_dwordx2 a[210:211], v147, s[8:11], s65 offen sc1
    buffer_load_dwordx2 a[212:213], v147, s[8:11], s66 offen sc1
    buffer_load_dwordx2 a[214:215], v147, s[8:11], s67 offen sc1
    buffer_load_dwordx2 a[216:217], v147, s[8:11], s68 offen sc1
    buffer_load_dwordx2 a[218:219], v147, s[8:11], s69 offen sc1
    buffer_load_dwordx2 a[220:221], v147, s[8:11], s70 offen sc1
    buffer_load_dwordx2 a[222:223], v147, s[8:11], s71 offen sc1
    s_waitcnt vmcnt(6)
    v_mfma_f32_16x16x32_bf16 v[112:115], v[10:13], a[208:211], 0
    v_mfma_f32_16x16x32_bf16 v[116:119], v[12:15], a[208:211], 0
    s_waitcnt vmcnt(4)
    v_mfma_f32_16x16x32_bf16 v[120:123], v[10:13], a[212:215], 0
    v_mfma_f32_16x16x32_bf16 v[124:127], v[12:15], a[212:215], 0
    s_waitcnt vmcnt(2)
    v_mfma_f32_16x16x32_bf16 v[128:131], v[10:13], a[216:219], 0
    v_mfma_f32_16x16x32_bf16 v[132:135], v[12:15], a[216:219], 0
    s_waitcnt vmcnt(0)
    v_mfma_f32_16x16x32_bf16 v[136:139], v[10:13], a[220:223], 0
    v_mfma_f32_16x16x32_bf16 v[140:143], v[12:15], a[220:223], 0
    s_nop 1
    s_add_u32 m0, s94, 28672
    s_nop 0
    buffer_load_dwordx4 v200, s[72:75], s95 offen offset:0 lds
    v_pk_fma_f32 v[80:81], v[32:33], v[112:113], v[80:81]
    v_pk_fma_f32 v[82:83], v[34:35], v[114:115], v[82:83]
    v_pk_fma_f32 v[84:85], v[36:37], v[116:117], v[84:85]
    v_pk_fma_f32 v[86:87], v[38:39], v[118:119], v[86:87]
    v_pk_fma_f32 v[88:89], v[40:41], v[120:121], v[88:89]
    v_pk_fma_f32 v[90:91], v[42:43], v[122:123], v[90:91]
    v_pk_fma_f32 v[92:93], v[44:45], v[124:125], v[92:93]
    v_pk_fma_f32 v[94:95], v[46:47], v[126:127], v[94:95]
    v_pk_fma_f32 v[96:97], v[48:49], v[128:129], v[96:97]
    v_pk_fma_f32 v[98:99], v[50:51], v[130:131], v[98:99]
    v_pk_fma_f32 v[100:101], v[52:53], v[132:133], v[100:101]
    v_pk_fma_f32 v[102:103], v[54:55], v[134:135], v[102:103]
    v_pk_fma_f32 v[104:105], v[56:57], v[136:137], v[104:105]
    v_pk_fma_f32 v[106:107], v[58:59], v[138:139], v[106:107]
    buffer_load_dwordx4 v201, s[72:75], s95 offen offset:1024 lds
    v_pk_fma_f32 v[108:109], v[60:61], v[140:141], v[108:109]
    v_pk_fma_f32 v[110:111], v[62:63], v[142:143], v[110:111]
    v_pk_add_f32 v[2:3], v[80:81], v[82:83]
    v_pk_mul_f32 v[8:9], v[80:81], v[80:81]
    v_pk_fma_f32 v[8:9], v[82:83], v[82:83], v[8:9]
    v_pk_add_f32 v[2:3], v[2:3], v[84:85]
    v_pk_fma_f32 v[8:9], v[84:85], v[84:85], v[8:9]
    v_pk_add_f32 v[2:3], v[2:3], v[86:87]
    v_pk_fma_f32 v[8:9], v[86:87], v[86:87], v[8:9]
    v_pk_add_f32 v[2:3], v[2:3], v[88:89]
    v_pk_fma_f32 v[8:9], v[88:89], v[88:89], v[8:9]
    v_pk_add_f32 v[2:3], v[2:3], v[90:91]
    v_pk_fma_f32 v[8:9], v[90:91], v[90:91], v[8:9]
    v_pk_add_f32 v[2:3], v[2:3], v[92:93]
    buffer_load_dwordx4 v202, s[72:75], s95 offen offset:2048 lds
    v_pk_fma_f32 v[8:9], v[92:93], v[92:93], v[8:9]
    v_pk_add_f32 v[2:3], v[2:3], v[94:95]
    v_pk_fma_f32 v[8:9], v[94:95], v[94:95], v[8:9]
    v_pk_add_f32 v[2:3], v[2:3], v[96:97]
    v_pk_fma_f32 v[8:9], v[96:97], v[96:97], v[8:9]
    v_pk_add_f32 v[2:3], v[2:3], v[98:99]
    v_pk_fma_f32 v[8:9], v[98:99], v[98:99], v[8:9]
    v_pk_add_f32 v[2:3], v[2:3], v[100:101]
    v_pk_fma_f32 v[8:9], v[100:101], v[100:101], v[8:9]
    v_pk_add_f32 v[2:3], v[2:3], v[102:103]
    v_pk_fma_f32 v[8:9], v[102:103], v[102:103], v[8:9]
    v_pk_add_f32 v[2:3], v[2:3], v[104:105]
    v_pk_fma_f32 v[8:9], v[104:105], v[104:105], v[8:9]
    v_pk_add_f32 v[2:3], v[2:3], v[106:107]
    buffer_load_dwordx4 v203, s[72:75], s95 offen offset:3072 lds
    v_pk_fma_f32 v[8:9], v[106:107], v[106:107], v[8:9]
    v_pk_add_f32 v[2:3], v[2:3], v[108:109]
    v_pk_fma_f32 v[8:9], v[108:109], v[108:109], v[8:9]
    v_pk_add_f32 v[2:3], v[2:3], v[110:111]
    v_pk_fma_f32 v[8:9], v[110:111], v[110:111], v[8:9]
    v_add_f32 v2, v2, v3
    v_add_f32 v3, v8, v9
    s_nop 0
    v_add_f32_dpp v2, v2, v2 row_ror:8 row_mask:0xf bank_mask:0xf
    v_add_f32_dpp v3, v3, v3 row_ror:8 row_mask:0xf bank_mask:0xf
    v_mov_b32 v8, v2
    v_mov_b32 v9, v3
    s_nop 0
    v_permlane16_swap_b32 v2, v8
    s_add_u32 m0, s94, 32768
    s_nop 0
    buffer_load_dwordx4 v204, s[72:75], s95 offen offset:0 lds
    v_permlane16_swap_b32 v3, v9
    s_nop 0
    v_pk_add_f32 v[2:3], v[2:3], v[8:9]
    v_mov_b32 v8, v2
    v_mov_b32 v9, v3
    s_nop 0
    v_permlane32_swap_b32 v2, v8
    v_permlane32_swap_b32 v3, v9
    s_nop 0
    v_pk_add_f32 v[2:3], v[2:3], v[8:9]
    ds_write_b64 v5, v[2:3] offset:256
    v_cvt_pk_bf16_f32 v16, v80, v81
    v_cvt_pk_bf16_f32 v17, v82, v83
    v_cvt_pk_bf16_f32 v18, v84, v85
    buffer_load_dwordx4 v205, s[72:75], s95 offen offset:1024 lds
    v_cvt_pk_bf16_f32 v19, v86, v87
    v_cvt_pk_bf16_f32 v20, v88, v89
    v_cvt_pk_bf16_f32 v21, v90, v91
    v_cvt_pk_bf16_f32 v22, v92, v93
    v_cvt_pk_bf16_f32 v23, v94, v95
    v_cvt_pk_bf16_f32 v24, v96, v97
    v_cvt_pk_bf16_f32 v25, v98, v99
    v_cvt_pk_bf16_f32 v26, v100, v101
    v_cvt_pk_bf16_f32 v27, v102, v103
    v_cvt_pk_bf16_f32 v28, v104, v105
    v_cvt_pk_bf16_f32 v29, v106, v107
    v_cvt_pk_bf16_f32 v30, v108, v109
    v_cvt_pk_bf16_f32 v31, v110, v111
    s_waitcnt lgkmcnt(0)
    buffer_load_dwordx4 v206, s[72:75], s95 offen offset:2048 lds
    s_add_u32 s95, s95, 458752
    s_barrier
    ds_read_b128 v[32:35], v6 offset:256
    ds_read_b128 v[36:39], v6 offset:272
    v_mfma_f32_16x16x32_bf16 v[80:83], v[10:13], v[16:19], 0
    v_mfma_f32_16x16x32_bf16 v[84:87], v[12:15], v[16:19], 0
    v_mfma_f32_16x16x32_bf16 v[88:91], v[10:13], v[20:23], 0
    v_mfma_f32_16x16x32_bf16 v[92:95], v[12:15], v[20:23], 0
    v_mfma_f32_16x16x32_bf16 v[96:99], v[10:13], v[24:27], 0
    v_mfma_f32_16x16x32_bf16 v[100:103], v[12:15], v[24:27], 0
    v_mfma_f32_16x16x32_bf16 v[104:107], v[10:13], v[28:31], 0
    v_mfma_f32_16x16x32_bf16 v[108:111], v[12:15], v[28:31], 0
    s_waitcnt lgkmcnt(0)
    v_add_f32 v2, v32, v34
    v_add_f32 v8, v36, v38
    v_add_f32 v3, v33, v35
    v_add_f32 v9, v37, v39
    v_add_f32 v2, v2, v8
    v_add_f32 v3, v3, v9
    v_mul_f32 v8, 0xba800000, v2
    v_mul_f32 v3, 0x3a800000, v3
    v_fma_f32 v3, -v8, v8, v3
    v_max_f32 v3, 0, v3
    v_cvt_pk_bf16_f32 v3, v3, v3
    v_and_b32 v3, s27, v3
    v_add_f32 v3, 0x3727c5ac, v3
    v_cvt_pk_bf16_f32 v3, v3, v3
    v_and_b32 v3, s27, v3
    v_sqrt_f32 v3, v3
    v_cvt_pk_bf16_f32 v8, v8, v8
    v_and_b32 v8, s27, v8
    v_cvt_pk_bf16_f32 v3, v3, v3
    v_and_b32 v3, s27, v3
    v_rcp_f32 v2, v3
    s_nop 0
    v_mov_b32 v3, v2
    v_mul_f32 v8, v8, v2
    v_mov_b32 v9, v8
    v_pk_fma_f32 v[80:81], v[80:81], v[2:3], v[8:9]
    v_pk_fma_f32 v[82:83], v[82:83], v[2:3], v[8:9]
    v_pk_fma_f32 v[84:85], v[84:85], v[2:3], v[8:9]
    v_pk_fma_f32 v[86:87], v[86:87], v[2:3], v[8:9]
    v_cvt_pk_bf16_f32 v64, v80, v81
    v_cvt_pk_bf16_f32 v65, v82, v83
    v_cvt_pk_bf16_f32 v66, v84, v85
    v_cvt_pk_bf16_f32 v67, v86, v87
    buffer_store_dwordx4 v[64:67], v4, s[20:23], s60 offen sc1
    v_pk_fma_f32 v[88:89], v[88:89], v[2:3], v[8:9]
    v_pk_fma_f32 v[90:91], v[90:91], v[2:3], v[8:9]
    v_pk_fma_f32 v[92:93], v[92:93], v[2:3], v[8:9]
    v_pk_fma_f32 v[94:95], v[94:95], v[2:3], v[8:9]
    v_cvt_pk_bf16_f32 v68, v88, v89
    v_cvt_pk_bf16_f32 v69, v90, v91
    v_cvt_pk_bf16_f32 v70, v92, v93
    v_cvt_pk_bf16_f32 v71, v94, v95
    buffer_store_dwordx4 v[68:71], v4, s[20:23], s61 offen sc1
    v_pk_fma_f32 v[96:97], v[96:97], v[2:3], v[8:9]
    v_pk_fma_f32 v[98:99], v[98:99], v[2:3], v[8:9]
    v_pk_fma_f32 v[100:101], v[100:101], v[2:3], v[8:9]
    v_pk_fma_f32 v[102:103], v[102:103], v[2:3], v[8:9]
    v_cvt_pk_bf16_f32 v72, v96, v97
    v_cvt_pk_bf16_f32 v73, v98, v99
    v_cvt_pk_bf16_f32 v74, v100, v101
    v_cvt_pk_bf16_f32 v75, v102, v103
    buffer_store_dwordx4 v[72:75], v4, s[20:23], s62 offen sc1
    v_pk_fma_f32 v[104:105], v[104:105], v[2:3], v[8:9]
    v_pk_fma_f32 v[106:107], v[106:107], v[2:3], v[8:9]
    v_pk_fma_f32 v[108:109], v[108:109], v[2:3], v[8:9]
    v_pk_fma_f32 v[110:111], v[110:111], v[2:3], v[8:9]
    v_cvt_pk_bf16_f32 v76, v104, v105
    v_cvt_pk_bf16_f32 v77, v106, v107
    v_cvt_pk_bf16_f32 v78, v108, v109
    v_cvt_pk_bf16_f32 v79, v110, v111
    buffer_store_dwordx4 v[76:79], v4, s[20:23], s63 offen sc1
    v_accvgpr_write_b32 a192, v16
    v_accvgpr_write_b32 a193, v17
    v_accvgpr_write_b32 a194, v18
    v_accvgpr_write_b32 a195, v19
    v_accvgpr_write_b32 a196, v20
    v_accvgpr_write_b32 a197, v21
    v_accvgpr_write_b32 a198, v22
    v_accvgpr_write_b32 a199, v23
    v_accvgpr_write_b32 a200, v24
    v_accvgpr_write_b32 a201, v25
    v_accvgpr_write_b32 a202, v26
    v_accvgpr_write_b32 a203, v27
    v_accvgpr_write_b32 a204, v28
    v_accvgpr_write_b32 a205, v29
    v_accvgpr_write_b32 a206, v30
    v_accvgpr_write_b32 a207, v31
    s_add_u32 s26, s2, s3
    s_cmp_eq_u32 s26, 0
    s_cselect_b32 s78, 8, 0
    s_mov_b32 s79, 0x20000
    v_lshlrev_b32 v146, 2, v0
    v_mov_b32 v145, 0
    buffer_store_dword v145, v146, s[76:79], 0 offen sc1
    v_add_u32 v17, s60, v4
    s_add_u32 s97, s32, 0
Lg1:
    s_load_dwordx2 s[68:69], s[0:1], 72
    s_and_b32 s18, s2, 7
    s_lshr_b32 s19, s2, 3
    s_and_b32 s20, s19, 7
    s_lshr_b32 s21, s19, 3
    s_lshl_b32 s22, s18, 2
    s_add_u32 s21, s21, s22
    v_lshlrev_b32 v1, 4, v0
    s_lshr_b32 s22, s3, 1
    s_mul_i32 s22, s22, 229376
    s_mul_i32 s23, s21, 224
    s_add_u32 s29, s22, s23
    s_movk_i32 s23, 4682
    s_movk_i32 s28, 6944
    v_mul_u32_u24 v24, s23, v0
    v_add_u32 v25, s29, v1
    v_add_u32 v26, 4096, v25
    v_lshrrev_b32 v27, 16, v24
    v_mad_u32_u24 v2, v27, s28, v25
    v_add_u32 v27, 299648, v24
    v_lshrrev_b32 v27, 16, v27
    v_mad_u32_u24 v3, v27, s28, v25
    v_add_u32 v27, 599296, v24
    v_lshrrev_b32 v27, 16, v27
    v_mad_u32_u24 v4, v27, s28, v25
    v_add_u32 v27, 898944, v24
    v_lshrrev_b32 v27, 16, v27
    v_mad_u32_u24 v5, v27, s28, v25
    v_add_u32 v27, 1198592, v24
    v_lshrrev_b32 v27, 16, v27
    v_mad_u32_u24 v6, v27, s28, v26
    v_add_u32 v27, 1498240, v24
    v_lshrrev_b32 v27, 16, v27
    v_mad_u32_u24 v7, v27, s28, v26
    v_add_u32 v27, 1797888, v24
    v_lshrrev_b32 v27, 16, v27
    v_mad_u32_u24 v8, v27, s28, v26
    s_lshl_b32 s22, s20, 2
    s_add_u32 s22, s22, s3
    s_mul_i32 s26, s3, 7168
    s_mul_i32 s67, s96, 57344
    s_add_u32 s66, s26, 57344
    s_sub_u32 s66, s66, s67
    s_add_u32 s26, s26, s67
    s_xor_b32 s65, s96, 1
    s_mul_i32 s25, s65, 917504
    s_mul_i32 s24, s96, 114688
    s_lshl_b32 s30, s22, 17
    s_mul_i32 s23, s96, 54525952
    s_add_u32 s30, s30, s23
    s_add_u32 s30, s30, 8388608
    s_and_b32 s23, s3, 1
    s_cmp_eq_u32 s23, 1
    s_cselect_b32 s8, s14, s12
    s_cselect_b32 s9, s15, s13
    s_mov_b32 s10, 7340032
    s_mov_b32 s11, 0x20000
    s_add_u32 s4, s16, s30
    s_addc_u32 s5, s17, 0
    s_mov_b32 s6, 131072
    s_mov_b32 s7, 0x20000
    v_lshrrev_b32 v24, 2, v0
    s_movk_i32 s23, 224
    v_mul_u32_u24 v24, s23, v24
    v_and_b32 v25, 3, v0
    v_lshl_add_u32 v24, v25, 3, v24
    s_and_b32 s31, s21, 1
    s_lshl_b32 s23, s31, 5
    v_add_u32 v9, s23, v24
    v_add_u32 v10, 57344, v9
    s_mul_i32 s23, s31, 192
    s_sub_u32 s23, 192, s23
    v_add_u32 v11, s23, v24
    v_add_u32 v12, 57344, v11
    v_add_u32 v9, s67, v9
    v_subrev_u32 v10, s67, v10
    v_add_u32 v11, s67, v11
    v_subrev_u32 v12, s67, v12
    s_mul_i32 s23, s96, 54525952
    s_add_u32 s23, s23, 12582912
    s_add_u32 s88, s16, s23
    s_addc_u32 s89, s17, 0
    s_mov_b32 s90, 14680064
    s_mov_b32 s91, 0x20000
    s_mov_b32 s92, 0xbdd2d3e8
    s_mov_b32 s93, 0xbdd2d3e8
    v_mov_b32 v22, 0xc0135761
    v_mov_b32 v23, 0xc0135761
    s_mul_i32 s30, s22, 458752
    s_mul_i32 s23, s21, 7
    s_lshr_b32 s23, s23, 1
    s_lshl_b32 s23, s23, 11
    s_add_u32 s30, s30, s23
    s_lshl_b32 s23, s31, 11
    s_add_u32 s32, s30, s23
    s_add_u32 s33, s32, 229376
    s_add_u32 s34, s32, 4096
    s_add_u32 s35, s33, 4096
    s_mul_i32 s23, s31, 6136
    s_sub_u32 s36, s30, s23
    s_add_u32 s36, s36, 6144
    s_add_u32 s37, s36, 229376
    s_lshl_b32 s23, s2, 2
    s_add_u32 s23, s23, s3
    s_lshr_b32 s30, s23, 3
    s_and_b32 s31, s23, 7
    s_lshl_b32 s79, s30, 16
    s_lshl_b32 s38, s31, 8
    s_add_u32 s79, s79, s38
    s_mul_i32 s31, s31, 112
    s_add_u32 s31, s31, s30
    s_lshl_b32 s76, s31, 13
    s_add_u32 s77, s76, 4096
    s_add_u32 s72, s16, 46137344
    s_addc_u32 s73, s17, 0
    s_mov_b32 s74, 0
    s_mov_b32 s75, 0x20000
    s_and_b32 s23, s2, 15
    s_lshl_b32 s23, s23, 7
    s_add_u32 s23, s23, 28385280
    s_add_u32 s80, s16, s23
    s_addc_u32 s81, s17, 0
    s_mov_b32 s82, 0
    s_mov_b32 s83, 0x20000
    s_cmp_eq_u32 s96, 0
    s_cselect_b32 s82, 4, 4
    s_cselect_b32 s23, 224, 0
    s_cmp_lt_u32 s2, s23
    s_cselect_b32 s70, 7340032, 0
    s_cselect_b32 s74, 7340032, 0
    s_mov_b32 s71, 0x20000
    s_mul_i32 s78, s3, 9504
    s_add_u32 s78, s78, 114688
    v_lshrrev_b32 v24, 4, v0
    v_lshlrev_b32 v24, 14, v24
    v_and_b32 v26, 15, v0
    v_lshl_add_u32 v13, v26, 4, v24
    v_bfe_u32 v24, v0, 2, 3
    s_movk_i32 s23, 1056
    v_mul_u32_u24 v24, s23, v24
    v_lshrrev_b32 v26, 5, v0
    v_lshl_add_u32 v24, v26, 8, v24
    v_lshl_add_u32 v24, v25, 3, v24
    v_add_u32 v14, s78, v24
    v_mov_b32 v16, 1
    s_movk_i32 s23, 9363
    v_mul_u32_u24 v24, s23, v0
    v_lshrrev_b32 v24, 16, v24
    s_mov_b32 s23, 457856
    v_mul_u32_u24 v24, s23, v24
    v_lshl_add_u32 v24, v0, 7, v24
    s_lshl_b32 s23, s19, 1
    s_lshr_b32 s30, s3, 1
    s_add_u32 s23, s23, s30
    s_mul_i32 s23, s23, 7168
    s_mul_i32 s30, s18, 896
    s_add_u32 s23, s23, s30
    v_cmp_gt_u32 vcc, 7, v0
    v_add_u32 v24, s23, v24
    v_bfrev_b32 v25, 1
    v_cndmask_b32 v15, v25, v24, vcc
    s_add_u32 s39, s25, 1376256
    s_getpc_b64 s[84:85]
Lpf2:
    s_add_u32 s84, s84, (Lg2m-Lpf2)&0xffffffff
    s_addc_u32 s85, s85, ((Lg2m-Lpf2)>>32)&0xffffffff
    s_lshr_b32 s86, s2, 3
    s_lshl_b32 s86, s86, 2
    s_add_u32 s86, s86, s3
    s_lshl_b32 s86, s86, 10
    v_lshrrev_b32 v19, 3, v0
    v_lshl_add_u32 v19, v19, 7, s86
    v_min_u32 v19, Lend-Lg2m-4, v19
    v_add_co_u32 v18, vcc, s84, v19
    v_mov_b32 v19, s85
    s_nop 0
    v_addc_co_u32 v19, vcc, 0, v19, vcc
    s_mul_i32 s23, s96, 768
    s_lshl_b32 s30, s20, 5
    s_add_u32 s23, s23, s30
    s_add_u32 s28, s16, 96468992
    s_addc_u32 s29, s17, 0
    s_mov_b32 s30, 4194304
    s_mov_b32 s31, 0x20000
    s_mul_i32 s30, s30, s96
    s_mov_b32 s38, 0
    s_waitcnt lgkmcnt(0)
    s_andn2_b32 s62, s97, 31
    s_lshl_b32 s62, s62, 7
    s_add_u32 s62, s62, 28442624
    s_add_u32 s60, s16, s62
    s_addc_u32 s61, s17, 0
    s_cmp_eq_u32 s3, 0
    s_cselect_b32 s62, 1024, 0
    s_mov_b32 s63, 0x20000
    v_mov_b32 v24, 1
    v_lshlrev_b32 v25, 7, v0
    s_waitcnt vmcnt(0)
    s_barrier
    buffer_atomic_add v24, v25, s[60:63], 0 offen sc1
    s_add_u32 m0, s66, 0
    s_nop 0
    buffer_load_dwordx4 v2, s[8:11], s25 offen offset:0 lds
    buffer_load_dwordx4 v3, s[8:11], s25 offen offset:1024 lds
    buffer_load_dwordx4 v4, s[8:11], s25 offen offset:2048 lds
    buffer_load_dwordx4 v5, s[8:11], s25 offen offset:3072 lds
    s_add_u32 m0, s66, 4096
    s_nop 0
    buffer_load_dwordx4 v6, s[8:11], s25 offen offset:0 lds
    buffer_load_dwordx4 v7, s[8:11], s25 offen offset:1024 lds
    buffer_load_dwordx4 v8, s[8:11], s25 offen offset:2048 lds
    s_add_u32 s25, s25, 458752
    ds_read_b64_tr_b16 a[0:1], v11 offset:0
    ds_read_b64_tr_b16 a[2:3], v11 offset:3584
    ds_read_b64_tr_b16 a[4:5], v11 offset:14336
    ds_read_b64_tr_b16 a[6:7], v11 offset:17920
    ds_read_b64_tr_b16 a[8:9], v11 offset:7168
    ds_read_b64_tr_b16 a[10:11], v11 offset:10752
    ds_read_b64_tr_b16 a[12:13], v11 offset:21504
    ds_read_b64_tr_b16 a[14:15], v11 offset:25088
    ds_read_b64_tr_b16 a[16:17], v9 offset:0
    ds_read_b64_tr_b16 a[18:19], v9 offset:3584
    ds_read_b64_tr_b16 a[20:21], v9 offset:14336
    ds_read_b64_tr_b16 a[22:23], v9 offset:17920
    ds_read_b64_tr_b16 a[24:25], v9 offset:7168
    ds_read_b64_tr_b16 a[26:27], v9 offset:10752
    ds_read_b64_tr_b16 a[28:29], v9 offset:21504
    ds_read_b64_tr_b16 a[30:31], v9 offset:25088
    ds_read_b64_tr_b16 a[32:33], v9 offset:32
    ds_read_b64_tr_b16 a[34:35], v9 offset:3616
    ds_read_b64_tr_b16 a[36:37], v9 offset:14368
    ds_read_b64_tr_b16 a[38:39], v9 offset:17952
    ds_read_b64_tr_b16 a[40:41], v9 offset:7200
    ds_read_b64_tr_b16 a[42:43], v9 offset:10784
    ds_read_b64_tr_b16 a[44:45], v9 offset:21536
    ds_read_b64_tr_b16 a[46:47], v9 offset:25120
    ds_read_b64_tr_b16 a[48:49], v9 offset:64
    ds_read_b64_tr_b16 a[50:51], v9 offset:3648
    ds_read_b64_tr_b16 a[52:53], v9 offset:14400
    ds_read_b64_tr_b16 a[54:55], v9 offset:17984
    s_cmp_lg_u32 s3, 0
    s_cbranch_scc1 Lw1_join
    s_and_b32 s62, s21, 7
    s_add_u32 s62, s62, s23
    s_lshl_b32 s62, s62, 7
    s_add_u32 s62, s62, 28442624
    s_add_u32 s60, s16, s62
    s_addc_u32 s61, s17, 0
    s_mov_b32 s62, 4
    s_mov_b32 s63, 0x20000
    v_lshlrev_b32 v24, 4, v0
    s_mov_b32 s64, 1048576
Lw1_poll:
    v_mov_b32 v25, 0
    buffer_atomic_or v25, v24, s[60:63], 0 offen sc0 sc1
    s_sub_u32 s64, s64, 1
    s_cbranch_scc1 Lw1_join
    s_waitcnt vmcnt(0)
    v_readfirstlane_b32 vcc_lo, v25
    s_nop 1
    s_cmp_lg_u32 vcc_lo, 32
    s_cbranch_scc1 Lw1_poll
Lw1_join:
    s_barrier
    buffer_load_dwordx4 a[56:59], v1, s[4:7], s24 offen offset:0 sc1
    buffer_load_dwordx4 a[60:63], v1, s[4:7], s24 offen offset:1024 sc1
    buffer_load_dwordx4 a[64:67], v1, s[4:7], s24 offen offset:2048 sc1
    buffer_load_dwordx4 a[68:71], v1, s[4:7], s24 offen offset:3072 sc1
    s_add_u32 s24, s24, 4096
    buffer_load_dwordx4 a[72:75], v1, s[4:7], s24 offen offset:0 sc1
    buffer_load_dwordx4 a[76:79], v1, s[4:7], s24 offen offset:1024 sc1
    buffer_load_dwordx4 a[80:83], v1, s[4:7], s24 offen offset:2048 sc1
    buffer_load_dwordx4 a[84:87], v1, s[4:7], s24 offen offset:3072 sc1
    s_add_u32 s24, s24, 4096
    buffer_load_dwordx4 a[88:91], v1, s[4:7], s24 offen offset:0 sc1
    buffer_load_dwordx4 a[92:95], v1, s[4:7], s24 offen offset:1024 sc1
    buffer_load_dwordx4 a[96:99], v1, s[4:7], s24 offen offset:2048 sc1
    buffer_load_dwordx4 a[100:103], v1, s[4:7], s24 offen offset:3072 sc1
    s_add_u32 s24, s24, 4096
    buffer_load_dwordx4 a[104:107], v1, s[4:7], s24 offen offset:0 sc1
    buffer_load_dwordx4 a[108:111], v1, s[4:7], s24 offen offset:1024 sc1
    buffer_load_dwordx4 a[112:115], v1, s[4:7], s24 offen offset:2048 sc1
    buffer_load_dwordx4 a[116:119], v1, s[4:7], s24 offen offset:3072 sc1
    s_add_u32 s24, s24, 4096
    s_and_b32 s24, s24, 0x1ffff
    s_waitcnt vmcnt(8) lgkmcnt(15)
    v_mfma_f32_16x16x32_bf16 v[32:35], a[0:3], a[56:59], 0
    v_mfma_f32_16x16x32_bf16 v[32:35], a[4:7], a[72:75], v[32:35]
    v_mfma_f32_16x16x32_bf16 v[36:39], a[4:7], a[76:79], 0
    buffer_load_dwordx4 a[120:123], v1, s[4:7], s24 offen offset:0 sc1
    v_mfma_f32_16x16x32_bf16 v[36:39], a[0:3], a[60:63], v[36:39]
    v_mfma_f32_16x16x32_bf16 v[40:43], a[0:3], a[64:67], 0
    v_mfma_f32_16x16x32_bf16 v[40:43], a[4:7], a[80:83], v[40:43]
    v_mfma_f32_16x16x32_bf16 v[44:47], a[4:7], a[84:87], 0
    v_mfma_f32_16x16x32_bf16 v[44:47], a[0:3], a[68:71], v[44:47]
    v_mfma_f32_16x16x32_bf16 v[60:63], a[8:11], a[68:71], 0
    ds_read_b64_tr_b16 a[0:1], v9 offset:7232
    v_mfma_f32_16x16x32_bf16 v[60:63], a[12:15], a[84:87], v[60:63]
    ds_read_b64_tr_b16 a[2:3], v9 offset:10816
    v_mfma_f32_16x16x32_bf16 v[56:59], a[12:15], a[80:83], 0
    ds_read_b64_tr_b16 a[4:5], v9 offset:21568
    v_mfma_f32_16x16x32_bf16 v[56:59], a[8:11], a[64:67], v[56:59]
    ds_read_b64_tr_b16 a[6:7], v9 offset:25152
    v_mfma_f32_16x16x32_bf16 v[52:55], a[8:11], a[60:63], 0
    buffer_load_dwordx4 a[124:127], v1, s[4:7], s24 offen offset:1024 sc1
    v_mfma_f32_16x16x32_bf16 v[52:55], a[12:15], a[76:79], v[52:55]
    v_mfma_f32_16x16x32_bf16 v[48:51], a[12:15], a[72:75], 0
    v_mfma_f32_16x16x32_bf16 v[48:51], a[8:11], a[56:59], v[48:51]
    v_mfma_f32_16x16x32_bf16 v[64:67], a[16:19], a[56:59], 0
    ds_read_b64_tr_b16 a[8:9], v9 offset:96
    v_mfma_f32_16x16x32_bf16 v[64:67], a[20:23], a[72:75], v[64:67]
    ds_read_b64_tr_b16 a[10:11], v9 offset:3680
    v_mfma_f32_16x16x32_bf16 v[68:71], a[20:23], a[76:79], 0
    ds_read_b64_tr_b16 a[12:13], v9 offset:14432
    v_mfma_f32_16x16x32_bf16 v[68:71], a[16:19], a[60:63], v[68:71]
    ds_read_b64_tr_b16 a[14:15], v9 offset:18016
    v_mfma_f32_16x16x32_bf16 v[72:75], a[16:19], a[64:67], 0
    buffer_load_dwordx4 a[128:131], v1, s[4:7], s24 offen offset:2048 sc1
    v_mfma_f32_16x16x32_bf16 v[72:75], a[20:23], a[80:83], v[72:75]
    v_mfma_f32_16x16x32_bf16 v[76:79], a[20:23], a[84:87], 0
    buffer_load_dwordx4 a[132:135], v1, s[4:7], s24 offen offset:3072 sc1
    s_add_u32 s24, s24, 4096
    v_mfma_f32_16x16x32_bf16 v[76:79], a[16:19], a[68:71], v[76:79]
    s_waitcnt lgkmcnt(15)
    v_mfma_f32_16x16x32_bf16 v[92:95], a[24:27], a[68:71], 0
    ds_read_b64_tr_b16 a[16:17], v9 offset:7264
    v_mfma_f32_16x16x32_bf16 v[92:95], a[28:31], a[84:87], v[92:95]
    ds_read_b64_tr_b16 a[18:19], v9 offset:10848
    v_mfma_f32_16x16x32_bf16 v[88:91], a[28:31], a[80:83], 0
    ds_read_b64_tr_b16 a[20:21], v9 offset:21600
    v_mfma_f32_16x16x32_bf16 v[88:91], a[24:27], a[64:67], v[88:91]
    ds_read_b64_tr_b16 a[22:23], v9 offset:25184
    v_mfma_f32_16x16x32_bf16 v[84:87], a[24:27], a[60:63], 0
    v_mfma_f32_16x16x32_bf16 v[84:87], a[28:31], a[76:79], v[84:87]
    buffer_load_dwordx4 a[136:139], v1, s[4:7], s24 offen offset:0 sc1
    v_mfma_f32_16x16x32_bf16 v[80:83], a[28:31], a[72:75], 0
    v_mfma_f32_16x16x32_bf16 v[80:83], a[24:27], a[56:59], v[80:83]
    v_mfma_f32_16x16x32_bf16 v[96:99], a[32:35], a[56:59], 0
    ds_read_b64_tr_b16 a[24:25], v9 offset:128
    v_mfma_f32_16x16x32_bf16 v[96:99], a[36:39], a[72:75], v[96:99]
    ds_read_b64_tr_b16 a[26:27], v9 offset:3712
    v_mfma_f32_16x16x32_bf16 v[100:103], a[36:39], a[76:79], 0
    ds_read_b64_tr_b16 a[28:29], v9 offset:14464
    v_mfma_f32_16x16x32_bf16 v[100:103], a[32:35], a[60:63], v[100:103]
    ds_read_b64_tr_b16 a[30:31], v9 offset:18048
    v_mfma_f32_16x16x32_bf16 v[104:107], a[32:35], a[64:67], 0
    buffer_load_dwordx4 a[140:143], v1, s[4:7], s24 offen offset:1024 sc1
    v_mfma_f32_16x16x32_bf16 v[104:107], a[36:39], a[80:83], v[104:107]
    v_mfma_f32_16x16x32_bf16 v[108:111], a[36:39], a[84:87], 0
    v_mfma_f32_16x16x32_bf16 v[108:111], a[32:35], a[68:71], v[108:111]
    s_waitcnt lgkmcnt(15)
    v_mfma_f32_16x16x32_bf16 v[124:127], a[40:43], a[68:71], 0
    ds_read_b64_tr_b16 a[32:33], v9 offset:7296
    v_mfma_f32_16x16x32_bf16 v[124:127], a[44:47], a[84:87], v[124:127]
    ds_read_b64_tr_b16 a[34:35], v9 offset:10880
    v_mfma_f32_16x16x32_bf16 v[120:123], a[44:47], a[80:83], 0
    ds_read_b64_tr_b16 a[36:37], v9 offset:21632
    v_mfma_f32_16x16x32_bf16 v[120:123], a[40:43], a[64:67], v[120:123]
    ds_read_b64_tr_b16 a[38:39], v9 offset:25216
    v_mfma_f32_16x16x32_bf16 v[116:119], a[40:43], a[60:63], 0
    buffer_load_dwordx4 a[144:147], v1, s[4:7], s24 offen offset:2048 sc1
    v_mfma_f32_16x16x32_bf16 v[116:119], a[44:47], a[76:79], v[116:119]
    v_mfma_f32_16x16x32_bf16 v[112:115], a[44:47], a[72:75], 0
    v_mfma_f32_16x16x32_bf16 v[112:115], a[40:43], a[56:59], v[112:115]
    v_mfma_f32_16x16x32_bf16 v[128:131], a[48:51], a[56:59], 0
    ds_read_b64_tr_b16 a[40:41], v9 offset:160
    v_mfma_f32_16x16x32_bf16 v[128:131], a[52:55], a[72:75], v[128:131]
    ds_read_b64_tr_b16 a[42:43], v9 offset:3744
    v_mfma_f32_16x16x32_bf16 v[132:135], a[52:55], a[76:79], 0
    ds_read_b64_tr_b16 a[44:45], v9 offset:14496
    v_mfma_f32_16x16x32_bf16 v[132:135], a[48:51], a[60:63], v[132:135]
    ds_read_b64_tr_b16 a[46:47], v9 offset:18080
    v_mfma_f32_16x16x32_bf16 v[136:139], a[48:51], a[64:67], 0
    buffer_load_dwordx4 a[148:151], v1, s[4:7], s24 offen offset:3072 sc1
    s_add_u32 s24, s24, 4096
    v_mfma_f32_16x16x32_bf16 v[136:139], a[52:55], a[80:83], v[136:139]
    v_mfma_f32_16x16x32_bf16 v[140:143], a[52:55], a[84:87], 0
    v_mfma_f32_16x16x32_bf16 v[140:143], a[48:51], a[68:71], v[140:143]
    s_add_u32 m0, s66, 28672
    s_waitcnt lgkmcnt(15)
    v_mfma_f32_16x16x32_bf16 v[156:159], a[0:3], a[68:71], 0
    ds_read_b64_tr_b16 a[48:49], v9 offset:7328
    v_mfma_f32_16x16x32_bf16 v[156:159], a[4:7], a[84:87], v[156:159]
    ds_read_b64_tr_b16 a[50:51], v9 offset:10912
    v_mfma_f32_16x16x32_bf16 v[152:155], a[4:7], a[80:83], 0
    ds_read_b64_tr_b16 a[52:53], v9 offset:21664
    v_mfma_f32_16x16x32_bf16 v[152:155], a[0:3], a[64:67], v[152:155]
    ds_read_b64_tr_b16 a[54:55], v9 offset:25248
    v_mfma_f32_16x16x32_bf16 v[148:151], a[0:3], a[60:63], 0
    buffer_load_dwordx4 v2, s[8:11], s25 offen offset:0 lds
    v_mfma_f32_16x16x32_bf16 v[148:151], a[4:7], a[76:79], v[148:151]
    v_mfma_f32_16x16x32_bf16 v[144:147], a[4:7], a[72:75], 0
    buffer_load_dwordx4 v3, s[8:11], s25 offen offset:1024 lds
    v_mfma_f32_16x16x32_bf16 v[144:147], a[0:3], a[56:59], v[144:147]
    v_mfma_f32_16x16x32_bf16 v[160:163], a[8:11], a[56:59], 0
    v_mfma_f32_16x16x32_bf16 v[160:163], a[12:15], a[72:75], v[160:163]
    v_mfma_f32_16x16x32_bf16 v[164:167], a[12:15], a[76:79], 0
    v_mfma_f32_16x16x32_bf16 v[164:167], a[8:11], a[60:63], v[164:167]
    s_waitcnt lgkmcnt(0)
    s_barrier
    v_mfma_f32_16x16x32_bf16 v[168:171], a[8:11], a[64:67], 0
    ds_read_b64_tr_b16 a[0:1], v11 offset:28672
    v_mfma_f32_16x16x32_bf16 v[168:171], a[12:15], a[80:83], v[168:171]
    ds_read_b64_tr_b16 a[2:3], v11 offset:32256
    v_mfma_f32_16x16x32_bf16 v[172:175], a[12:15], a[84:87], 0
    ds_read_b64_tr_b16 a[4:5], v11 offset:43008
    v_mfma_f32_16x16x32_bf16 v[172:175], a[8:11], a[68:71], v[172:175]
    ds_read_b64_tr_b16 a[6:7], v11 offset:46592
    v_mfma_f32_16x16x32_bf16 v[188:191], a[16:19], a[68:71], 0
    ds_read_b64_tr_b16 a[8:9], v11 offset:35840
    v_mfma_f32_16x16x32_bf16 v[188:191], a[20:23], a[84:87], v[188:191]
    ds_read_b64_tr_b16 a[10:11], v11 offset:39424
    v_mfma_f32_16x16x32_bf16 v[184:187], a[20:23], a[80:83], 0
    ds_read_b64_tr_b16 a[12:13], v11 offset:50176
    v_mfma_f32_16x16x32_bf16 v[184:187], a[16:19], a[64:67], v[184:187]
    ds_read_b64_tr_b16 a[14:15], v11 offset:53760
    v_mfma_f32_16x16x32_bf16 v[180:183], a[16:19], a[60:63], 0
    buffer_load_dwordx4 v4, s[8:11], s25 offen offset:2048 lds
    v_mfma_f32_16x16x32_bf16 v[180:183], a[20:23], a[76:79], v[180:183]
    v_mfma_f32_16x16x32_bf16 v[176:179], a[20:23], a[72:75], 0
    buffer_load_dwordx4 v5, s[8:11], s25 offen offset:3072 lds
    v_mfma_f32_16x16x32_bf16 v[176:179], a[16:19], a[56:59], v[176:179]
    v_mfma_f32_16x16x32_bf16 v[192:195], a[24:27], a[56:59], 0
    ds_read_b64_tr_b16 a[16:17], v9 offset:28672
    v_mfma_f32_16x16x32_bf16 v[192:195], a[28:31], a[72:75], v[192:195]
    ds_read_b64_tr_b16 a[18:19], v9 offset:32256
    v_mfma_f32_16x16x32_bf16 v[196:199], a[28:31], a[76:79], 0
    ds_read_b64_tr_b16 a[20:21], v9 offset:43008
    v_mfma_f32_16x16x32_bf16 v[196:199], a[24:27], a[60:63], v[196:199]
    ds_read_b64_tr_b16 a[22:23], v9 offset:46592
    v_mfma_f32_16x16x32_bf16 v[200:203], a[24:27], a[64:67], 0
    s_add_u32 m0, s66, 32768
    v_mfma_f32_16x16x32_bf16 v[200:203], a[28:31], a[80:83], v[200:203]
    buffer_load_dwordx4 v6, s[8:11], s25 offen offset:0 lds
    v_mfma_f32_16x16x32_bf16 v[204:207], a[28:31], a[84:87], 0
    v_mfma_f32_16x16x32_bf16 v[204:207], a[24:27], a[68:71], v[204:207]
    v_mfma_f32_16x16x32_bf16 v[220:223], a[32:35], a[68:71], 0
    ds_read_b64_tr_b16 a[24:25], v9 offset:35840
    v_mfma_f32_16x16x32_bf16 v[220:223], a[36:39], a[84:87], v[220:223]
    ds_read_b64_tr_b16 a[26:27], v9 offset:39424
    v_mfma_f32_16x16x32_bf16 v[216:219], a[36:39], a[80:83], 0
    ds_read_b64_tr_b16 a[28:29], v9 offset:50176
    v_mfma_f32_16x16x32_bf16 v[216:219], a[32:35], a[64:67], v[216:219]
    ds_read_b64_tr_b16 a[30:31], v9 offset:53760
    v_mfma_f32_16x16x32_bf16 v[212:215], a[32:35], a[60:63], 0
    buffer_load_dwordx4 v7, s[8:11], s25 offen offset:1024 lds
    v_mfma_f32_16x16x32_bf16 v[212:215], a[36:39], a[76:79], v[212:215]
    v_mfma_f32_16x16x32_bf16 v[208:211], a[36:39], a[72:75], 0
    v_mfma_f32_16x16x32_bf16 v[208:211], a[32:35], a[56:59], v[208:211]
    buffer_load_dwordx4 v8, s[8:11], s25 offen offset:2048 lds
    s_add_u32 s25, s25, 458752
    v_mfma_f32_16x16x32_bf16 v[224:227], a[40:43], a[56:59], 0
    ds_read_b64_tr_b16 a[32:33], v9 offset:28704
    v_mfma_f32_16x16x32_bf16 v[224:227], a[44:47], a[72:75], v[224:227]
    ds_read_b64_tr_b16 a[34:35], v9 offset:32288
    v_mfma_f32_16x16x32_bf16 v[228:231], a[44:47], a[76:79], 0
    ds_read_b64_tr_b16 a[36:37], v9 offset:43040
    v_mfma_f32_16x16x32_bf16 v[228:231], a[40:43], a[60:63], v[228:231]
    ds_read_b64_tr_b16 a[38:39], v9 offset:46624
    v_mfma_f32_16x16x32_bf16 v[232:235], a[40:43], a[64:67], 0
    v_mfma_f32_16x16x32_bf16 v[232:235], a[44:47], a[80:83], v[232:235]
    v_mfma_f32_16x16x32_bf16 v[236:239], a[44:47], a[84:87], 0
    v_mfma_f32_16x16x32_bf16 v[236:239], a[40:43], a[68:71], v[236:239]
    v_mfma_f32_16x16x32_bf16 v[252:255], a[48:51], a[68:71], 0
    ds_read_b64_tr_b16 a[40:41], v9 offset:35872
    v_mfma_f32_16x16x32_bf16 v[252:255], a[52:55], a[84:87], v[252:255]
    ds_read_b64_tr_b16 a[42:43], v9 offset:39456
    v_mfma_f32_16x16x32_bf16 v[248:251], a[52:55], a[80:83], 0
    ds_read_b64_tr_b16 a[44:45], v9 offset:50208
    v_mfma_f32_16x16x32_bf16 v[248:251], a[48:51], a[64:67], v[248:251]
    ds_read_b64_tr_b16 a[46:47], v9 offset:53792
    v_mfma_f32_16x16x32_bf16 v[244:247], a[48:51], a[60:63], 0
    v_mfma_f32_16x16x32_bf16 v[244:247], a[52:55], a[76:79], v[244:247]
    v_mfma_f32_16x16x32_bf16 v[240:243], a[52:55], a[72:75], 0
    v_mfma_f32_16x16x32_bf16 v[240:243], a[48:51], a[56:59], v[240:243]
    s_waitcnt vmcnt(15)
    s_mov_b32 s27, 3
Lg1_loop:
    s_waitcnt vmcnt(23) lgkmcnt(15)
    v_mfma_f32_16x16x32_bf16 v[32:35], a[0:3], a[88:91], v[32:35]
    ds_read_b64_tr_b16 a[48:49], v9 offset:28736
    v_mfma_f32_16x16x32_bf16 v[32:35], a[4:7], a[104:107], v[32:35]
    ds_read_b64_tr_b16 a[50:51], v9 offset:32320
    v_mfma_f32_16x16x32_bf16 v[36:39], a[4:7], a[108:111], v[36:39]
    ds_read_b64_tr_b16 a[52:53], v9 offset:43072
    v_mfma_f32_16x16x32_bf16 v[36:39], a[0:3], a[92:95], v[36:39]
    ds_read_b64_tr_b16 a[54:55], v9 offset:46656
    v_mfma_f32_16x16x32_bf16 v[40:43], a[0:3], a[96:99], v[40:43]
    buffer_load_dwordx4 a[152:155], v1, s[4:7], s24 offen offset:0 sc1
    v_mfma_f32_16x16x32_bf16 v[40:43], a[4:7], a[112:115], v[40:43]
    v_mfma_f32_16x16x32_bf16 v[44:47], a[4:7], a[116:119], v[44:47]
    v_mfma_f32_16x16x32_bf16 v[44:47], a[0:3], a[100:103], v[44:47]
    v_mfma_f32_16x16x32_bf16 v[60:63], a[8:11], a[100:103], v[60:63]
    ds_read_b64_tr_b16 a[0:1], v9 offset:35904
    v_mfma_f32_16x16x32_bf16 v[60:63], a[12:15], a[116:119], v[60:63]
    ds_read_b64_tr_b16 a[2:3], v9 offset:39488
    v_mfma_f32_16x16x32_bf16 v[56:59], a[12:15], a[112:115], v[56:59]
    ds_read_b64_tr_b16 a[4:5], v9 offset:50240
    v_mfma_f32_16x16x32_bf16 v[56:59], a[8:11], a[96:99], v[56:59]
    ds_read_b64_tr_b16 a[6:7], v9 offset:53824
    v_mfma_f32_16x16x32_bf16 v[52:55], a[8:11], a[92:95], v[52:55]
    buffer_load_dwordx4 a[156:159], v1, s[4:7], s24 offen offset:1024 sc1
    v_mfma_f32_16x16x32_bf16 v[52:55], a[12:15], a[108:111], v[52:55]
    v_mfma_f32_16x16x32_bf16 v[48:51], a[12:15], a[104:107], v[48:51]
    buffer_load_dword a184, v15, s[8:11], s39 offen
    s_add_u32 s39, s39, 458752
    v_mfma_f32_16x16x32_bf16 v[48:51], a[8:11], a[88:91], v[48:51]
    s_waitcnt lgkmcnt(15)
    v_mfma_f32_16x16x32_bf16 v[64:67], a[16:19], a[88:91], v[64:67]
    ds_read_b64_tr_b16 a[8:9], v9 offset:28768
    v_mfma_f32_16x16x32_bf16 v[64:67], a[20:23], a[104:107], v[64:67]
    ds_read_b64_tr_b16 a[10:11], v9 offset:32352
    v_mfma_f32_16x16x32_bf16 v[68:71], a[20:23], a[108:111], v[68:71]
    ds_read_b64_tr_b16 a[12:13], v9 offset:43104
    v_mfma_f32_16x16x32_bf16 v[68:71], a[16:19], a[92:95], v[68:71]
    ds_read_b64_tr_b16 a[14:15], v9 offset:46688
    v_mfma_f32_16x16x32_bf16 v[72:75], a[16:19], a[96:99], v[72:75]
    buffer_load_dwordx4 a[160:163], v1, s[4:7], s24 offen offset:2048 sc1
    v_mfma_f32_16x16x32_bf16 v[72:75], a[20:23], a[112:115], v[72:75]
    v_mfma_f32_16x16x32_bf16 v[76:79], a[20:23], a[116:119], v[76:79]
    buffer_load_dwordx4 a[164:167], v1, s[4:7], s24 offen offset:3072 sc1
    s_add_u32 s24, s24, 4096
    v_mfma_f32_16x16x32_bf16 v[76:79], a[16:19], a[100:103], v[76:79]
    v_mfma_f32_16x16x32_bf16 v[92:95], a[24:27], a[100:103], v[92:95]
    ds_read_b64_tr_b16 a[16:17], v9 offset:35936
    v_mfma_f32_16x16x32_bf16 v[92:95], a[28:31], a[116:119], v[92:95]
    ds_read_b64_tr_b16 a[18:19], v9 offset:39520
    v_mfma_f32_16x16x32_bf16 v[88:91], a[28:31], a[112:115], v[88:91]
    ds_read_b64_tr_b16 a[20:21], v9 offset:50272
    v_mfma_f32_16x16x32_bf16 v[88:91], a[24:27], a[96:99], v[88:91]
    ds_read_b64_tr_b16 a[22:23], v9 offset:53856
    v_mfma_f32_16x16x32_bf16 v[84:87], a[24:27], a[92:95], v[84:87]
    s_mov_b32 m0, s78
    s_add_u32 s78, s78, 1056
    v_mfma_f32_16x16x32_bf16 v[84:87], a[28:31], a[108:111], v[84:87]
    buffer_load_dwordx4 a[168:171], v1, s[4:7], s24 offen offset:0 sc1
    v_mfma_f32_16x16x32_bf16 v[80:83], a[28:31], a[104:107], v[80:83]
    v_mfma_f32_16x16x32_bf16 v[80:83], a[24:27], a[88:91], v[80:83]
    s_waitcnt lgkmcnt(15)
    v_mfma_f32_16x16x32_bf16 v[96:99], a[32:35], a[88:91], v[96:99]
    ds_read_b64_tr_b16 a[24:25], v9 offset:28800
    v_mfma_f32_16x16x32_bf16 v[96:99], a[36:39], a[104:107], v[96:99]
    ds_read_b64_tr_b16 a[26:27], v9 offset:32384
    v_mfma_f32_16x16x32_bf16 v[100:103], a[36:39], a[108:111], v[100:103]
    ds_read_b64_tr_b16 a[28:29], v9 offset:43136
    v_mfma_f32_16x16x32_bf16 v[100:103], a[32:35], a[92:95], v[100:103]
    ds_read_b64_tr_b16 a[30:31], v9 offset:46720
    v_mfma_f32_16x16x32_bf16 v[104:107], a[32:35], a[96:99], v[104:107]
    buffer_load_dwordx4 a[172:175], v1, s[4:7], s24 offen offset:1024 sc1
    v_mfma_f32_16x16x32_bf16 v[104:107], a[36:39], a[112:115], v[104:107]
    v_mfma_f32_16x16x32_bf16 v[108:111], a[36:39], a[116:119], v[108:111]
    buffer_load_dwordx4 v13, s[68:71], s79 offen nt lds
    s_add_u32 s79, s79, 2048
    v_mfma_f32_16x16x32_bf16 v[108:111], a[32:35], a[100:103], v[108:111]
    v_mfma_f32_16x16x32_bf16 v[124:127], a[40:43], a[100:103], v[124:127]
    ds_read_b64_tr_b16 a[32:33], v9 offset:35968
    v_mfma_f32_16x16x32_bf16 v[124:127], a[44:47], a[116:119], v[124:127]
    ds_read_b64_tr_b16 a[34:35], v9 offset:39552
    v_mfma_f32_16x16x32_bf16 v[120:123], a[44:47], a[112:115], v[120:123]
    ds_read_b64_tr_b16 a[36:37], v9 offset:50304
    v_mfma_f32_16x16x32_bf16 v[120:123], a[40:43], a[96:99], v[120:123]
    ds_read_b64_tr_b16 a[38:39], v9 offset:53888
    v_mfma_f32_16x16x32_bf16 v[116:119], a[40:43], a[92:95], v[116:119]
    buffer_load_dwordx4 a[176:179], v1, s[4:7], s24 offen offset:2048 sc1
    v_mfma_f32_16x16x32_bf16 v[116:119], a[44:47], a[108:111], v[116:119]
    v_mfma_f32_16x16x32_bf16 v[112:115], a[44:47], a[104:107], v[112:115]
    v_mfma_f32_16x16x32_bf16 v[112:115], a[40:43], a[88:91], v[112:115]
    s_waitcnt lgkmcnt(15)
    v_mfma_f32_16x16x32_bf16 v[128:131], a[48:51], a[88:91], v[128:131]
    ds_read_b64_tr_b16 a[40:41], v9 offset:28832
    v_mfma_f32_16x16x32_bf16 v[128:131], a[52:55], a[104:107], v[128:131]
    ds_read_b64_tr_b16 a[42:43], v9 offset:32416
    v_mfma_f32_16x16x32_bf16 v[132:135], a[52:55], a[108:111], v[132:135]
    ds_read_b64_tr_b16 a[44:45], v9 offset:43168
    v_mfma_f32_16x16x32_bf16 v[132:135], a[48:51], a[92:95], v[132:135]
    ds_read_b64_tr_b16 a[46:47], v9 offset:46752
    v_mfma_f32_16x16x32_bf16 v[136:139], a[48:51], a[96:99], v[136:139]
    buffer_load_dwordx4 a[180:183], v1, s[4:7], s24 offen offset:3072 sc1
    s_add_u32 s24, s24, 4096
    v_mfma_f32_16x16x32_bf16 v[136:139], a[52:55], a[112:115], v[136:139]
    v_mfma_f32_16x16x32_bf16 v[140:143], a[52:55], a[116:119], v[140:143]
    v_mfma_f32_16x16x32_bf16 v[140:143], a[48:51], a[100:103], v[140:143]
    s_add_u32 m0, s26, 0
    v_mfma_f32_16x16x32_bf16 v[156:159], a[0:3], a[100:103], v[156:159]
    ds_read_b64_tr_b16 a[48:49], v9 offset:36000
    v_mfma_f32_16x16x32_bf16 v[156:159], a[4:7], a[116:119], v[156:159]
    ds_read_b64_tr_b16 a[50:51], v9 offset:39584
    v_mfma_f32_16x16x32_bf16 v[152:155], a[4:7], a[112:115], v[152:155]
    ds_read_b64_tr_b16 a[52:53], v9 offset:50336
    v_mfma_f32_16x16x32_bf16 v[152:155], a[0:3], a[96:99], v[152:155]
    ds_read_b64_tr_b16 a[54:55], v9 offset:53920
    v_mfma_f32_16x16x32_bf16 v[148:151], a[0:3], a[92:95], v[148:151]
    buffer_load_dwordx4 v2, s[8:11], s25 offen offset:0 lds
    v_mfma_f32_16x16x32_bf16 v[148:151], a[4:7], a[108:111], v[148:151]
    v_mfma_f32_16x16x32_bf16 v[144:147], a[4:7], a[104:107], v[144:147]
    buffer_load_dwordx4 v3, s[8:11], s25 offen offset:1024 lds
    v_mfma_f32_16x16x32_bf16 v[144:147], a[0:3], a[88:91], v[144:147]
    s_waitcnt lgkmcnt(15)
    v_mfma_f32_16x16x32_bf16 v[160:163], a[8:11], a[88:91], v[160:163]
    v_mfma_f32_16x16x32_bf16 v[160:163], a[12:15], a[104:107], v[160:163]
    v_mfma_f32_16x16x32_bf16 v[164:167], a[12:15], a[108:111], v[164:167]
    v_mfma_f32_16x16x32_bf16 v[164:167], a[8:11], a[92:95], v[164:167]
    s_waitcnt vmcnt(28) lgkmcnt(0)
    s_barrier
    v_mfma_f32_16x16x32_bf16 v[168:171], a[8:11], a[96:99], v[168:171]
    ds_read_b64_tr_b16 a[0:1], v12 offset:0
    v_mfma_f32_16x16x32_bf16 v[168:171], a[12:15], a[112:115], v[168:171]
    ds_read_b64_tr_b16 a[2:3], v12 offset:3584
    v_mfma_f32_16x16x32_bf16 v[172:175], a[12:15], a[116:119], v[172:175]
    ds_read_b64_tr_b16 a[4:5], v12 offset:14336
    v_mfma_f32_16x16x32_bf16 v[172:175], a[8:11], a[100:103], v[172:175]
    ds_read_b64_tr_b16 a[6:7], v12 offset:17920
    v_mfma_f32_16x16x32_bf16 v[188:191], a[16:19], a[100:103], v[188:191]
    ds_read_b64_tr_b16 a[8:9], v12 offset:7168
    v_mfma_f32_16x16x32_bf16 v[188:191], a[20:23], a[116:119], v[188:191]
    ds_read_b64_tr_b16 a[10:11], v12 offset:10752
    v_mfma_f32_16x16x32_bf16 v[184:187], a[20:23], a[112:115], v[184:187]
    ds_read_b64_tr_b16 a[12:13], v12 offset:21504
    v_mfma_f32_16x16x32_bf16 v[184:187], a[16:19], a[96:99], v[184:187]
    ds_read_b64_tr_b16 a[14:15], v12 offset:25088
    v_mfma_f32_16x16x32_bf16 v[180:183], a[16:19], a[92:95], v[180:183]
    buffer_load_dwordx4 v4, s[8:11], s25 offen offset:2048 lds
    v_mfma_f32_16x16x32_bf16 v[180:183], a[20:23], a[108:111], v[180:183]
    v_mfma_f32_16x16x32_bf16 v[176:179], a[20:23], a[104:107], v[176:179]
    buffer_load_dwordx4 v5, s[8:11], s25 offen offset:3072 lds
    v_mfma_f32_16x16x32_bf16 v[176:179], a[16:19], a[88:91], v[176:179]
    v_mfma_f32_16x16x32_bf16 v[192:195], a[24:27], a[88:91], v[192:195]
    ds_read_b64_tr_b16 a[16:17], v10 offset:0
    v_mfma_f32_16x16x32_bf16 v[192:195], a[28:31], a[104:107], v[192:195]
    ds_read_b64_tr_b16 a[18:19], v10 offset:3584
    v_mfma_f32_16x16x32_bf16 v[196:199], a[28:31], a[108:111], v[196:199]
    ds_read_b64_tr_b16 a[20:21], v10 offset:14336
    v_mfma_f32_16x16x32_bf16 v[196:199], a[24:27], a[92:95], v[196:199]
    ds_read_b64_tr_b16 a[22:23], v10 offset:17920
    v_mfma_f32_16x16x32_bf16 v[200:203], a[24:27], a[96:99], v[200:203]
    s_add_u32 m0, s26, 4096
    v_mfma_f32_16x16x32_bf16 v[200:203], a[28:31], a[112:115], v[200:203]
    buffer_load_dwordx4 v6, s[8:11], s25 offen offset:0 lds
    v_mfma_f32_16x16x32_bf16 v[204:207], a[28:31], a[116:119], v[204:207]
    v_mfma_f32_16x16x32_bf16 v[204:207], a[24:27], a[100:103], v[204:207]
    v_mfma_f32_16x16x32_bf16 v[220:223], a[32:35], a[100:103], v[220:223]
    ds_read_b64_tr_b16 a[24:25], v10 offset:7168
    v_mfma_f32_16x16x32_bf16 v[220:223], a[36:39], a[116:119], v[220:223]
    ds_read_b64_tr_b16 a[26:27], v10 offset:10752
    v_mfma_f32_16x16x32_bf16 v[216:219], a[36:39], a[112:115], v[216:219]
    ds_read_b64_tr_b16 a[28:29], v10 offset:21504
    v_mfma_f32_16x16x32_bf16 v[216:219], a[32:35], a[96:99], v[216:219]
    ds_read_b64_tr_b16 a[30:31], v10 offset:25088
    v_mfma_f32_16x16x32_bf16 v[212:215], a[32:35], a[92:95], v[212:215]
    buffer_load_dwordx4 v7, s[8:11], s25 offen offset:1024 lds
    v_mfma_f32_16x16x32_bf16 v[212:215], a[36:39], a[108:111], v[212:215]
    v_mfma_f32_16x16x32_bf16 v[208:211], a[36:39], a[104:107], v[208:211]
    v_mfma_f32_16x16x32_bf16 v[208:211], a[32:35], a[88:91], v[208:211]
    buffer_load_dwordx4 v8, s[8:11], s25 offen offset:2048 lds
    s_add_u32 s25, s25, 458752
    v_mfma_f32_16x16x32_bf16 v[224:227], a[40:43], a[88:91], v[224:227]
    ds_read_b64_tr_b16 a[32:33], v10 offset:32
    v_mfma_f32_16x16x32_bf16 v[224:227], a[44:47], a[104:107], v[224:227]
    ds_read_b64_tr_b16 a[34:35], v10 offset:3616
    v_mfma_f32_16x16x32_bf16 v[228:231], a[44:47], a[108:111], v[228:231]
    ds_read_b64_tr_b16 a[36:37], v10 offset:14368
    v_mfma_f32_16x16x32_bf16 v[228:231], a[40:43], a[92:95], v[228:231]
    ds_read_b64_tr_b16 a[38:39], v10 offset:17952
    v_mfma_f32_16x16x32_bf16 v[232:235], a[40:43], a[96:99], v[232:235]
    v_mfma_f32_16x16x32_bf16 v[232:235], a[44:47], a[112:115], v[232:235]
    v_mfma_f32_16x16x32_bf16 v[236:239], a[44:47], a[116:119], v[236:239]
    v_mfma_f32_16x16x32_bf16 v[236:239], a[40:43], a[100:103], v[236:239]
    v_mfma_f32_16x16x32_bf16 v[252:255], a[48:51], a[100:103], v[252:255]
    ds_read_b64_tr_b16 a[40:41], v10 offset:7200
    v_mfma_f32_16x16x32_bf16 v[252:255], a[52:55], a[116:119], v[252:255]
    ds_read_b64_tr_b16 a[42:43], v10 offset:10784
    v_mfma_f32_16x16x32_bf16 v[248:251], a[52:55], a[112:115], v[248:251]
    ds_read_b64_tr_b16 a[44:45], v10 offset:21536
    v_mfma_f32_16x16x32_bf16 v[248:251], a[48:51], a[96:99], v[248:251]
    ds_read_b64_tr_b16 a[46:47], v10 offset:25120
    v_mfma_f32_16x16x32_bf16 v[244:247], a[48:51], a[92:95], v[244:247]
    v_mfma_f32_16x16x32_bf16 v[244:247], a[52:55], a[108:111], v[244:247]
    v_mfma_f32_16x16x32_bf16 v[240:243], a[52:55], a[104:107], v[240:243]
    v_mfma_f32_16x16x32_bf16 v[240:243], a[48:51], a[88:91], v[240:243]
    s_waitcnt vmcnt(24) lgkmcnt(15)
    v_mfma_f32_16x16x32_bf16 v[32:35], a[0:3], a[120:123], v[32:35]
    ds_read_b64_tr_b16 a[48:49], v10 offset:64
    v_mfma_f32_16x16x32_bf16 v[32:35], a[4:7], a[136:139], v[32:35]
    ds_read_b64_tr_b16 a[50:51], v10 offset:3648
    v_mfma_f32_16x16x32_bf16 v[36:39], a[4:7], a[140:143], v[36:39]
    ds_read_b64_tr_b16 a[52:53], v10 offset:14400
    v_mfma_f32_16x16x32_bf16 v[36:39], a[0:3], a[124:127], v[36:39]
    ds_read_b64_tr_b16 a[54:55], v10 offset:17984
    v_mfma_f32_16x16x32_bf16 v[40:43], a[0:3], a[128:131], v[40:43]
    buffer_load_dwordx4 a[56:59], v1, s[4:7], s24 offen offset:0 sc1
    v_mfma_f32_16x16x32_bf16 v[40:43], a[4:7], a[144:147], v[40:43]
    v_mfma_f32_16x16x32_bf16 v[44:47], a[4:7], a[148:151], v[44:47]
    v_mfma_f32_16x16x32_bf16 v[44:47], a[0:3], a[132:135], v[44:47]
    v_mfma_f32_16x16x32_bf16 v[60:63], a[8:11], a[132:135], v[60:63]
    ds_read_b64_tr_b16 a[0:1], v10 offset:7232
    v_mfma_f32_16x16x32_bf16 v[60:63], a[12:15], a[148:151], v[60:63]
    ds_read_b64_tr_b16 a[2:3], v10 offset:10816
    v_mfma_f32_16x16x32_bf16 v[56:59], a[12:15], a[144:147], v[56:59]
    ds_read_b64_tr_b16 a[4:5], v10 offset:21568
    v_mfma_f32_16x16x32_bf16 v[56:59], a[8:11], a[128:131], v[56:59]
    ds_read_b64_tr_b16 a[6:7], v10 offset:25152
    v_mfma_f32_16x16x32_bf16 v[52:55], a[8:11], a[124:127], v[52:55]
    buffer_load_dwordx4 a[60:63], v1, s[4:7], s24 offen offset:1024 sc1
    v_mfma_f32_16x16x32_bf16 v[52:55], a[12:15], a[140:143], v[52:55]
    v_mfma_f32_16x16x32_bf16 v[48:51], a[12:15], a[136:139], v[48:51]
    buffer_load_dword a184, v15, s[8:11], s39 offen
    s_add_u32 s39, s39, 458752
    v_mfma_f32_16x16x32_bf16 v[48:51], a[8:11], a[120:123], v[48:51]
    s_waitcnt lgkmcnt(15)
    v_mfma_f32_16x16x32_bf16 v[64:67], a[16:19], a[120:123], v[64:67]
    ds_read_b64_tr_b16 a[8:9], v10 offset:96
    v_mfma_f32_16x16x32_bf16 v[64:67], a[20:23], a[136:139], v[64:67]
    ds_read_b64_tr_b16 a[10:11], v10 offset:3680
    v_mfma_f32_16x16x32_bf16 v[68:71], a[20:23], a[140:143], v[68:71]
    ds_read_b64_tr_b16 a[12:13], v10 offset:14432
    v_mfma_f32_16x16x32_bf16 v[68:71], a[16:19], a[124:127], v[68:71]
    ds_read_b64_tr_b16 a[14:15], v10 offset:18016
    v_mfma_f32_16x16x32_bf16 v[72:75], a[16:19], a[128:131], v[72:75]
    buffer_load_dwordx4 a[64:67], v1, s[4:7], s24 offen offset:2048 sc1
    v_mfma_f32_16x16x32_bf16 v[72:75], a[20:23], a[144:147], v[72:75]
    v_mfma_f32_16x16x32_bf16 v[76:79], a[20:23], a[148:151], v[76:79]
    buffer_load_dwordx4 a[68:71], v1, s[4:7], s24 offen offset:3072 sc1
    s_add_u32 s24, s24, 4096
    v_mfma_f32_16x16x32_bf16 v[76:79], a[16:19], a[132:135], v[76:79]
    v_mfma_f32_16x16x32_bf16 v[92:95], a[24:27], a[132:135], v[92:95]
    ds_read_b64_tr_b16 a[16:17], v10 offset:7264
    v_mfma_f32_16x16x32_bf16 v[92:95], a[28:31], a[148:151], v[92:95]
    ds_read_b64_tr_b16 a[18:19], v10 offset:10848
    v_mfma_f32_16x16x32_bf16 v[88:91], a[28:31], a[144:147], v[88:91]
    ds_read_b64_tr_b16 a[20:21], v10 offset:21600
    v_mfma_f32_16x16x32_bf16 v[88:91], a[24:27], a[128:131], v[88:91]
    ds_read_b64_tr_b16 a[22:23], v10 offset:25184
    v_mfma_f32_16x16x32_bf16 v[84:87], a[24:27], a[124:127], v[84:87]
    s_mov_b32 m0, s78
    s_add_u32 s78, s78, 1056
    v_mfma_f32_16x16x32_bf16 v[84:87], a[28:31], a[140:143], v[84:87]
    buffer_load_dwordx4 a[72:75], v1, s[4:7], s24 offen offset:0 sc1
    v_mfma_f32_16x16x32_bf16 v[80:83], a[28:31], a[136:139], v[80:83]
    v_mfma_f32_16x16x32_bf16 v[80:83], a[24:27], a[120:123], v[80:83]
    s_waitcnt lgkmcnt(15)
    v_mfma_f32_16x16x32_bf16 v[96:99], a[32:35], a[120:123], v[96:99]
    ds_read_b64_tr_b16 a[24:25], v10 offset:128
    v_mfma_f32_16x16x32_bf16 v[96:99], a[36:39], a[136:139], v[96:99]
    ds_read_b64_tr_b16 a[26:27], v10 offset:3712
    v_mfma_f32_16x16x32_bf16 v[100:103], a[36:39], a[140:143], v[100:103]
    ds_read_b64_tr_b16 a[28:29], v10 offset:14464
    v_mfma_f32_16x16x32_bf16 v[100:103], a[32:35], a[124:127], v[100:103]
    ds_read_b64_tr_b16 a[30:31], v10 offset:18048
    v_mfma_f32_16x16x32_bf16 v[104:107], a[32:35], a[128:131], v[104:107]
    buffer_load_dwordx4 a[76:79], v1, s[4:7], s24 offen offset:1024 sc1
    v_mfma_f32_16x16x32_bf16 v[104:107], a[36:39], a[144:147], v[104:107]
    v_mfma_f32_16x16x32_bf16 v[108:111], a[36:39], a[148:151], v[108:111]
    buffer_load_dwordx4 v13, s[68:71], s79 offen nt lds
    s_add_u32 s79, s79, 2048
    v_mfma_f32_16x16x32_bf16 v[108:111], a[32:35], a[132:135], v[108:111]
    v_mfma_f32_16x16x32_bf16 v[124:127], a[40:43], a[132:135], v[124:127]
    ds_read_b64_tr_b16 a[32:33], v10 offset:7296
    v_mfma_f32_16x16x32_bf16 v[124:127], a[44:47], a[148:151], v[124:127]
    ds_read_b64_tr_b16 a[34:35], v10 offset:10880
    v_mfma_f32_16x16x32_bf16 v[120:123], a[44:47], a[144:147], v[120:123]
    ds_read_b64_tr_b16 a[36:37], v10 offset:21632
    v_mfma_f32_16x16x32_bf16 v[120:123], a[40:43], a[128:131], v[120:123]
    ds_read_b64_tr_b16 a[38:39], v10 offset:25216
    v_mfma_f32_16x16x32_bf16 v[116:119], a[40:43], a[124:127], v[116:119]
    buffer_load_dwordx4 a[80:83], v1, s[4:7], s24 offen offset:2048 sc1
    v_mfma_f32_16x16x32_bf16 v[116:119], a[44:47], a[140:143], v[116:119]
    v_mfma_f32_16x16x32_bf16 v[112:115], a[44:47], a[136:139], v[112:115]
    v_mfma_f32_16x16x32_bf16 v[112:115], a[40:43], a[120:123], v[112:115]
    s_waitcnt lgkmcnt(15)
    v_mfma_f32_16x16x32_bf16 v[128:131], a[48:51], a[120:123], v[128:131]
    ds_read_b64_tr_b16 a[40:41], v10 offset:160
    v_mfma_f32_16x16x32_bf16 v[128:131], a[52:55], a[136:139], v[128:131]
    ds_read_b64_tr_b16 a[42:43], v10 offset:3744
    v_mfma_f32_16x16x32_bf16 v[132:135], a[52:55], a[140:143], v[132:135]
    ds_read_b64_tr_b16 a[44:45], v10 offset:14496
    v_mfma_f32_16x16x32_bf16 v[132:135], a[48:51], a[124:127], v[132:135]
    ds_read_b64_tr_b16 a[46:47], v10 offset:18080
    v_mfma_f32_16x16x32_bf16 v[136:139], a[48:51], a[128:131], v[136:139]
    buffer_load_dwordx4 a[84:87], v1, s[4:7], s24 offen offset:3072 sc1
    s_add_u32 s24, s24, 4096
    v_mfma_f32_16x16x32_bf16 v[136:139], a[52:55], a[144:147], v[136:139]
    v_mfma_f32_16x16x32_bf16 v[140:143], a[52:55], a[148:151], v[140:143]
    v_mfma_f32_16x16x32_bf16 v[140:143], a[48:51], a[132:135], v[140:143]
    s_add_u32 m0, s26, 28672
    v_mfma_f32_16x16x32_bf16 v[156:159], a[0:3], a[132:135], v[156:159]
    ds_read_b64_tr_b16 a[48:49], v10 offset:7328
    v_mfma_f32_16x16x32_bf16 v[156:159], a[4:7], a[148:151], v[156:159]
    ds_read_b64_tr_b16 a[50:51], v10 offset:10912
    v_mfma_f32_16x16x32_bf16 v[152:155], a[4:7], a[144:147], v[152:155]
    ds_read_b64_tr_b16 a[52:53], v10 offset:21664
    v_mfma_f32_16x16x32_bf16 v[152:155], a[0:3], a[128:131], v[152:155]
    ds_read_b64_tr_b16 a[54:55], v10 offset:25248
    v_mfma_f32_16x16x32_bf16 v[148:151], a[0:3], a[124:127], v[148:151]
    buffer_load_dwordx4 v2, s[8:11], s25 offen offset:0 lds
    v_mfma_f32_16x16x32_bf16 v[148:151], a[4:7], a[140:143], v[148:151]
    v_mfma_f32_16x16x32_bf16 v[144:147], a[4:7], a[136:139], v[144:147]
    buffer_load_dwordx4 v3, s[8:11], s25 offen offset:1024 lds
    v_mfma_f32_16x16x32_bf16 v[144:147], a[0:3], a[120:123], v[144:147]
    s_waitcnt lgkmcnt(15)
    v_mfma_f32_16x16x32_bf16 v[160:163], a[8:11], a[120:123], v[160:163]
    v_mfma_f32_16x16x32_bf16 v[160:163], a[12:15], a[136:139], v[160:163]
    v_mfma_f32_16x16x32_bf16 v[164:167], a[12:15], a[140:143], v[164:167]
    v_mfma_f32_16x16x32_bf16 v[164:167], a[8:11], a[124:127], v[164:167]
    s_waitcnt vmcnt(29) lgkmcnt(0)
    s_barrier
    v_mfma_f32_16x16x32_bf16 v[168:171], a[8:11], a[128:131], v[168:171]
    ds_read_b64_tr_b16 a[0:1], v12 offset:28672
    v_mfma_f32_16x16x32_bf16 v[168:171], a[12:15], a[144:147], v[168:171]
    ds_read_b64_tr_b16 a[2:3], v12 offset:32256
    v_mfma_f32_16x16x32_bf16 v[172:175], a[12:15], a[148:151], v[172:175]
    ds_read_b64_tr_b16 a[4:5], v12 offset:43008
    v_mfma_f32_16x16x32_bf16 v[172:175], a[8:11], a[132:135], v[172:175]
    ds_read_b64_tr_b16 a[6:7], v12 offset:46592
    v_mfma_f32_16x16x32_bf16 v[188:191], a[16:19], a[132:135], v[188:191]
    ds_read_b64_tr_b16 a[8:9], v12 offset:35840
    v_mfma_f32_16x16x32_bf16 v[188:191], a[20:23], a[148:151], v[188:191]
    ds_read_b64_tr_b16 a[10:11], v12 offset:39424
    v_mfma_f32_16x16x32_bf16 v[184:187], a[20:23], a[144:147], v[184:187]
    ds_read_b64_tr_b16 a[12:13], v12 offset:50176
    v_mfma_f32_16x16x32_bf16 v[184:187], a[16:19], a[128:131], v[184:187]
    ds_read_b64_tr_b16 a[14:15], v12 offset:53760
    v_mfma_f32_16x16x32_bf16 v[180:183], a[16:19], a[124:127], v[180:183]
    buffer_load_dwordx4 v4, s[8:11], s25 offen offset:2048 lds
    v_mfma_f32_16x16x32_bf16 v[180:183], a[20:23], a[140:143], v[180:183]
    v_mfma_f32_16x16x32_bf16 v[176:179], a[20:23], a[136:139], v[176:179]
    buffer_load_dwordx4 v5, s[8:11], s25 offen offset:3072 lds
    v_mfma_f32_16x16x32_bf16 v[176:179], a[16:19], a[120:123], v[176:179]
    v_mfma_f32_16x16x32_bf16 v[192:195], a[24:27], a[120:123], v[192:195]
    ds_read_b64_tr_b16 a[16:17], v10 offset:28672
    v_mfma_f32_16x16x32_bf16 v[192:195], a[28:31], a[136:139], v[192:195]
    ds_read_b64_tr_b16 a[18:19], v10 offset:32256
    v_mfma_f32_16x16x32_bf16 v[196:199], a[28:31], a[140:143], v[196:199]
    ds_read_b64_tr_b16 a[20:21], v10 offset:43008
    v_mfma_f32_16x16x32_bf16 v[196:199], a[24:27], a[124:127], v[196:199]
    ds_read_b64_tr_b16 a[22:23], v10 offset:46592
    v_mfma_f32_16x16x32_bf16 v[200:203], a[24:27], a[128:131], v[200:203]
    s_add_u32 m0, s26, 32768
    v_mfma_f32_16x16x32_bf16 v[200:203], a[28:31], a[144:147], v[200:203]
    buffer_load_dwordx4 v6, s[8:11], s25 offen offset:0 lds
    v_mfma_f32_16x16x32_bf16 v[204:207], a[28:31], a[148:151], v[204:207]
    v_mfma_f32_16x16x32_bf16 v[204:207], a[24:27], a[132:135], v[204:207]
    v_mfma_f32_16x16x32_bf16 v[220:223], a[32:35], a[132:135], v[220:223]
    ds_read_b64_tr_b16 a[24:25], v10 offset:35840
    v_mfma_f32_16x16x32_bf16 v[220:223], a[36:39], a[148:151], v[220:223]
    ds_read_b64_tr_b16 a[26:27], v10 offset:39424
    v_mfma_f32_16x16x32_bf16 v[216:219], a[36:39], a[144:147], v[216:219]
    ds_read_b64_tr_b16 a[28:29], v10 offset:50176
    v_mfma_f32_16x16x32_bf16 v[216:219], a[32:35], a[128:131], v[216:219]
    ds_read_b64_tr_b16 a[30:31], v10 offset:53760
    v_mfma_f32_16x16x32_bf16 v[212:215], a[32:35], a[124:127], v[212:215]
    buffer_load_dwordx4 v7, s[8:11], s25 offen offset:1024 lds
    v_mfma_f32_16x16x32_bf16 v[212:215], a[36:39], a[140:143], v[212:215]
    v_mfma_f32_16x16x32_bf16 v[208:211], a[36:39], a[136:139], v[208:211]
    v_mfma_f32_16x16x32_bf16 v[208:211], a[32:35], a[120:123], v[208:211]
    buffer_load_dwordx4 v8, s[8:11], s25 offen offset:2048 lds
    s_add_u32 s25, s25, 458752
    v_mfma_f32_16x16x32_bf16 v[224:227], a[40:43], a[120:123], v[224:227]
    ds_read_b64_tr_b16 a[32:33], v10 offset:28704
    v_mfma_f32_16x16x32_bf16 v[224:227], a[44:47], a[136:139], v[224:227]
    ds_read_b64_tr_b16 a[34:35], v10 offset:32288
    v_mfma_f32_16x16x32_bf16 v[228:231], a[44:47], a[140:143], v[228:231]
    ds_read_b64_tr_b16 a[36:37], v10 offset:43040
    v_mfma_f32_16x16x32_bf16 v[228:231], a[40:43], a[124:127], v[228:231]
    ds_read_b64_tr_b16 a[38:39], v10 offset:46624
    v_mfma_f32_16x16x32_bf16 v[232:235], a[40:43], a[128:131], v[232:235]
    v_mfma_f32_16x16x32_bf16 v[232:235], a[44:47], a[144:147], v[232:235]
    v_mfma_f32_16x16x32_bf16 v[236:239], a[44:47], a[148:151], v[236:239]
    v_mfma_f32_16x16x32_bf16 v[236:239], a[40:43], a[132:135], v[236:239]
    v_mfma_f32_16x16x32_bf16 v[252:255], a[48:51], a[132:135], v[252:255]
    ds_read_b64_tr_b16 a[40:41], v10 offset:35872
    v_mfma_f32_16x16x32_bf16 v[252:255], a[52:55], a[148:151], v[252:255]
    ds_read_b64_tr_b16 a[42:43], v10 offset:39456
    v_mfma_f32_16x16x32_bf16 v[248:251], a[52:55], a[144:147], v[248:251]
    ds_read_b64_tr_b16 a[44:45], v10 offset:50208
    v_mfma_f32_16x16x32_bf16 v[248:251], a[48:51], a[128:131], v[248:251]
    ds_read_b64_tr_b16 a[46:47], v10 offset:53792
    v_mfma_f32_16x16x32_bf16 v[244:247], a[48:51], a[124:127], v[244:247]
    v_mfma_f32_16x16x32_bf16 v[244:247], a[52:55], a[140:143], v[244:247]
    v_mfma_f32_16x16x32_bf16 v[240:243], a[52:55], a[136:139], v[240:243]
    v_mfma_f32_16x16x32_bf16 v[240:243], a[48:51], a[120:123], v[240:243]
    s_waitcnt vmcnt(24) lgkmcnt(15)
    v_mfma_f32_16x16x32_bf16 v[32:35], a[0:3], a[152:155], v[32:35]
    ds_read_b64_tr_b16 a[48:49], v10 offset:28736
    v_mfma_f32_16x16x32_bf16 v[32:35], a[4:7], a[168:171], v[32:35]
    ds_read_b64_tr_b16 a[50:51], v10 offset:32320
    v_mfma_f32_16x16x32_bf16 v[36:39], a[4:7], a[172:175], v[36:39]
    ds_read_b64_tr_b16 a[52:53], v10 offset:43072
    v_mfma_f32_16x16x32_bf16 v[36:39], a[0:3], a[156:159], v[36:39]
    ds_read_b64_tr_b16 a[54:55], v10 offset:46656
    v_mfma_f32_16x16x32_bf16 v[40:43], a[0:3], a[160:163], v[40:43]
    buffer_load_dwordx4 a[88:91], v1, s[4:7], s24 offen offset:0 sc1
    v_mfma_f32_16x16x32_bf16 v[40:43], a[4:7], a[176:179], v[40:43]
    v_mfma_f32_16x16x32_bf16 v[44:47], a[4:7], a[180:183], v[44:47]
    v_mfma_f32_16x16x32_bf16 v[44:47], a[0:3], a[164:167], v[44:47]
    v_mfma_f32_16x16x32_bf16 v[60:63], a[8:11], a[164:167], v[60:63]
    ds_read_b64_tr_b16 a[0:1], v10 offset:35904
    v_mfma_f32_16x16x32_bf16 v[60:63], a[12:15], a[180:183], v[60:63]
    ds_read_b64_tr_b16 a[2:3], v10 offset:39488
    v_mfma_f32_16x16x32_bf16 v[56:59], a[12:15], a[176:179], v[56:59]
    ds_read_b64_tr_b16 a[4:5], v10 offset:50240
    v_mfma_f32_16x16x32_bf16 v[56:59], a[8:11], a[160:163], v[56:59]
    ds_read_b64_tr_b16 a[6:7], v10 offset:53824
    v_mfma_f32_16x16x32_bf16 v[52:55], a[8:11], a[156:159], v[52:55]
    buffer_load_dwordx4 a[92:95], v1, s[4:7], s24 offen offset:1024 sc1
    v_mfma_f32_16x16x32_bf16 v[52:55], a[12:15], a[172:175], v[52:55]
    v_mfma_f32_16x16x32_bf16 v[48:51], a[12:15], a[168:171], v[48:51]
    buffer_load_dword a184, v15, s[8:11], s39 offen
    s_add_u32 s39, s39, 458752
    v_mfma_f32_16x16x32_bf16 v[48:51], a[8:11], a[152:155], v[48:51]
    s_waitcnt lgkmcnt(15)
    v_mfma_f32_16x16x32_bf16 v[64:67], a[16:19], a[152:155], v[64:67]
    ds_read_b64_tr_b16 a[8:9], v10 offset:28768
    v_mfma_f32_16x16x32_bf16 v[64:67], a[20:23], a[168:171], v[64:67]
    ds_read_b64_tr_b16 a[10:11], v10 offset:32352
    v_mfma_f32_16x16x32_bf16 v[68:71], a[20:23], a[172:175], v[68:71]
    ds_read_b64_tr_b16 a[12:13], v10 offset:43104
    v_mfma_f32_16x16x32_bf16 v[68:71], a[16:19], a[156:159], v[68:71]
    ds_read_b64_tr_b16 a[14:15], v10 offset:46688
    v_mfma_f32_16x16x32_bf16 v[72:75], a[16:19], a[160:163], v[72:75]
    buffer_load_dwordx4 a[96:99], v1, s[4:7], s24 offen offset:2048 sc1
    v_mfma_f32_16x16x32_bf16 v[72:75], a[20:23], a[176:179], v[72:75]
    v_mfma_f32_16x16x32_bf16 v[76:79], a[20:23], a[180:183], v[76:79]
    buffer_load_dwordx4 a[100:103], v1, s[4:7], s24 offen offset:3072 sc1
    s_add_u32 s24, s24, 4096
    v_mfma_f32_16x16x32_bf16 v[76:79], a[16:19], a[164:167], v[76:79]
    v_mfma_f32_16x16x32_bf16 v[92:95], a[24:27], a[164:167], v[92:95]
    ds_read_b64_tr_b16 a[16:17], v10 offset:35936
    v_mfma_f32_16x16x32_bf16 v[92:95], a[28:31], a[180:183], v[92:95]
    ds_read_b64_tr_b16 a[18:19], v10 offset:39520
    v_mfma_f32_16x16x32_bf16 v[88:91], a[28:31], a[176:179], v[88:91]
    ds_read_b64_tr_b16 a[20:21], v10 offset:50272
    v_mfma_f32_16x16x32_bf16 v[88:91], a[24:27], a[160:163], v[88:91]
    ds_read_b64_tr_b16 a[22:23], v10 offset:53856
    v_mfma_f32_16x16x32_bf16 v[84:87], a[24:27], a[156:159], v[84:87]
    s_mov_b32 m0, s78
    s_add_u32 s78, s78, 1056
    v_mfma_f32_16x16x32_bf16 v[84:87], a[28:31], a[172:175], v[84:87]
    buffer_load_dwordx4 a[104:107], v1, s[4:7], s24 offen offset:0 sc1
    v_mfma_f32_16x16x32_bf16 v[80:83], a[28:31], a[168:171], v[80:83]
    v_mfma_f32_16x16x32_bf16 v[80:83], a[24:27], a[152:155], v[80:83]
    s_waitcnt lgkmcnt(15)
    v_mfma_f32_16x16x32_bf16 v[96:99], a[32:35], a[152:155], v[96:99]
    ds_read_b64_tr_b16 a[24:25], v10 offset:28800
    v_mfma_f32_16x16x32_bf16 v[96:99], a[36:39], a[168:171], v[96:99]
    ds_read_b64_tr_b16 a[26:27], v10 offset:32384
    v_mfma_f32_16x16x32_bf16 v[100:103], a[36:39], a[172:175], v[100:103]
    ds_read_b64_tr_b16 a[28:29], v10 offset:43136
    v_mfma_f32_16x16x32_bf16 v[100:103], a[32:35], a[156:159], v[100:103]
    ds_read_b64_tr_b16 a[30:31], v10 offset:46720
    v_mfma_f32_16x16x32_bf16 v[104:107], a[32:35], a[160:163], v[104:107]
    buffer_load_dwordx4 a[108:111], v1, s[4:7], s24 offen offset:1024 sc1
    v_mfma_f32_16x16x32_bf16 v[104:107], a[36:39], a[176:179], v[104:107]
    v_mfma_f32_16x16x32_bf16 v[108:111], a[36:39], a[180:183], v[108:111]
    buffer_load_dwordx4 v13, s[68:71], s79 offen nt lds
    s_add_u32 s79, s79, 2048
    v_mfma_f32_16x16x32_bf16 v[108:111], a[32:35], a[164:167], v[108:111]
    v_mfma_f32_16x16x32_bf16 v[124:127], a[40:43], a[164:167], v[124:127]
    ds_read_b64_tr_b16 a[32:33], v10 offset:35968
    v_mfma_f32_16x16x32_bf16 v[124:127], a[44:47], a[180:183], v[124:127]
    ds_read_b64_tr_b16 a[34:35], v10 offset:39552
    v_mfma_f32_16x16x32_bf16 v[120:123], a[44:47], a[176:179], v[120:123]
    ds_read_b64_tr_b16 a[36:37], v10 offset:50304
    v_mfma_f32_16x16x32_bf16 v[120:123], a[40:43], a[160:163], v[120:123]
    ds_read_b64_tr_b16 a[38:39], v10 offset:53888
    v_mfma_f32_16x16x32_bf16 v[116:119], a[40:43], a[156:159], v[116:119]
    buffer_load_dwordx4 a[112:115], v1, s[4:7], s24 offen offset:2048 sc1
    v_mfma_f32_16x16x32_bf16 v[116:119], a[44:47], a[172:175], v[116:119]
    v_mfma_f32_16x16x32_bf16 v[112:115], a[44:47], a[168:171], v[112:115]
    v_mfma_f32_16x16x32_bf16 v[112:115], a[40:43], a[152:155], v[112:115]
    s_waitcnt lgkmcnt(15)
    v_mfma_f32_16x16x32_bf16 v[128:131], a[48:51], a[152:155], v[128:131]
    ds_read_b64_tr_b16 a[40:41], v10 offset:28832
    v_mfma_f32_16x16x32_bf16 v[128:131], a[52:55], a[168:171], v[128:131]
    ds_read_b64_tr_b16 a[42:43], v10 offset:32416
    v_mfma_f32_16x16x32_bf16 v[132:135], a[52:55], a[172:175], v[132:135]
    ds_read_b64_tr_b16 a[44:45], v10 offset:43168
    v_mfma_f32_16x16x32_bf16 v[132:135], a[48:51], a[156:159], v[132:135]
    ds_read_b64_tr_b16 a[46:47], v10 offset:46752
    v_mfma_f32_16x16x32_bf16 v[136:139], a[48:51], a[160:163], v[136:139]
    buffer_load_dwordx4 a[116:119], v1, s[4:7], s24 offen offset:3072 sc1
    s_add_u32 s24, s24, 4096
    v_mfma_f32_16x16x32_bf16 v[136:139], a[52:55], a[176:179], v[136:139]
    v_mfma_f32_16x16x32_bf16 v[140:143], a[52:55], a[180:183], v[140:143]
    v_mfma_f32_16x16x32_bf16 v[140:143], a[48:51], a[164:167], v[140:143]
    s_add_u32 m0, s66, 0
    v_mfma_f32_16x16x32_bf16 v[156:159], a[0:3], a[164:167], v[156:159]
    ds_read_b64_tr_b16 a[48:49], v10 offset:36000
    v_mfma_f32_16x16x32_bf16 v[156:159], a[4:7], a[180:183], v[156:159]
    ds_read_b64_tr_b16 a[50:51], v10 offset:39584
    v_mfma_f32_16x16x32_bf16 v[152:155], a[4:7], a[176:179], v[152:155]
    ds_read_b64_tr_b16 a[52:53], v10 offset:50336
    v_mfma_f32_16x16x32_bf16 v[152:155], a[0:3], a[160:163], v[152:155]
    ds_read_b64_tr_b16 a[54:55], v10 offset:53920
    v_mfma_f32_16x16x32_bf16 v[148:151], a[0:3], a[156:159], v[148:151]
    buffer_load_dwordx4 v2, s[8:11], s25 offen offset:0 lds
    v_mfma_f32_16x16x32_bf16 v[148:151], a[4:7], a[172:175], v[148:151]
    v_mfma_f32_16x16x32_bf16 v[144:147], a[4:7], a[168:171], v[144:147]
    buffer_load_dwordx4 v3, s[8:11], s25 offen offset:1024 lds
    v_mfma_f32_16x16x32_bf16 v[144:147], a[0:3], a[152:155], v[144:147]
    s_waitcnt lgkmcnt(15)
    v_mfma_f32_16x16x32_bf16 v[160:163], a[8:11], a[152:155], v[160:163]
    v_mfma_f32_16x16x32_bf16 v[160:163], a[12:15], a[168:171], v[160:163]
    v_mfma_f32_16x16x32_bf16 v[164:167], a[12:15], a[172:175], v[164:167]
    v_mfma_f32_16x16x32_bf16 v[164:167], a[8:11], a[156:159], v[164:167]
    s_waitcnt vmcnt(29) lgkmcnt(0)
    s_barrier
    v_mfma_f32_16x16x32_bf16 v[168:171], a[8:11], a[160:163], v[168:171]
    ds_read_b64_tr_b16 a[0:1], v11 offset:0
    v_mfma_f32_16x16x32_bf16 v[168:171], a[12:15], a[176:179], v[168:171]
    ds_read_b64_tr_b16 a[2:3], v11 offset:3584
    v_mfma_f32_16x16x32_bf16 v[172:175], a[12:15], a[180:183], v[172:175]
    ds_read_b64_tr_b16 a[4:5], v11 offset:14336
    v_mfma_f32_16x16x32_bf16 v[172:175], a[8:11], a[164:167], v[172:175]
    ds_read_b64_tr_b16 a[6:7], v11 offset:17920
    v_mfma_f32_16x16x32_bf16 v[188:191], a[16:19], a[164:167], v[188:191]
    ds_read_b64_tr_b16 a[8:9], v11 offset:7168
    v_mfma_f32_16x16x32_bf16 v[188:191], a[20:23], a[180:183], v[188:191]
    ds_read_b64_tr_b16 a[10:11], v11 offset:10752
    v_mfma_f32_16x16x32_bf16 v[184:187], a[20:23], a[176:179], v[184:187]
    ds_read_b64_tr_b16 a[12:13], v11 offset:21504
    v_mfma_f32_16x16x32_bf16 v[184:187], a[16:19], a[160:163], v[184:187]
    ds_read_b64_tr_b16 a[14:15], v11 offset:25088
    v_mfma_f32_16x16x32_bf16 v[180:183], a[16:19], a[156:159], v[180:183]
    buffer_load_dwordx4 v4, s[8:11], s25 offen offset:2048 lds
    v_mfma_f32_16x16x32_bf16 v[180:183], a[20:23], a[172:175], v[180:183]
    v_mfma_f32_16x16x32_bf16 v[176:179], a[20:23], a[168:171], v[176:179]
    buffer_load_dwordx4 v5, s[8:11], s25 offen offset:3072 lds
    v_mfma_f32_16x16x32_bf16 v[176:179], a[16:19], a[152:155], v[176:179]
    v_mfma_f32_16x16x32_bf16 v[192:195], a[24:27], a[152:155], v[192:195]
    ds_read_b64_tr_b16 a[16:17], v9 offset:0
    v_mfma_f32_16x16x32_bf16 v[192:195], a[28:31], a[168:171], v[192:195]
    ds_read_b64_tr_b16 a[18:19], v9 offset:3584
    v_mfma_f32_16x16x32_bf16 v[196:199], a[28:31], a[172:175], v[196:199]
    ds_read_b64_tr_b16 a[20:21], v9 offset:14336
    v_mfma_f32_16x16x32_bf16 v[196:199], a[24:27], a[156:159], v[196:199]
    ds_read_b64_tr_b16 a[22:23], v9 offset:17920
    v_mfma_f32_16x16x32_bf16 v[200:203], a[24:27], a[160:163], v[200:203]
    s_add_u32 m0, s66, 4096
    v_mfma_f32_16x16x32_bf16 v[200:203], a[28:31], a[176:179], v[200:203]
    buffer_load_dwordx4 v6, s[8:11], s25 offen offset:0 lds
    v_mfma_f32_16x16x32_bf16 v[204:207], a[28:31], a[180:183], v[204:207]
    v_mfma_f32_16x16x32_bf16 v[204:207], a[24:27], a[164:167], v[204:207]
    v_mfma_f32_16x16x32_bf16 v[220:223], a[32:35], a[164:167], v[220:223]
    ds_read_b64_tr_b16 a[24:25], v9 offset:7168
    v_mfma_f32_16x16x32_bf16 v[220:223], a[36:39], a[180:183], v[220:223]
    ds_read_b64_tr_b16 a[26:27], v9 offset:10752
    v_mfma_f32_16x16x32_bf16 v[216:219], a[36:39], a[176:179], v[216:219]
    ds_read_b64_tr_b16 a[28:29], v9 offset:21504
    v_mfma_f32_16x16x32_bf16 v[216:219], a[32:35], a[160:163], v[216:219]
    ds_read_b64_tr_b16 a[30:31], v9 offset:25088
    v_mfma_f32_16x16x32_bf16 v[212:215], a[32:35], a[156:159], v[212:215]
    buffer_load_dwordx4 v7, s[8:11], s25 offen offset:1024 lds
    v_mfma_f32_16x16x32_bf16 v[212:215], a[36:39], a[172:175], v[212:215]
    v_mfma_f32_16x16x32_bf16 v[208:211], a[36:39], a[168:171], v[208:211]
    v_mfma_f32_16x16x32_bf16 v[208:211], a[32:35], a[152:155], v[208:211]
    buffer_load_dwordx4 v8, s[8:11], s25 offen offset:2048 lds
    s_add_u32 s25, s25, 458752
    v_mfma_f32_16x16x32_bf16 v[224:227], a[40:43], a[152:155], v[224:227]
    ds_read_b64_tr_b16 a[32:33], v9 offset:32
    v_mfma_f32_16x16x32_bf16 v[224:227], a[44:47], a[168:171], v[224:227]
    ds_read_b64_tr_b16 a[34:35], v9 offset:3616
    v_mfma_f32_16x16x32_bf16 v[228:231], a[44:47], a[172:175], v[228:231]
    ds_read_b64_tr_b16 a[36:37], v9 offset:14368
    v_mfma_f32_16x16x32_bf16 v[228:231], a[40:43], a[156:159], v[228:231]
    ds_read_b64_tr_b16 a[38:39], v9 offset:17952
    v_mfma_f32_16x16x32_bf16 v[232:235], a[40:43], a[160:163], v[232:235]
    v_mfma_f32_16x16x32_bf16 v[232:235], a[44:47], a[176:179], v[232:235]
    v_mfma_f32_16x16x32_bf16 v[236:239], a[44:47], a[180:183], v[236:239]
    v_mfma_f32_16x16x32_bf16 v[236:239], a[40:43], a[164:167], v[236:239]
    v_mfma_f32_16x16x32_bf16 v[252:255], a[48:51], a[164:167], v[252:255]
    ds_read_b64_tr_b16 a[40:41], v9 offset:7200
    v_mfma_f32_16x16x32_bf16 v[252:255], a[52:55], a[180:183], v[252:255]
    ds_read_b64_tr_b16 a[42:43], v9 offset:10784
    v_mfma_f32_16x16x32_bf16 v[248:251], a[52:55], a[176:179], v[248:251]
    ds_read_b64_tr_b16 a[44:45], v9 offset:21536
    v_mfma_f32_16x16x32_bf16 v[248:251], a[48:51], a[160:163], v[248:251]
    ds_read_b64_tr_b16 a[46:47], v9 offset:25120
    v_mfma_f32_16x16x32_bf16 v[244:247], a[48:51], a[156:159], v[244:247]
    v_mfma_f32_16x16x32_bf16 v[244:247], a[52:55], a[172:175], v[244:247]
    v_mfma_f32_16x16x32_bf16 v[240:243], a[52:55], a[168:171], v[240:243]
    v_mfma_f32_16x16x32_bf16 v[240:243], a[48:51], a[152:155], v[240:243]
    s_waitcnt vmcnt(24) lgkmcnt(15)
    v_mfma_f32_16x16x32_bf16 v[32:35], a[0:3], a[56:59], v[32:35]
    ds_read_b64_tr_b16 a[48:49], v9 offset:64
    v_mfma_f32_16x16x32_bf16 v[32:35], a[4:7], a[72:75], v[32:35]
    ds_read_b64_tr_b16 a[50:51], v9 offset:3648
    v_mfma_f32_16x16x32_bf16 v[36:39], a[4:7], a[76:79], v[36:39]
    ds_read_b64_tr_b16 a[52:53], v9 offset:14400
    v_mfma_f32_16x16x32_bf16 v[36:39], a[0:3], a[60:63], v[36:39]
    ds_read_b64_tr_b16 a[54:55], v9 offset:17984
    v_mfma_f32_16x16x32_bf16 v[40:43], a[0:3], a[64:67], v[40:43]
    buffer_load_dwordx4 a[120:123], v1, s[4:7], s24 offen offset:0 sc1
    v_mfma_f32_16x16x32_bf16 v[40:43], a[4:7], a[80:83], v[40:43]
    v_mfma_f32_16x16x32_bf16 v[44:47], a[4:7], a[84:87], v[44:47]
    v_mfma_f32_16x16x32_bf16 v[44:47], a[0:3], a[68:71], v[44:47]
    v_mfma_f32_16x16x32_bf16 v[60:63], a[8:11], a[68:71], v[60:63]
    ds_read_b64_tr_b16 a[0:1], v9 offset:7232
    v_mfma_f32_16x16x32_bf16 v[60:63], a[12:15], a[84:87], v[60:63]
    ds_read_b64_tr_b16 a[2:3], v9 offset:10816
    v_mfma_f32_16x16x32_bf16 v[56:59], a[12:15], a[80:83], v[56:59]
    ds_read_b64_tr_b16 a[4:5], v9 offset:21568
    v_mfma_f32_16x16x32_bf16 v[56:59], a[8:11], a[64:67], v[56:59]
    ds_read_b64_tr_b16 a[6:7], v9 offset:25152
    v_mfma_f32_16x16x32_bf16 v[52:55], a[8:11], a[60:63], v[52:55]
    buffer_load_dwordx4 a[124:127], v1, s[4:7], s24 offen offset:1024 sc1
    v_mfma_f32_16x16x32_bf16 v[52:55], a[12:15], a[76:79], v[52:55]
    v_mfma_f32_16x16x32_bf16 v[48:51], a[12:15], a[72:75], v[48:51]
    buffer_load_dword a184, v15, s[8:11], s39 offen
    s_add_u32 s39, s39, 458752
    v_mfma_f32_16x16x32_bf16 v[48:51], a[8:11], a[56:59], v[48:51]
    s_waitcnt lgkmcnt(15)
    v_mfma_f32_16x16x32_bf16 v[64:67], a[16:19], a[56:59], v[64:67]
    ds_read_b64_tr_b16 a[8:9], v9 offset:96
    v_mfma_f32_16x16x32_bf16 v[64:67], a[20:23], a[72:75], v[64:67]
    ds_read_b64_tr_b16 a[10:11], v9 offset:3680
    v_mfma_f32_16x16x32_bf16 v[68:71], a[20:23], a[76:79], v[68:71]
    ds_read_b64_tr_b16 a[12:13], v9 offset:14432
    v_mfma_f32_16x16x32_bf16 v[68:71], a[16:19], a[60:63], v[68:71]
    ds_read_b64_tr_b16 a[14:15], v9 offset:18016
    v_mfma_f32_16x16x32_bf16 v[72:75], a[16:19], a[64:67], v[72:75]
    buffer_load_dwordx4 a[128:131], v1, s[4:7], s24 offen offset:2048 sc1
    v_mfma_f32_16x16x32_bf16 v[72:75], a[20:23], a[80:83], v[72:75]
    v_mfma_f32_16x16x32_bf16 v[76:79], a[20:23], a[84:87], v[76:79]
    buffer_load_dwordx4 a[132:135], v1, s[4:7], s24 offen offset:3072 sc1
    s_add_u32 s24, s24, 4096
    v_mfma_f32_16x16x32_bf16 v[76:79], a[16:19], a[68:71], v[76:79]
    v_mfma_f32_16x16x32_bf16 v[92:95], a[24:27], a[68:71], v[92:95]
    ds_read_b64_tr_b16 a[16:17], v9 offset:7264
    v_mfma_f32_16x16x32_bf16 v[92:95], a[28:31], a[84:87], v[92:95]
    ds_read_b64_tr_b16 a[18:19], v9 offset:10848
    v_mfma_f32_16x16x32_bf16 v[88:91], a[28:31], a[80:83], v[88:91]
    ds_read_b64_tr_b16 a[20:21], v9 offset:21600
    v_mfma_f32_16x16x32_bf16 v[88:91], a[24:27], a[64:67], v[88:91]
    ds_read_b64_tr_b16 a[22:23], v9 offset:25184
    v_mfma_f32_16x16x32_bf16 v[84:87], a[24:27], a[60:63], v[84:87]
    v_mfma_f32_16x16x32_bf16 v[84:87], a[28:31], a[76:79], v[84:87]
    buffer_load_dwordx4 a[136:139], v1, s[4:7], s24 offen offset:0 sc1
    v_mfma_f32_16x16x32_bf16 v[80:83], a[28:31], a[72:75], v[80:83]
    v_mfma_f32_16x16x32_bf16 v[80:83], a[24:27], a[56:59], v[80:83]
    s_waitcnt lgkmcnt(15)
    v_mfma_f32_16x16x32_bf16 v[96:99], a[32:35], a[56:59], v[96:99]
    ds_read_b64_tr_b16 a[24:25], v9 offset:128
    v_mfma_f32_16x16x32_bf16 v[96:99], a[36:39], a[72:75], v[96:99]
    ds_read_b64_tr_b16 a[26:27], v9 offset:3712
    v_mfma_f32_16x16x32_bf16 v[100:103], a[36:39], a[76:79], v[100:103]
    ds_read_b64_tr_b16 a[28:29], v9 offset:14464
    v_mfma_f32_16x16x32_bf16 v[100:103], a[32:35], a[60:63], v[100:103]
    ds_read_b64_tr_b16 a[30:31], v9 offset:18048
    v_mfma_f32_16x16x32_bf16 v[104:107], a[32:35], a[64:67], v[104:107]
    buffer_load_dwordx4 a[140:143], v1, s[4:7], s24 offen offset:1024 sc1
    v_mfma_f32_16x16x32_bf16 v[104:107], a[36:39], a[80:83], v[104:107]
    v_mfma_f32_16x16x32_bf16 v[108:111], a[36:39], a[84:87], v[108:111]
    v_mfma_f32_16x16x32_bf16 v[108:111], a[32:35], a[68:71], v[108:111]
    v_mfma_f32_16x16x32_bf16 v[124:127], a[40:43], a[68:71], v[124:127]
    ds_read_b64_tr_b16 a[32:33], v9 offset:7296
    v_mfma_f32_16x16x32_bf16 v[124:127], a[44:47], a[84:87], v[124:127]
    ds_read_b64_tr_b16 a[34:35], v9 offset:10880
    v_mfma_f32_16x16x32_bf16 v[120:123], a[44:47], a[80:83], v[120:123]
    ds_read_b64_tr_b16 a[36:37], v9 offset:21632
    v_mfma_f32_16x16x32_bf16 v[120:123], a[40:43], a[64:67], v[120:123]
    ds_read_b64_tr_b16 a[38:39], v9 offset:25216
    v_mfma_f32_16x16x32_bf16 v[116:119], a[40:43], a[60:63], v[116:119]
    buffer_load_dwordx4 a[144:147], v1, s[4:7], s24 offen offset:2048 sc1
    v_mfma_f32_16x16x32_bf16 v[116:119], a[44:47], a[76:79], v[116:119]
    v_mfma_f32_16x16x32_bf16 v[112:115], a[44:47], a[72:75], v[112:115]
    v_mfma_f32_16x16x32_bf16 v[112:115], a[40:43], a[56:59], v[112:115]
    s_waitcnt lgkmcnt(15)
    v_mfma_f32_16x16x32_bf16 v[128:131], a[48:51], a[56:59], v[128:131]
    ds_read_b64_tr_b16 a[40:41], v9 offset:160
    v_mfma_f32_16x16x32_bf16 v[128:131], a[52:55], a[72:75], v[128:131]
    ds_read_b64_tr_b16 a[42:43], v9 offset:3744
    v_mfma_f32_16x16x32_bf16 v[132:135], a[52:55], a[76:79], v[132:135]
    ds_read_b64_tr_b16 a[44:45], v9 offset:14496
    v_mfma_f32_16x16x32_bf16 v[132:135], a[48:51], a[60:63], v[132:135]
    ds_read_b64_tr_b16 a[46:47], v9 offset:18080
    v_mfma_f32_16x16x32_bf16 v[136:139], a[48:51], a[64:67], v[136:139]
    buffer_load_dwordx4 a[148:151], v1, s[4:7], s24 offen offset:3072 sc1
    s_add_u32 s24, s24, 4096
    v_mfma_f32_16x16x32_bf16 v[136:139], a[52:55], a[80:83], v[136:139]
    v_mfma_f32_16x16x32_bf16 v[140:143], a[52:55], a[84:87], v[140:143]
    v_mfma_f32_16x16x32_bf16 v[140:143], a[48:51], a[68:71], v[140:143]
    s_add_u32 m0, s66, 28672
    v_mfma_f32_16x16x32_bf16 v[156:159], a[0:3], a[68:71], v[156:159]
    ds_read_b64_tr_b16 a[48:49], v9 offset:7328
    v_mfma_f32_16x16x32_bf16 v[156:159], a[4:7], a[84:87], v[156:159]
    ds_read_b64_tr_b16 a[50:51], v9 offset:10912
    v_mfma_f32_16x16x32_bf16 v[152:155], a[4:7], a[80:83], v[152:155]
    ds_read_b64_tr_b16 a[52:53], v9 offset:21664
    v_mfma_f32_16x16x32_bf16 v[152:155], a[0:3], a[64:67], v[152:155]
    ds_read_b64_tr_b16 a[54:55], v9 offset:25248
    v_mfma_f32_16x16x32_bf16 v[148:151], a[0:3], a[60:63], v[148:151]
    buffer_load_dwordx4 v2, s[8:11], s25 offen offset:0 lds
    v_mfma_f32_16x16x32_bf16 v[148:151], a[4:7], a[76:79], v[148:151]
    v_mfma_f32_16x16x32_bf16 v[144:147], a[4:7], a[72:75], v[144:147]
    buffer_load_dwordx4 v3, s[8:11], s25 offen offset:1024 lds
    v_mfma_f32_16x16x32_bf16 v[144:147], a[0:3], a[56:59], v[144:147]
    s_waitcnt lgkmcnt(15)
    v_mfma_f32_16x16x32_bf16 v[160:163], a[8:11], a[56:59], v[160:163]
    v_mfma_f32_16x16x32_bf16 v[160:163], a[12:15], a[72:75], v[160:163]
    v_mfma_f32_16x16x32_bf16 v[164:167], a[12:15], a[76:79], v[164:167]
    v_mfma_f32_16x16x32_bf16 v[164:167], a[8:11], a[60:63], v[164:167]
    s_waitcnt vmcnt(28) lgkmcnt(0)
    s_barrier
    v_mfma_f32_16x16x32_bf16 v[168:171], a[8:11], a[64:67], v[168:171]
    ds_read_b64_tr_b16 a[0:1], v11 offset:28672
    v_mfma_f32_16x16x32_bf16 v[168:171], a[12:15], a[80:83], v[168:171]
    ds_read_b64_tr_b16 a[2:3], v11 offset:32256
    v_mfma_f32_16x16x32_bf16 v[172:175], a[12:15], a[84:87], v[172:175]
    ds_read_b64_tr_b16 a[4:5], v11 offset:43008
    v_mfma_f32_16x16x32_bf16 v[172:175], a[8:11], a[68:71], v[172:175]
    ds_read_b64_tr_b16 a[6:7], v11 offset:46592
    v_mfma_f32_16x16x32_bf16 v[188:191], a[16:19], a[68:71], v[188:191]
    ds_read_b64_tr_b16 a[8:9], v11 offset:35840
    v_mfma_f32_16x16x32_bf16 v[188:191], a[20:23], a[84:87], v[188:191]
    ds_read_b64_tr_b16 a[10:11], v11 offset:39424
    v_mfma_f32_16x16x32_bf16 v[184:187], a[20:23], a[80:83], v[184:187]
    ds_read_b64_tr_b16 a[12:13], v11 offset:50176
    v_mfma_f32_16x16x32_bf16 v[184:187], a[16:19], a[64:67], v[184:187]
    ds_read_b64_tr_b16 a[14:15], v11 offset:53760
    v_mfma_f32_16x16x32_bf16 v[180:183], a[16:19], a[60:63], v[180:183]
    buffer_load_dwordx4 v4, s[8:11], s25 offen offset:2048 lds
    v_mfma_f32_16x16x32_bf16 v[180:183], a[20:23], a[76:79], v[180:183]
    v_mfma_f32_16x16x32_bf16 v[176:179], a[20:23], a[72:75], v[176:179]
    buffer_load_dwordx4 v5, s[8:11], s25 offen offset:3072 lds
    v_mfma_f32_16x16x32_bf16 v[176:179], a[16:19], a[56:59], v[176:179]
    v_mfma_f32_16x16x32_bf16 v[192:195], a[24:27], a[56:59], v[192:195]
    ds_read_b64_tr_b16 a[16:17], v9 offset:28672
    v_mfma_f32_16x16x32_bf16 v[192:195], a[28:31], a[72:75], v[192:195]
    ds_read_b64_tr_b16 a[18:19], v9 offset:32256
    v_mfma_f32_16x16x32_bf16 v[196:199], a[28:31], a[76:79], v[196:199]
    ds_read_b64_tr_b16 a[20:21], v9 offset:43008
    v_mfma_f32_16x16x32_bf16 v[196:199], a[24:27], a[60:63], v[196:199]
    ds_read_b64_tr_b16 a[22:23], v9 offset:46592
    v_mfma_f32_16x16x32_bf16 v[200:203], a[24:27], a[64:67], v[200:203]
    s_add_u32 m0, s66, 32768
    v_mfma_f32_16x16x32_bf16 v[200:203], a[28:31], a[80:83], v[200:203]
    buffer_load_dwordx4 v6, s[8:11], s25 offen offset:0 lds
    v_mfma_f32_16x16x32_bf16 v[204:207], a[28:31], a[84:87], v[204:207]
    v_mfma_f32_16x16x32_bf16 v[204:207], a[24:27], a[68:71], v[204:207]
    v_mfma_f32_16x16x32_bf16 v[220:223], a[32:35], a[68:71], v[220:223]
    ds_read_b64_tr_b16 a[24:25], v9 offset:35840
    v_mfma_f32_16x16x32_bf16 v[220:223], a[36:39], a[84:87], v[220:223]
    ds_read_b64_tr_b16 a[26:27], v9 offset:39424
    v_mfma_f32_16x16x32_bf16 v[216:219], a[36:39], a[80:83], v[216:219]
    ds_read_b64_tr_b16 a[28:29], v9 offset:50176
    v_mfma_f32_16x16x32_bf16 v[216:219], a[32:35], a[64:67], v[216:219]
    ds_read_b64_tr_b16 a[30:31], v9 offset:53760
    v_mfma_f32_16x16x32_bf16 v[212:215], a[32:35], a[60:63], v[212:215]
    buffer_load_dwordx4 v7, s[8:11], s25 offen offset:1024 lds
    v_mfma_f32_16x16x32_bf16 v[212:215], a[36:39], a[76:79], v[212:215]
    v_mfma_f32_16x16x32_bf16 v[208:211], a[36:39], a[72:75], v[208:211]
    v_mfma_f32_16x16x32_bf16 v[208:211], a[32:35], a[56:59], v[208:211]
    buffer_load_dwordx4 v8, s[8:11], s25 offen offset:2048 lds
    s_add_u32 s25, s25, 458752
    v_mfma_f32_16x16x32_bf16 v[224:227], a[40:43], a[56:59], v[224:227]
    ds_read_b64_tr_b16 a[32:33], v9 offset:28704
    v_mfma_f32_16x16x32_bf16 v[224:227], a[44:47], a[72:75], v[224:227]
    ds_read_b64_tr_b16 a[34:35], v9 offset:32288
    v_mfma_f32_16x16x32_bf16 v[228:231], a[44:47], a[76:79], v[228:231]
    ds_read_b64_tr_b16 a[36:37], v9 offset:43040
    v_mfma_f32_16x16x32_bf16 v[228:231], a[40:43], a[60:63], v[228:231]
    ds_read_b64_tr_b16 a[38:39], v9 offset:46624
    v_mfma_f32_16x16x32_bf16 v[232:235], a[40:43], a[64:67], v[232:235]
    v_mfma_f32_16x16x32_bf16 v[232:235], a[44:47], a[80:83], v[232:235]
    v_mfma_f32_16x16x32_bf16 v[236:239], a[44:47], a[84:87], v[236:239]
    v_mfma_f32_16x16x32_bf16 v[236:239], a[40:43], a[68:71], v[236:239]
    v_mfma_f32_16x16x32_bf16 v[252:255], a[48:51], a[68:71], v[252:255]
    ds_read_b64_tr_b16 a[40:41], v9 offset:35872
    v_mfma_f32_16x16x32_bf16 v[252:255], a[52:55], a[84:87], v[252:255]
    ds_read_b64_tr_b16 a[42:43], v9 offset:39456
    v_mfma_f32_16x16x32_bf16 v[248:251], a[52:55], a[80:83], v[248:251]
    ds_read_b64_tr_b16 a[44:45], v9 offset:50208
    v_mfma_f32_16x16x32_bf16 v[248:251], a[48:51], a[64:67], v[248:251]
    ds_read_b64_tr_b16 a[46:47], v9 offset:53792
    v_mfma_f32_16x16x32_bf16 v[244:247], a[48:51], a[60:63], v[244:247]
    v_mfma_f32_16x16x32_bf16 v[244:247], a[52:55], a[76:79], v[244:247]
    v_mfma_f32_16x16x32_bf16 v[240:243], a[52:55], a[72:75], v[240:243]
    v_mfma_f32_16x16x32_bf16 v[240:243], a[48:51], a[56:59], v[240:243]
    s_sub_u32 s27, s27, 1
    s_cmp_lg_u32 s27, 0
    s_cbranch_scc1 Lg1_loop
Lg1_tail:
    s_waitcnt vmcnt(23) lgkmcnt(15)
    v_mfma_f32_16x16x32_bf16 v[32:35], a[0:3], a[88:91], v[32:35]
    ds_read_b64_tr_b16 a[48:49], v9 offset:28736
    v_mfma_f32_16x16x32_bf16 v[32:35], a[4:7], a[104:107], v[32:35]
    ds_read_b64_tr_b16 a[50:51], v9 offset:32320
    v_mfma_f32_16x16x32_bf16 v[36:39], a[4:7], a[108:111], v[36:39]
    ds_read_b64_tr_b16 a[52:53], v9 offset:43072
    v_mfma_f32_16x16x32_bf16 v[36:39], a[0:3], a[92:95], v[36:39]
    ds_read_b64_tr_b16 a[54:55], v9 offset:46656
    v_mfma_f32_16x16x32_bf16 v[40:43], a[0:3], a[96:99], v[40:43]
    ds_read_b64_tr_b16 a[224:225], v14 offset:0
    v_mfma_f32_16x16x32_bf16 v[40:43], a[4:7], a[112:115], v[40:43]
    ds_read_b64_tr_b16 a[226:227], v14 offset:512
    v_mfma_f32_16x16x32_bf16 v[44:47], a[4:7], a[116:119], v[44:47]
    buffer_load_dwordx4 a[152:155], v1, s[4:7], s24 offen offset:0 sc1
    v_mfma_f32_16x16x32_bf16 v[44:47], a[0:3], a[100:103], v[44:47]
    v_mfma_f32_16x16x32_bf16 v[60:63], a[8:11], a[100:103], v[60:63]
    ds_read_b64_tr_b16 a[0:1], v9 offset:35904
    v_mfma_f32_16x16x32_bf16 v[60:63], a[12:15], a[116:119], v[60:63]
    ds_read_b64_tr_b16 a[2:3], v9 offset:39488
    v_mfma_f32_16x16x32_bf16 v[56:59], a[12:15], a[112:115], v[56:59]
    ds_read_b64_tr_b16 a[4:5], v9 offset:50240
    v_mfma_f32_16x16x32_bf16 v[56:59], a[8:11], a[96:99], v[56:59]
    ds_read_b64_tr_b16 a[6:7], v9 offset:53824
    v_mfma_f32_16x16x32_bf16 v[52:55], a[8:11], a[92:95], v[52:55]
    ds_read_b64_tr_b16 a[228:229], v14 offset:32
    v_mfma_f32_16x16x32_bf16 v[52:55], a[12:15], a[108:111], v[52:55]
    ds_read_b64_tr_b16 a[230:231], v14 offset:544
    v_mfma_f32_16x16x32_bf16 v[48:51], a[12:15], a[104:107], v[48:51]
    buffer_load_dwordx4 a[156:159], v1, s[4:7], s24 offen offset:1024 sc1
    v_mfma_f32_16x16x32_bf16 v[48:51], a[8:11], a[88:91], v[48:51]
    s_waitcnt lgkmcnt(15)
    v_mfma_f32_16x16x32_bf16 v[64:67], a[16:19], a[88:91], v[64:67]
    ds_read_b64_tr_b16 a[8:9], v9 offset:28768
    v_mfma_f32_16x16x32_bf16 v[64:67], a[20:23], a[104:107], v[64:67]
    ds_read_b64_tr_b16 a[10:11], v9 offset:32352
    v_mfma_f32_16x16x32_bf16 v[68:71], a[20:23], a[108:111], v[68:71]
    ds_read_b64_tr_b16 a[12:13], v9 offset:43104
    v_mfma_f32_16x16x32_bf16 v[68:71], a[16:19], a[92:95], v[68:71]
    ds_read_b64_tr_b16 a[14:15], v9 offset:46688
    v_mfma_f32_16x16x32_bf16 v[72:75], a[16:19], a[96:99], v[72:75]
    ds_read_b64_tr_b16 a[232:233], v14 offset:64
    v_mfma_f32_16x16x32_bf16 v[72:75], a[20:23], a[112:115], v[72:75]
    ds_read_b64_tr_b16 a[234:235], v14 offset:576
    v_mfma_f32_16x16x32_bf16 v[76:79], a[20:23], a[116:119], v[76:79]
    buffer_load_dwordx4 a[160:163], v1, s[4:7], s24 offen offset:2048 sc1
    v_mfma_f32_16x16x32_bf16 v[76:79], a[16:19], a[100:103], v[76:79]
    v_mfma_f32_16x16x32_bf16 v[92:95], a[24:27], a[100:103], v[92:95]
    ds_read_b64_tr_b16 a[16:17], v9 offset:35936
    v_mfma_f32_16x16x32_bf16 v[92:95], a[28:31], a[116:119], v[92:95]
    ds_read_b64_tr_b16 a[18:19], v9 offset:39520
    v_mfma_f32_16x16x32_bf16 v[88:91], a[28:31], a[112:115], v[88:91]
    ds_read_b64_tr_b16 a[20:21], v9 offset:50272
    v_mfma_f32_16x16x32_bf16 v[88:91], a[24:27], a[96:99], v[88:91]
    ds_read_b64_tr_b16 a[22:23], v9 offset:53856
    v_mfma_f32_16x16x32_bf16 v[84:87], a[24:27], a[92:95], v[84:87]
    ds_read_b64_tr_b16 a[236:237], v14 offset:96
    v_mfma_f32_16x16x32_bf16 v[84:87], a[28:31], a[108:111], v[84:87]
    ds_read_b64_tr_b16 a[238:239], v14 offset:608
    v_mfma_f32_16x16x32_bf16 v[80:83], a[28:31], a[104:107], v[80:83]
    buffer_load_dwordx4 a[164:167], v1, s[4:7], s24 offen offset:3072 sc1
    s_add_u32 s24, s24, 4096
    v_mfma_f32_16x16x32_bf16 v[80:83], a[24:27], a[88:91], v[80:83]
    v_mfma_f32_16x16x32_bf16 v[96:99], a[32:35], a[88:91], v[96:99]
    ds_read_b64_tr_b16 a[24:25], v9 offset:28800
    v_mfma_f32_16x16x32_bf16 v[96:99], a[36:39], a[104:107], v[96:99]
    ds_read_b64_tr_b16 a[26:27], v9 offset:32384
    v_mfma_f32_16x16x32_bf16 v[100:103], a[36:39], a[108:111], v[100:103]
    ds_read_b64_tr_b16 a[28:29], v9 offset:43136
    v_mfma_f32_16x16x32_bf16 v[100:103], a[32:35], a[92:95], v[100:103]
    ds_read_b64_tr_b16 a[30:31], v9 offset:46720
    v_mfma_f32_16x16x32_bf16 v[104:107], a[32:35], a[96:99], v[104:107]
    ds_read_b64_tr_b16 a[240:241], v14 offset:128
    v_mfma_f32_16x16x32_bf16 v[104:107], a[36:39], a[112:115], v[104:107]
    ds_read_b64_tr_b16 a[242:243], v14 offset:640
    v_mfma_f32_16x16x32_bf16 v[108:111], a[36:39], a[116:119], v[108:111]
    buffer_load_dwordx4 a[168:171], v1, s[4:7], s24 offen offset:0 sc1
    v_mfma_f32_16x16x32_bf16 v[108:111], a[32:35], a[100:103], v[108:111]
    s_waitcnt lgkmcnt(15)
    v_mfma_f32_16x16x32_bf16 v[124:127], a[40:43], a[100:103], v[124:127]
    ds_read_b64_tr_b16 a[32:33], v9 offset:35968
    v_mfma_f32_16x16x32_bf16 v[124:127], a[44:47], a[116:119], v[124:127]
    ds_read_b64_tr_b16 a[34:35], v9 offset:39552
    v_mfma_f32_16x16x32_bf16 v[120:123], a[44:47], a[112:115], v[120:123]
    ds_read_b64_tr_b16 a[36:37], v9 offset:50304
    v_mfma_f32_16x16x32_bf16 v[120:123], a[40:43], a[96:99], v[120:123]
    ds_read_b64_tr_b16 a[38:39], v9 offset:53888
    v_mfma_f32_16x16x32_bf16 v[116:119], a[40:43], a[92:95], v[116:119]
    ds_read_b64_tr_b16 a[244:245], v14 offset:160
    v_mfma_f32_16x16x32_bf16 v[116:119], a[44:47], a[108:111], v[116:119]
    ds_read_b64_tr_b16 a[246:247], v14 offset:672
    v_mfma_f32_16x16x32_bf16 v[112:115], a[44:47], a[104:107], v[112:115]
    buffer_load_dwordx4 a[172:175], v1, s[4:7], s24 offen offset:1024 sc1
    v_mfma_f32_16x16x32_bf16 v[112:115], a[40:43], a[88:91], v[112:115]
    v_mfma_f32_16x16x32_bf16 v[128:131], a[48:51], a[88:91], v[128:131]
    ds_read_b64_tr_b16 a[40:41], v9 offset:28832
    v_mfma_f32_16x16x32_bf16 v[128:131], a[52:55], a[104:107], v[128:131]
    ds_read_b64_tr_b16 a[42:43], v9 offset:32416
    v_mfma_f32_16x16x32_bf16 v[132:135], a[52:55], a[108:111], v[132:135]
    ds_read_b64_tr_b16 a[44:45], v9 offset:43168
    v_mfma_f32_16x16x32_bf16 v[132:135], a[48:51], a[92:95], v[132:135]
    ds_read_b64_tr_b16 a[46:47], v9 offset:46752
    v_mfma_f32_16x16x32_bf16 v[136:139], a[48:51], a[96:99], v[136:139]
    ds_read_b64_tr_b16 a[248:249], v14 offset:192
    v_mfma_f32_16x16x32_bf16 v[136:139], a[52:55], a[112:115], v[136:139]
    ds_read_b64_tr_b16 a[250:251], v14 offset:704
    v_mfma_f32_16x16x32_bf16 v[140:143], a[52:55], a[116:119], v[140:143]
    buffer_load_dwordx4 a[176:179], v1, s[4:7], s24 offen offset:2048 sc1
    v_mfma_f32_16x16x32_bf16 v[140:143], a[48:51], a[100:103], v[140:143]
    v_mfma_f32_16x16x32_bf16 v[156:159], a[0:3], a[100:103], v[156:159]
    ds_read_b64_tr_b16 a[48:49], v9 offset:36000
    v_mfma_f32_16x16x32_bf16 v[156:159], a[4:7], a[116:119], v[156:159]
    ds_read_b64_tr_b16 a[50:51], v9 offset:39584
    v_mfma_f32_16x16x32_bf16 v[152:155], a[4:7], a[112:115], v[152:155]
    ds_read_b64_tr_b16 a[52:53], v9 offset:50336
    v_mfma_f32_16x16x32_bf16 v[152:155], a[0:3], a[96:99], v[152:155]
    ds_read_b64_tr_b16 a[54:55], v9 offset:53920
    v_mfma_f32_16x16x32_bf16 v[148:151], a[0:3], a[92:95], v[148:151]
    ds_read_b64_tr_b16 a[252:253], v14 offset:224
    v_mfma_f32_16x16x32_bf16 v[148:151], a[4:7], a[108:111], v[148:151]
    ds_read_b64_tr_b16 a[254:255], v14 offset:736
    v_mfma_f32_16x16x32_bf16 v[144:147], a[4:7], a[104:107], v[144:147]
    buffer_load_dwordx4 a[180:183], v1, s[4:7], s24 offen offset:3072 sc1
    s_add_u32 s24, s24, 4096
    v_mfma_f32_16x16x32_bf16 v[144:147], a[0:3], a[88:91], v[144:147]
    s_waitcnt lgkmcnt(15)
    v_mfma_f32_16x16x32_bf16 v[160:163], a[8:11], a[88:91], v[160:163]
    global_load_dword a184, v[18:19], off
    v_mfma_f32_16x16x32_bf16 v[160:163], a[12:15], a[104:107], v[160:163]
    v_mfma_f32_16x16x32_bf16 v[164:167], a[12:15], a[108:111], v[164:167]
    v_mfma_f32_16x16x32_bf16 v[164:167], a[8:11], a[92:95], v[164:167]
    s_waitcnt vmcnt(9) lgkmcnt(0)
    s_barrier
    v_mfma_f32_16x16x32_bf16 v[168:171], a[8:11], a[96:99], v[168:171]
    ds_read_b64_tr_b16 a[0:1], v12 offset:0
    v_mfma_f32_16x16x32_bf16 v[168:171], a[12:15], a[112:115], v[168:171]
    ds_read_b64_tr_b16 a[2:3], v12 offset:3584
    v_mfma_f32_16x16x32_bf16 v[172:175], a[12:15], a[116:119], v[172:175]
    ds_read_b64_tr_b16 a[4:5], v12 offset:14336
    v_mfma_f32_16x16x32_bf16 v[172:175], a[8:11], a[100:103], v[172:175]
    ds_read_b64_tr_b16 a[6:7], v12 offset:17920
    v_mfma_f32_16x16x32_bf16 v[188:191], a[16:19], a[100:103], v[188:191]
    ds_read_b64_tr_b16 a[8:9], v12 offset:28672
    v_mfma_f32_16x16x32_bf16 v[188:191], a[20:23], a[116:119], v[188:191]
    ds_read_b64_tr_b16 a[10:11], v12 offset:32256
    v_mfma_f32_16x16x32_bf16 v[184:187], a[20:23], a[112:115], v[184:187]
    ds_read_b64_tr_b16 a[12:13], v12 offset:43008
    v_mfma_f32_16x16x32_bf16 v[184:187], a[16:19], a[96:99], v[184:187]
    ds_read_b64_tr_b16 a[14:15], v12 offset:46592
    v_mfma_f32_16x16x32_bf16 v[180:183], a[16:19], a[92:95], v[180:183]
    v_mfma_f32_16x16x32_bf16 v[180:183], a[20:23], a[108:111], v[180:183]
    v_mfma_f32_16x16x32_bf16 v[176:179], a[20:23], a[104:107], v[176:179]
    v_mfma_f32_16x16x32_bf16 v[176:179], a[16:19], a[88:91], v[176:179]
    v_mfma_f32_16x16x32_bf16 v[192:195], a[24:27], a[88:91], v[192:195]
    ds_read_b64_tr_b16 a[16:17], v12 offset:7168
    v_mfma_f32_16x16x32_bf16 v[192:195], a[28:31], a[104:107], v[192:195]
    ds_read_b64_tr_b16 a[18:19], v12 offset:10752
    v_mfma_f32_16x16x32_bf16 v[196:199], a[28:31], a[108:111], v[196:199]
    ds_read_b64_tr_b16 a[20:21], v12 offset:21504
    v_mfma_f32_16x16x32_bf16 v[196:199], a[24:27], a[92:95], v[196:199]
    ds_read_b64_tr_b16 a[22:23], v12 offset:25088
    v_mfma_f32_16x16x32_bf16 v[200:203], a[24:27], a[96:99], v[200:203]
    buffer_store_dwordx4 a[224:227], v1, s[72:75], s76 offen offset:0 sc1
    v_mfma_f32_16x16x32_bf16 v[200:203], a[28:31], a[112:115], v[200:203]
    v_mfma_f32_16x16x32_bf16 v[204:207], a[28:31], a[116:119], v[204:207]
    buffer_store_dwordx4 a[228:231], v1, s[72:75], s76 offen offset:1024 sc1
    v_mfma_f32_16x16x32_bf16 v[204:207], a[24:27], a[100:103], v[204:207]
    v_mfma_f32_16x16x32_bf16 v[220:223], a[32:35], a[100:103], v[220:223]
    ds_read_b64_tr_b16 a[24:25], v12 offset:35840
    v_mfma_f32_16x16x32_bf16 v[220:223], a[36:39], a[116:119], v[220:223]
    ds_read_b64_tr_b16 a[26:27], v12 offset:39424
    v_mfma_f32_16x16x32_bf16 v[216:219], a[36:39], a[112:115], v[216:219]
    ds_read_b64_tr_b16 a[28:29], v12 offset:50176
    v_mfma_f32_16x16x32_bf16 v[216:219], a[32:35], a[96:99], v[216:219]
    ds_read_b64_tr_b16 a[30:31], v12 offset:53760
    v_mfma_f32_16x16x32_bf16 v[212:215], a[32:35], a[92:95], v[212:215]
    buffer_store_dwordx4 a[232:235], v1, s[72:75], s76 offen offset:2048 sc1
    v_mfma_f32_16x16x32_bf16 v[212:215], a[36:39], a[108:111], v[212:215]
    v_mfma_f32_16x16x32_bf16 v[208:211], a[36:39], a[104:107], v[208:211]
    buffer_store_dwordx4 a[236:239], v1, s[72:75], s76 offen offset:3072 sc1
    v_mfma_f32_16x16x32_bf16 v[208:211], a[32:35], a[88:91], v[208:211]
    v_mfma_f32_16x16x32_bf16 v[224:227], a[40:43], a[88:91], v[224:227]
    ds_read_b64_tr_b16 a[32:33], v10 offset:0
    v_mfma_f32_16x16x32_bf16 v[224:227], a[44:47], a[104:107], v[224:227]
    ds_read_b64_tr_b16 a[34:35], v10 offset:3584
    v_mfma_f32_16x16x32_bf16 v[228:231], a[44:47], a[108:111], v[228:231]
    ds_read_b64_tr_b16 a[36:37], v10 offset:14336
    v_mfma_f32_16x16x32_bf16 v[228:231], a[40:43], a[92:95], v[228:231]
    ds_read_b64_tr_b16 a[38:39], v10 offset:17920
    v_mfma_f32_16x16x32_bf16 v[232:235], a[40:43], a[96:99], v[232:235]
    buffer_store_dwordx4 a[240:243], v1, s[72:75], s77 offen offset:0 sc1
    v_mfma_f32_16x16x32_bf16 v[232:235], a[44:47], a[112:115], v[232:235]
    v_mfma_f32_16x16x32_bf16 v[236:239], a[44:47], a[116:119], v[236:239]
    buffer_store_dwordx4 a[244:247], v1, s[72:75], s77 offen offset:1024 sc1
    v_mfma_f32_16x16x32_bf16 v[236:239], a[40:43], a[100:103], v[236:239]
    v_mfma_f32_16x16x32_bf16 v[252:255], a[48:51], a[100:103], v[252:255]
    ds_read_b64_tr_b16 a[40:41], v10 offset:28672
    v_mfma_f32_16x16x32_bf16 v[252:255], a[52:55], a[116:119], v[252:255]
    ds_read_b64_tr_b16 a[42:43], v10 offset:32256
    v_mfma_f32_16x16x32_bf16 v[248:251], a[52:55], a[112:115], v[248:251]
    ds_read_b64_tr_b16 a[44:45], v10 offset:43008
    v_mfma_f32_16x16x32_bf16 v[248:251], a[48:51], a[96:99], v[248:251]
    ds_read_b64_tr_b16 a[46:47], v10 offset:46592
    v_mfma_f32_16x16x32_bf16 v[244:247], a[48:51], a[92:95], v[244:247]
    buffer_store_dwordx4 a[248:251], v1, s[72:75], s77 offen offset:2048 sc1
    v_mfma_f32_16x16x32_bf16 v[244:247], a[52:55], a[108:111], v[244:247]
    v_mfma_f32_16x16x32_bf16 v[240:243], a[52:55], a[104:107], v[240:243]
    buffer_store_dwordx4 a[252:255], v1, s[72:75], s77 offen offset:3072 sc1
    v_mfma_f32_16x16x32_bf16 v[240:243], a[48:51], a[88:91], v[240:243]
    s_waitcnt lgkmcnt(15)
    v_mfma_f32_16x16x32_bf16 v[32:35], a[0:3], a[120:123], v[32:35]
    ds_read_b64_tr_b16 a[48:49], v10 offset:7168
    v_mfma_f32_16x16x32_bf16 v[32:35], a[4:7], a[136:139], v[32:35]
    ds_read_b64_tr_b16 a[50:51], v10 offset:10752
    v_mfma_f32_16x16x32_bf16 v[36:39], a[4:7], a[140:143], v[36:39]
    ds_read_b64_tr_b16 a[52:53], v10 offset:21504
    v_mfma_f32_16x16x32_bf16 v[36:39], a[0:3], a[124:127], v[36:39]
    ds_read_b64_tr_b16 a[54:55], v10 offset:25088
    v_mfma_f32_16x16x32_bf16 v[40:43], a[0:3], a[128:131], v[40:43]
    buffer_store_dwordx4 a[192:195], v17, s[28:31], s38 offen sc1
    s_add_u32 s38, s38, 8192
    v_mfma_f32_16x16x32_bf16 v[40:43], a[4:7], a[144:147], v[40:43]
    v_mfma_f32_16x16x32_bf16 v[44:47], a[4:7], a[148:151], v[44:47]
    buffer_store_dwordx4 a[196:199], v17, s[28:31], s38 offen sc1
    s_add_u32 s38, s38, 8192
    v_mfma_f32_16x16x32_bf16 v[44:47], a[0:3], a[132:135], v[44:47]
    s_waitcnt vmcnt(11)
    v_mfma_f32_16x16x32_bf16 v[44:47], a[8:11], a[164:167], v[44:47]
    ds_read_b64_tr_b16 a[0:1], v10 offset:35840
    v_mfma_f32_16x16x32_bf16 v[44:47], a[12:15], a[180:183], v[44:47]
    ds_read_b64_tr_b16 a[2:3], v10 offset:39424
    v_mfma_f32_16x16x32_bf16 v[40:43], a[12:15], a[176:179], v[40:43]
    ds_read_b64_tr_b16 a[4:5], v10 offset:50176
    v_mfma_f32_16x16x32_bf16 v[40:43], a[8:11], a[160:163], v[40:43]
    ds_read_b64_tr_b16 a[6:7], v10 offset:53760
    v_mfma_f32_16x16x32_bf16 v[36:39], a[8:11], a[156:159], v[36:39]
    buffer_store_dwordx4 a[200:203], v17, s[28:31], s38 offen sc1
    s_add_u32 s38, s38, 8192
    v_mfma_f32_16x16x32_bf16 v[36:39], a[12:15], a[172:175], v[36:39]
    v_mfma_f32_16x16x32_bf16 v[32:35], a[12:15], a[168:171], v[32:35]
    buffer_store_dwordx4 a[204:207], v17, s[28:31], s38 offen sc1
    s_add_u32 s38, s38, 8192
    v_mfma_f32_16x16x32_bf16 v[32:35], a[8:11], a[152:155], v[32:35]
    s_nop 7
    v_pk_mul_f32 v[2:3], v[32:33], v[32:33]
    v_pk_mul_f32 v[4:5], v[34:35], v[34:35]
    v_pk_mul_f32 v[6:7], v[36:37], v[36:37]
    v_pk_mul_f32 v[20:21], v[38:39], v[38:39]
    v_pk_fma_f32 v[2:3], v[2:3], s[92:93], v[22:23]
    v_pk_fma_f32 v[4:5], v[4:5], s[92:93], v[22:23]
    v_pk_fma_f32 v[6:7], v[6:7], s[92:93], v[22:23]
    v_pk_fma_f32 v[20:21], v[20:21], s[92:93], v[22:23]
    v_pk_mul_f32 v[2:3], v[2:3], v[32:33]
    v_pk_mul_f32 v[4:5], v[4:5], v[34:35]
    v_pk_mul_f32 v[6:7], v[6:7], v[36:37]
    v_pk_mul_f32 v[20:21], v[20:21], v[38:39]
    v_pk_mul_f32 v[24:25], v[40:41], v[40:41]
    v_pk_mul_f32 v[26:27], v[42:43], v[42:43]
    v_pk_mul_f32 v[28:29], v[44:45], v[44:45]
    v_pk_mul_f32 v[30:31], v[46:47], v[46:47]
    v_pk_fma_f32 v[24:25], v[24:25], s[92:93], v[22:23]
    v_pk_fma_f32 v[26:27], v[26:27], s[92:93], v[22:23]
    v_pk_fma_f32 v[28:29], v[28:29], s[92:93], v[22:23]
    v_pk_fma_f32 v[30:31], v[30:31], s[92:93], v[22:23]
    v_pk_mul_f32 v[24:25], v[24:25], v[40:41]
    v_pk_mul_f32 v[26:27], v[26:27], v[42:43]
    v_pk_mul_f32 v[28:29], v[28:29], v[44:45]
    v_pk_mul_f32 v[30:31], v[30:31], v[46:47]
    s_waitcnt lgkmcnt(15)
    v_mfma_f32_16x16x32_bf16 v[48:51], a[16:19], a[120:123], v[48:51]
    ds_read_b64_tr_b16 a[8:9], v10 offset:32
    v_exp_f32 v2, v2
    v_mfma_f32_16x16x32_bf16 v[48:51], a[20:23], a[136:139], v[48:51]
    ds_read_b64_tr_b16 a[10:11], v10 offset:3616
    v_exp_f32 v3, v3
    v_mfma_f32_16x16x32_bf16 v[52:55], a[20:23], a[140:143], v[52:55]
    ds_read_b64_tr_b16 a[12:13], v10 offset:14368
    v_exp_f32 v4, v4
    v_add_f32 v2, 1.0, v2
    v_mfma_f32_16x16x32_bf16 v[52:55], a[16:19], a[124:127], v[52:55]
    ds_read_b64_tr_b16 a[14:15], v10 offset:17952
    v_exp_f32 v5, v5
    v_add_f32 v3, 1.0, v3
    v_mfma_f32_16x16x32_bf16 v[56:59], a[16:19], a[128:131], v[56:59]
    v_exp_f32 v6, v6
    v_add_f32 v4, 1.0, v4
    v_mfma_f32_16x16x32_bf16 v[56:59], a[20:23], a[144:147], v[56:59]
    v_exp_f32 v7, v7
    v_mfma_f32_16x16x32_bf16 v[60:63], a[20:23], a[148:151], v[60:63]
    v_add_f32 v5, 1.0, v5
    v_exp_f32 v20, v20
    v_mfma_f32_16x16x32_bf16 v[60:63], a[16:19], a[132:135], v[60:63]
    v_add_f32 v6, 1.0, v6
    v_mfma_f32_16x16x32_bf16 v[60:63], a[24:27], a[164:167], v[60:63]
    ds_read_b64_tr_b16 a[16:17], v10 offset:28704
    v_exp_f32 v21, v21
    v_add_f32 v7, 1.0, v7
    v_mfma_f32_16x16x32_bf16 v[60:63], a[28:31], a[180:183], v[60:63]
    ds_read_b64_tr_b16 a[18:19], v10 offset:32288
    v_exp_f32 v24, v24
    v_add_f32 v20, 1.0, v20
    v_mfma_f32_16x16x32_bf16 v[56:59], a[28:31], a[176:179], v[56:59]
    ds_read_b64_tr_b16 a[20:21], v10 offset:43040
    v_exp_f32 v25, v25
    v_mfma_f32_16x16x32_bf16 v[56:59], a[24:27], a[160:163], v[56:59]
    ds_read_b64_tr_b16 a[22:23], v10 offset:46624
    v_add_f32 v21, 1.0, v21
    v_exp_f32 v26, v26
    v_mfma_f32_16x16x32_bf16 v[52:55], a[24:27], a[156:159], v[52:55]
    v_add_f32 v24, 1.0, v24
    v_exp_f32 v27, v27
    v_mfma_f32_16x16x32_bf16 v[52:55], a[28:31], a[172:175], v[52:55]
    v_add_f32 v25, 1.0, v25
    v_mfma_f32_16x16x32_bf16 v[48:51], a[28:31], a[168:171], v[48:51]
    v_exp_f32 v28, v28
    v_add_f32 v26, 1.0, v26
    v_mfma_f32_16x16x32_bf16 v[48:51], a[24:27], a[152:155], v[48:51]
    v_exp_f32 v29, v29
    v_add_f32 v27, 1.0, v27
    s_waitcnt lgkmcnt(15)
    v_mfma_f32_16x16x32_bf16 v[64:67], a[32:35], a[120:123], v[64:67]
    ds_read_b64_tr_b16 a[24:25], v10 offset:7200
    v_exp_f32 v30, v30
    v_mfma_f32_16x16x32_bf16 v[64:67], a[36:39], a[136:139], v[64:67]
    ds_read_b64_tr_b16 a[26:27], v10 offset:10784
    v_add_f32 v28, 1.0, v28
    v_exp_f32 v31, v31
    v_mfma_f32_16x16x32_bf16 v[68:71], a[36:39], a[140:143], v[68:71]
    ds_read_b64_tr_b16 a[28:29], v10 offset:21536
    v_add_f32 v29, 1.0, v29
    v_add_f32 v30, 1.0, v30
    v_mfma_f32_16x16x32_bf16 v[68:71], a[32:35], a[124:127], v[68:71]
    ds_read_b64_tr_b16 a[30:31], v10 offset:25120
    v_add_f32 v31, 1.0, v31
    v_rcp_f32 v2, v2
    v_mfma_f32_16x16x32_bf16 v[72:75], a[32:35], a[128:131], v[72:75]
    v_rcp_f32 v3, v3
    v_mfma_f32_16x16x32_bf16 v[72:75], a[36:39], a[144:147], v[72:75]
    v_rcp_f32 v4, v4
    v_mfma_f32_16x16x32_bf16 v[76:79], a[36:39], a[148:151], v[76:79]
    v_rcp_f32 v5, v5
    v_rcp_f32 v6, v6
    v_mfma_f32_16x16x32_bf16 v[76:79], a[32:35], a[132:135], v[76:79]
    v_rcp_f32 v7, v7
    v_mfma_f32_16x16x32_bf16 v[76:79], a[40:43], a[164:167], v[76:79]
    ds_read_b64_tr_b16 a[32:33], v10 offset:35872
    v_rcp_f32 v20, v20
    v_mfma_f32_16x16x32_bf16 v[76:79], a[44:47], a[180:183], v[76:79]
    ds_read_b64_tr_b16 a[34:35], v10 offset:39456
    v_rcp_f32 v21, v21
    v_mfma_f32_16x16x32_bf16 v[72:75], a[44:47], a[176:179], v[72:75]
    ds_read_b64_tr_b16 a[36:37], v10 offset:50208
    v_rcp_f32 v24, v24
    v_mfma_f32_16x16x32_bf16 v[72:75], a[40:43], a[160:163], v[72:75]
    ds_read_b64_tr_b16 a[38:39], v10 offset:53792
    v_rcp_f32 v25, v25
    v_rcp_f32 v26, v26
    v_mfma_f32_16x16x32_bf16 v[68:71], a[40:43], a[156:159], v[68:71]
    v_rcp_f32 v27, v27
    v_mfma_f32_16x16x32_bf16 v[68:71], a[44:47], a[172:175], v[68:71]
    v_rcp_f32 v28, v28
    v_mfma_f32_16x16x32_bf16 v[64:67], a[44:47], a[168:171], v[64:67]
    v_rcp_f32 v29, v29
    v_rcp_f32 v30, v30
    v_mfma_f32_16x16x32_bf16 v[64:67], a[40:43], a[152:155], v[64:67]
    v_rcp_f32 v31, v31
    s_nop 0
    s_waitcnt vmcnt(0)
    buffer_atomic_add v16, v1, s[80:83], 0 offen sc1
    v_pk_mul_f32 v[32:33], v[32:33], v[48:49]
    v_pk_mul_f32 v[34:35], v[34:35], v[50:51]
    v_pk_mul_f32 v[36:37], v[36:37], v[52:53]
    v_pk_mul_f32 v[38:39], v[38:39], v[54:55]
    v_pk_mul_f32 v[32:33], v[32:33], v[2:3]
    v_pk_mul_f32 v[34:35], v[34:35], v[4:5]
    v_pk_mul_f32 v[36:37], v[36:37], v[6:7]
    v_pk_mul_f32 v[38:39], v[38:39], v[20:21]
    v_cvt_pk_bf16_f32 v48, v32, v33
    v_cvt_pk_bf16_f32 v49, v34, v35
    v_cvt_pk_bf16_f32 v52, v36, v37
    v_cvt_pk_bf16_f32 v53, v38, v39
    v_pk_mul_f32 v[40:41], v[40:41], v[56:57]
    v_pk_mul_f32 v[42:43], v[42:43], v[58:59]
    v_pk_mul_f32 v[44:45], v[44:45], v[60:61]
    v_pk_mul_f32 v[46:47], v[46:47], v[62:63]
    v_pk_mul_f32 v[40:41], v[40:41], v[24:25]
    v_pk_mul_f32 v[42:43], v[42:43], v[26:27]
    v_pk_mul_f32 v[44:45], v[44:45], v[28:29]
    v_pk_mul_f32 v[46:47], v[46:47], v[30:31]
    v_cvt_pk_bf16_f32 v56, v40, v41
    v_cvt_pk_bf16_f32 v57, v42, v43
    v_cvt_pk_bf16_f32 v60, v44, v45
    v_cvt_pk_bf16_f32 v61, v46, v47
    buffer_store_dwordx2 v[48:49], v1, s[88:91], s36 offen offset:0 sc1
    buffer_store_dwordx2 v[52:53], v1, s[88:91], s36 offen offset:1024 sc1
    buffer_store_dwordx2 v[56:57], v1, s[88:91], s37 offen offset:0 sc1
    buffer_store_dwordx2 v[60:61], v1, s[88:91], s37 offen offset:1024 sc1
    v_pk_mul_f32 v[32:33], v[64:65], v[64:65]
    v_pk_mul_f32 v[34:35], v[66:67], v[66:67]
    v_pk_mul_f32 v[36:37], v[68:69], v[68:69]
    v_pk_mul_f32 v[38:39], v[70:71], v[70:71]
    v_pk_fma_f32 v[32:33], v[32:33], s[92:93], v[22:23]
    v_pk_fma_f32 v[34:35], v[34:35], s[92:93], v[22:23]
    v_pk_fma_f32 v[36:37], v[36:37], s[92:93], v[22:23]
    v_pk_fma_f32 v[38:39], v[38:39], s[92:93], v[22:23]
    v_pk_mul_f32 v[32:33], v[32:33], v[64:65]
    v_pk_mul_f32 v[34:35], v[34:35], v[66:67]
    v_pk_mul_f32 v[36:37], v[36:37], v[68:69]
    v_pk_mul_f32 v[38:39], v[38:39], v[70:71]
    v_pk_mul_f32 v[40:41], v[72:73], v[72:73]
    v_pk_mul_f32 v[42:43], v[74:75], v[74:75]
    v_pk_mul_f32 v[44:45], v[76:77], v[76:77]
    v_pk_mul_f32 v[46:47], v[78:79], v[78:79]
    v_pk_fma_f32 v[40:41], v[40:41], s[92:93], v[22:23]
    v_pk_fma_f32 v[42:43], v[42:43], s[92:93], v[22:23]
    v_pk_fma_f32 v[44:45], v[44:45], s[92:93], v[22:23]
    v_pk_fma_f32 v[46:47], v[46:47], s[92:93], v[22:23]
    v_pk_mul_f32 v[40:41], v[40:41], v[72:73]
    v_pk_mul_f32 v[42:43], v[42:43], v[74:75]
    v_pk_mul_f32 v[44:45], v[44:45], v[76:77]
    v_pk_mul_f32 v[46:47], v[46:47], v[78:79]
    s_waitcnt lgkmcnt(15)
    v_mfma_f32_16x16x32_bf16 v[80:83], a[48:51], a[120:123], v[80:83]
    ds_read_b64_tr_b16 a[40:41], v10 offset:64
    v_exp_f32 v32, v32
    v_mfma_f32_16x16x32_bf16 v[80:83], a[52:55], a[136:139], v[80:83]
    ds_read_b64_tr_b16 a[42:43], v10 offset:3648
    v_exp_f32 v33, v33
    v_mfma_f32_16x16x32_bf16 v[84:87], a[52:55], a[140:143], v[84:87]
    ds_read_b64_tr_b16 a[44:45], v10 offset:14400
    v_exp_f32 v34, v34
    v_add_f32 v32, 1.0, v32
    v_mfma_f32_16x16x32_bf16 v[84:87], a[48:51], a[124:127], v[84:87]
    ds_read_b64_tr_b16 a[46:47], v10 offset:17984
    v_exp_f32 v35, v35
    v_add_f32 v33, 1.0, v33
    v_mfma_f32_16x16x32_bf16 v[88:91], a[48:51], a[128:131], v[88:91]
    v_exp_f32 v36, v36
    v_add_f32 v34, 1.0, v34
    v_mfma_f32_16x16x32_bf16 v[88:91], a[52:55], a[144:147], v[88:91]
    v_exp_f32 v37, v37
    v_mfma_f32_16x16x32_bf16 v[92:95], a[52:55], a[148:151], v[92:95]
    v_add_f32 v35, 1.0, v35
    v_exp_f32 v38, v38
    v_mfma_f32_16x16x32_bf16 v[92:95], a[48:51], a[132:135], v[92:95]
    v_add_f32 v36, 1.0, v36
    v_mfma_f32_16x16x32_bf16 v[92:95], a[0:3], a[164:167], v[92:95]
    ds_read_b64_tr_b16 a[48:49], v10 offset:28736
    v_exp_f32 v39, v39
    v_add_f32 v37, 1.0, v37
    v_mfma_f32_16x16x32_bf16 v[92:95], a[4:7], a[180:183], v[92:95]
    ds_read_b64_tr_b16 a[50:51], v10 offset:32320
    v_exp_f32 v40, v40
    v_add_f32 v38, 1.0, v38
    v_mfma_f32_16x16x32_bf16 v[88:91], a[4:7], a[176:179], v[88:91]
    ds_read_b64_tr_b16 a[52:53], v10 offset:43072
    v_exp_f32 v41, v41
    v_mfma_f32_16x16x32_bf16 v[88:91], a[0:3], a[160:163], v[88:91]
    ds_read_b64_tr_b16 a[54:55], v10 offset:46656
    v_add_f32 v39, 1.0, v39
    v_exp_f32 v42, v42
    v_mfma_f32_16x16x32_bf16 v[84:87], a[0:3], a[156:159], v[84:87]
    v_add_f32 v40, 1.0, v40
    v_exp_f32 v43, v43
    v_mfma_f32_16x16x32_bf16 v[84:87], a[4:7], a[172:175], v[84:87]
    v_add_f32 v41, 1.0, v41
    v_mfma_f32_16x16x32_bf16 v[80:83], a[4:7], a[168:171], v[80:83]
    v_exp_f32 v44, v44
    v_add_f32 v42, 1.0, v42
    v_mfma_f32_16x16x32_bf16 v[80:83], a[0:3], a[152:155], v[80:83]
    v_exp_f32 v45, v45
    v_add_f32 v43, 1.0, v43
    s_waitcnt lgkmcnt(15)
    v_mfma_f32_16x16x32_bf16 v[96:99], a[8:11], a[120:123], v[96:99]
    ds_read_b64_tr_b16 a[0:1], v10 offset:7232
    v_exp_f32 v46, v46
    v_mfma_f32_16x16x32_bf16 v[96:99], a[12:15], a[136:139], v[96:99]
    ds_read_b64_tr_b16 a[2:3], v10 offset:10816
    v_add_f32 v44, 1.0, v44
    v_exp_f32 v47, v47
    v_mfma_f32_16x16x32_bf16 v[100:103], a[12:15], a[140:143], v[100:103]
    ds_read_b64_tr_b16 a[4:5], v10 offset:21568
    v_add_f32 v45, 1.0, v45
    v_add_f32 v46, 1.0, v46
    v_mfma_f32_16x16x32_bf16 v[100:103], a[8:11], a[124:127], v[100:103]
    ds_read_b64_tr_b16 a[6:7], v10 offset:25152
    v_add_f32 v47, 1.0, v47
    v_rcp_f32 v32, v32
    v_mfma_f32_16x16x32_bf16 v[104:107], a[8:11], a[128:131], v[104:107]
    v_rcp_f32 v33, v33
    v_mfma_f32_16x16x32_bf16 v[104:107], a[12:15], a[144:147], v[104:107]
    v_rcp_f32 v34, v34
    v_mfma_f32_16x16x32_bf16 v[108:111], a[12:15], a[148:151], v[108:111]
    v_rcp_f32 v35, v35
    v_rcp_f32 v36, v36
    v_mfma_f32_16x16x32_bf16 v[108:111], a[8:11], a[132:135], v[108:111]
    v_rcp_f32 v37, v37
    v_mfma_f32_16x16x32_bf16 v[108:111], a[16:19], a[164:167], v[108:111]
    ds_read_b64_tr_b16 a[8:9], v10 offset:35904
    v_rcp_f32 v38, v38
    v_mfma_f32_16x16x32_bf16 v[108:111], a[20:23], a[180:183], v[108:111]
    ds_read_b64_tr_b16 a[10:11], v10 offset:39488
    v_rcp_f32 v39, v39
    v_mfma_f32_16x16x32_bf16 v[104:107], a[20:23], a[176:179], v[104:107]
    ds_read_b64_tr_b16 a[12:13], v10 offset:50240
    v_rcp_f32 v40, v40
    v_mfma_f32_16x16x32_bf16 v[104:107], a[16:19], a[160:163], v[104:107]
    ds_read_b64_tr_b16 a[14:15], v10 offset:53824
    v_rcp_f32 v41, v41
    v_rcp_f32 v42, v42
    v_mfma_f32_16x16x32_bf16 v[100:103], a[16:19], a[156:159], v[100:103]
    v_rcp_f32 v43, v43
    v_mfma_f32_16x16x32_bf16 v[100:103], a[20:23], a[172:175], v[100:103]
    v_rcp_f32 v44, v44
    v_mfma_f32_16x16x32_bf16 v[96:99], a[20:23], a[168:171], v[96:99]
    v_rcp_f32 v45, v45
    v_rcp_f32 v46, v46
    v_mfma_f32_16x16x32_bf16 v[96:99], a[16:19], a[152:155], v[96:99]
    v_rcp_f32 v47, v47
    s_nop 0
    v_pk_mul_f32 v[64:65], v[64:65], v[80:81]
    v_pk_mul_f32 v[66:67], v[66:67], v[82:83]
    v_pk_mul_f32 v[68:69], v[68:69], v[84:85]
    v_pk_mul_f32 v[70:71], v[70:71], v[86:87]
    v_pk_mul_f32 v[64:65], v[64:65], v[32:33]
    v_pk_mul_f32 v[66:67], v[66:67], v[34:35]
    v_pk_mul_f32 v[68:69], v[68:69], v[36:37]
    v_pk_mul_f32 v[70:71], v[70:71], v[38:39]
    v_cvt_pk_bf16_f32 v80, v64, v65
    v_cvt_pk_bf16_f32 v81, v66, v67
    v_cvt_pk_bf16_f32 v84, v68, v69
    v_cvt_pk_bf16_f32 v85, v70, v71
    v_pk_mul_f32 v[72:73], v[72:73], v[88:89]
    v_pk_mul_f32 v[74:75], v[74:75], v[90:91]
    v_pk_mul_f32 v[76:77], v[76:77], v[92:93]
    v_pk_mul_f32 v[78:79], v[78:79], v[94:95]
    v_pk_mul_f32 v[72:73], v[72:73], v[40:41]
    v_pk_mul_f32 v[74:75], v[74:75], v[42:43]
    v_pk_mul_f32 v[76:77], v[76:77], v[44:45]
    v_pk_mul_f32 v[78:79], v[78:79], v[46:47]
    v_cvt_pk_bf16_f32 v88, v72, v73
    v_cvt_pk_bf16_f32 v89, v74, v75
    v_cvt_pk_bf16_f32 v92, v76, v77
    v_cvt_pk_bf16_f32 v93, v78, v79
    v_pk_mul_f32 v[64:65], v[96:97], v[96:97]
    v_pk_mul_f32 v[66:67], v[98:99], v[98:99]
    v_pk_mul_f32 v[68:69], v[100:101], v[100:101]
    v_pk_mul_f32 v[70:71], v[102:103], v[102:103]
    v_pk_fma_f32 v[64:65], v[64:65], s[92:93], v[22:23]
    v_pk_fma_f32 v[66:67], v[66:67], s[92:93], v[22:23]
    v_pk_fma_f32 v[68:69], v[68:69], s[92:93], v[22:23]
    v_pk_fma_f32 v[70:71], v[70:71], s[92:93], v[22:23]
    v_pk_mul_f32 v[64:65], v[64:65], v[96:97]
    v_pk_mul_f32 v[66:67], v[66:67], v[98:99]
    v_pk_mul_f32 v[68:69], v[68:69], v[100:101]
    v_pk_mul_f32 v[70:71], v[70:71], v[102:103]
    v_pk_mul_f32 v[72:73], v[104:105], v[104:105]
    v_pk_mul_f32 v[74:75], v[106:107], v[106:107]
    v_pk_mul_f32 v[76:77], v[108:109], v[108:109]
    v_pk_mul_f32 v[78:79], v[110:111], v[110:111]
    v_pk_fma_f32 v[72:73], v[72:73], s[92:93], v[22:23]
    v_pk_fma_f32 v[74:75], v[74:75], s[92:93], v[22:23]
    v_pk_fma_f32 v[76:77], v[76:77], s[92:93], v[22:23]
    v_pk_fma_f32 v[78:79], v[78:79], s[92:93], v[22:23]
    v_pk_mul_f32 v[72:73], v[72:73], v[104:105]
    v_pk_mul_f32 v[74:75], v[74:75], v[106:107]
    v_pk_mul_f32 v[76:77], v[76:77], v[108:109]
    v_pk_mul_f32 v[78:79], v[78:79], v[110:111]
    s_waitcnt lgkmcnt(15)
    v_mfma_f32_16x16x32_bf16 v[112:115], a[24:27], a[120:123], v[112:115]
    ds_read_b64_tr_b16 a[16:17], v10 offset:96
    v_exp_f32 v64, v64
    v_mfma_f32_16x16x32_bf16 v[112:115], a[28:31], a[136:139], v[112:115]
    ds_read_b64_tr_b16 a[18:19], v10 offset:3680
    v_exp_f32 v65, v65
    v_mfma_f32_16x16x32_bf16 v[116:119], a[28:31], a[140:143], v[116:119]
    ds_read_b64_tr_b16 a[20:21], v10 offset:14432
    v_exp_f32 v66, v66
    v_add_f32 v64, 1.0, v64
    v_mfma_f32_16x16x32_bf16 v[116:119], a[24:27], a[124:127], v[116:119]
    ds_read_b64_tr_b16 a[22:23], v10 offset:18016
    v_exp_f32 v67, v67
    v_add_f32 v65, 1.0, v65
    v_mfma_f32_16x16x32_bf16 v[120:123], a[24:27], a[128:131], v[120:123]
    v_exp_f32 v68, v68
    v_add_f32 v66, 1.0, v66
    v_mfma_f32_16x16x32_bf16 v[120:123], a[28:31], a[144:147], v[120:123]
    v_exp_f32 v69, v69
    v_mfma_f32_16x16x32_bf16 v[124:127], a[28:31], a[148:151], v[124:127]
    v_add_f32 v67, 1.0, v67
    v_exp_f32 v70, v70
    v_mfma_f32_16x16x32_bf16 v[124:127], a[24:27], a[132:135], v[124:127]
    v_add_f32 v68, 1.0, v68
    v_mfma_f32_16x16x32_bf16 v[124:127], a[32:35], a[164:167], v[124:127]
    ds_read_b64_tr_b16 a[24:25], v10 offset:28768
    v_exp_f32 v71, v71
    v_add_f32 v69, 1.0, v69
    v_mfma_f32_16x16x32_bf16 v[124:127], a[36:39], a[180:183], v[124:127]
    ds_read_b64_tr_b16 a[26:27], v10 offset:32352
    v_exp_f32 v72, v72
    v_add_f32 v70, 1.0, v70
    v_mfma_f32_16x16x32_bf16 v[120:123], a[36:39], a[176:179], v[120:123]
    ds_read_b64_tr_b16 a[28:29], v10 offset:43104
    v_exp_f32 v73, v73
    v_mfma_f32_16x16x32_bf16 v[120:123], a[32:35], a[160:163], v[120:123]
    ds_read_b64_tr_b16 a[30:31], v10 offset:46688
    v_add_f32 v71, 1.0, v71
    v_exp_f32 v74, v74
    v_mfma_f32_16x16x32_bf16 v[116:119], a[32:35], a[156:159], v[116:119]
    v_add_f32 v72, 1.0, v72
    v_exp_f32 v75, v75
    v_mfma_f32_16x16x32_bf16 v[116:119], a[36:39], a[172:175], v[116:119]
    v_add_f32 v73, 1.0, v73
    v_mfma_f32_16x16x32_bf16 v[112:115], a[36:39], a[168:171], v[112:115]
    v_exp_f32 v76, v76
    v_add_f32 v74, 1.0, v74
    v_mfma_f32_16x16x32_bf16 v[112:115], a[32:35], a[152:155], v[112:115]
    v_exp_f32 v77, v77
    v_add_f32 v75, 1.0, v75
    s_waitcnt lgkmcnt(15)
    v_mfma_f32_16x16x32_bf16 v[128:131], a[40:43], a[120:123], v[128:131]
    ds_read_b64_tr_b16 a[32:33], v10 offset:7264
    v_exp_f32 v78, v78
    v_mfma_f32_16x16x32_bf16 v[128:131], a[44:47], a[136:139], v[128:131]
    ds_read_b64_tr_b16 a[34:35], v10 offset:10848
    v_add_f32 v76, 1.0, v76
    v_exp_f32 v79, v79
    v_mfma_f32_16x16x32_bf16 v[132:135], a[44:47], a[140:143], v[132:135]
    ds_read_b64_tr_b16 a[36:37], v10 offset:21600
    v_add_f32 v77, 1.0, v77
    v_add_f32 v78, 1.0, v78
    v_mfma_f32_16x16x32_bf16 v[132:135], a[40:43], a[124:127], v[132:135]
    ds_read_b64_tr_b16 a[38:39], v10 offset:25184
    v_add_f32 v79, 1.0, v79
    v_rcp_f32 v64, v64
    v_mfma_f32_16x16x32_bf16 v[136:139], a[40:43], a[128:131], v[136:139]
    v_rcp_f32 v65, v65
    v_mfma_f32_16x16x32_bf16 v[136:139], a[44:47], a[144:147], v[136:139]
    v_rcp_f32 v66, v66
    v_mfma_f32_16x16x32_bf16 v[140:143], a[44:47], a[148:151], v[140:143]
    v_rcp_f32 v67, v67
    v_rcp_f32 v68, v68
    v_mfma_f32_16x16x32_bf16 v[140:143], a[40:43], a[132:135], v[140:143]
    v_rcp_f32 v69, v69
    v_mfma_f32_16x16x32_bf16 v[140:143], a[48:51], a[164:167], v[140:143]
    ds_read_b64_tr_b16 a[40:41], v10 offset:35936
    v_rcp_f32 v70, v70
    v_mfma_f32_16x16x32_bf16 v[140:143], a[52:55], a[180:183], v[140:143]
    ds_read_b64_tr_b16 a[42:43], v10 offset:39520
    v_rcp_f32 v71, v71
    v_mfma_f32_16x16x32_bf16 v[136:139], a[52:55], a[176:179], v[136:139]
    ds_read_b64_tr_b16 a[44:45], v10 offset:50272
    v_rcp_f32 v72, v72
    v_mfma_f32_16x16x32_bf16 v[136:139], a[48:51], a[160:163], v[136:139]
    ds_read_b64_tr_b16 a[46:47], v10 offset:53856
    v_rcp_f32 v73, v73
    v_rcp_f32 v74, v74
    v_mfma_f32_16x16x32_bf16 v[132:135], a[48:51], a[156:159], v[132:135]
    v_rcp_f32 v75, v75
    v_mfma_f32_16x16x32_bf16 v[132:135], a[52:55], a[172:175], v[132:135]
    v_rcp_f32 v76, v76
    v_mfma_f32_16x16x32_bf16 v[128:131], a[52:55], a[168:171], v[128:131]
    v_rcp_f32 v77, v77
    v_rcp_f32 v78, v78
    v_mfma_f32_16x16x32_bf16 v[128:131], a[48:51], a[152:155], v[128:131]
    v_rcp_f32 v79, v79
    s_nop 0
    v_pk_mul_f32 v[96:97], v[96:97], v[112:113]
    v_pk_mul_f32 v[98:99], v[98:99], v[114:115]
    v_pk_mul_f32 v[100:101], v[100:101], v[116:117]
    v_pk_mul_f32 v[102:103], v[102:103], v[118:119]
    v_pk_mul_f32 v[96:97], v[96:97], v[64:65]
    v_pk_mul_f32 v[98:99], v[98:99], v[66:67]
    v_pk_mul_f32 v[100:101], v[100:101], v[68:69]
    v_pk_mul_f32 v[102:103], v[102:103], v[70:71]
    v_cvt_pk_bf16_f32 v82, v96, v97
    v_cvt_pk_bf16_f32 v83, v98, v99
    v_cvt_pk_bf16_f32 v86, v100, v101
    v_cvt_pk_bf16_f32 v87, v102, v103
    v_pk_mul_f32 v[104:105], v[104:105], v[120:121]
    v_pk_mul_f32 v[106:107], v[106:107], v[122:123]
    v_pk_mul_f32 v[108:109], v[108:109], v[124:125]
    v_pk_mul_f32 v[110:111], v[110:111], v[126:127]
    v_pk_mul_f32 v[104:105], v[104:105], v[72:73]
    v_pk_mul_f32 v[106:107], v[106:107], v[74:75]
    v_pk_mul_f32 v[108:109], v[108:109], v[76:77]
    v_pk_mul_f32 v[110:111], v[110:111], v[78:79]
    v_cvt_pk_bf16_f32 v90, v104, v105
    v_cvt_pk_bf16_f32 v91, v106, v107
    v_cvt_pk_bf16_f32 v94, v108, v109
    v_cvt_pk_bf16_f32 v95, v110, v111
    buffer_store_dwordx4 v[80:83], v1, s[88:91], s32 offen offset:0 sc1
    buffer_store_dwordx4 v[84:87], v1, s[88:91], s32 offen offset:1024 sc1
    buffer_store_dwordx4 v[88:91], v1, s[88:91], s33 offen offset:0 sc1
    buffer_store_dwordx4 v[92:95], v1, s[88:91], s33 offen offset:1024 sc1
    v_pk_mul_f32 v[96:97], v[128:129], v[128:129]
    v_pk_mul_f32 v[98:99], v[130:131], v[130:131]
    v_pk_mul_f32 v[100:101], v[132:133], v[132:133]
    v_pk_mul_f32 v[102:103], v[134:135], v[134:135]
    v_pk_fma_f32 v[96:97], v[96:97], s[92:93], v[22:23]
    v_pk_fma_f32 v[98:99], v[98:99], s[92:93], v[22:23]
    v_pk_fma_f32 v[100:101], v[100:101], s[92:93], v[22:23]
    v_pk_fma_f32 v[102:103], v[102:103], s[92:93], v[22:23]
    v_pk_mul_f32 v[96:97], v[96:97], v[128:129]
    v_pk_mul_f32 v[98:99], v[98:99], v[130:131]
    v_pk_mul_f32 v[100:101], v[100:101], v[132:133]
    v_pk_mul_f32 v[102:103], v[102:103], v[134:135]
    v_pk_mul_f32 v[104:105], v[136:137], v[136:137]
    v_pk_mul_f32 v[106:107], v[138:139], v[138:139]
    v_pk_mul_f32 v[108:109], v[140:141], v[140:141]
    v_pk_mul_f32 v[110:111], v[142:143], v[142:143]
    v_pk_fma_f32 v[104:105], v[104:105], s[92:93], v[22:23]
    v_pk_fma_f32 v[106:107], v[106:107], s[92:93], v[22:23]
    v_pk_fma_f32 v[108:109], v[108:109], s[92:93], v[22:23]
    v_pk_fma_f32 v[110:111], v[110:111], s[92:93], v[22:23]
    v_pk_mul_f32 v[104:105], v[104:105], v[136:137]
    v_pk_mul_f32 v[106:107], v[106:107], v[138:139]
    v_pk_mul_f32 v[108:109], v[108:109], v[140:141]
    v_pk_mul_f32 v[110:111], v[110:111], v[142:143]
    s_waitcnt lgkmcnt(15)
    v_mfma_f32_16x16x32_bf16 v[144:147], a[0:3], a[120:123], v[144:147]
    ds_read_b64_tr_b16 a[48:49], v10 offset:128
    v_exp_f32 v96, v96
    v_mfma_f32_16x16x32_bf16 v[144:147], a[4:7], a[136:139], v[144:147]
    ds_read_b64_tr_b16 a[50:51], v10 offset:3712
    v_exp_f32 v97, v97
    v_mfma_f32_16x16x32_bf16 v[148:151], a[4:7], a[140:143], v[148:151]
    ds_read_b64_tr_b16 a[52:53], v10 offset:14464
    v_exp_f32 v98, v98
    v_add_f32 v96, 1.0, v96
    v_mfma_f32_16x16x32_bf16 v[148:151], a[0:3], a[124:127], v[148:151]
    ds_read_b64_tr_b16 a[54:55], v10 offset:18048
    v_exp_f32 v99, v99
    v_add_f32 v97, 1.0, v97
    v_mfma_f32_16x16x32_bf16 v[152:155], a[0:3], a[128:131], v[152:155]
    v_exp_f32 v100, v100
    v_add_f32 v98, 1.0, v98
    v_mfma_f32_16x16x32_bf16 v[152:155], a[4:7], a[144:147], v[152:155]
    v_exp_f32 v101, v101
    v_mfma_f32_16x16x32_bf16 v[156:159], a[4:7], a[148:151], v[156:159]
    v_add_f32 v99, 1.0, v99
    v_exp_f32 v102, v102
    v_mfma_f32_16x16x32_bf16 v[156:159], a[0:3], a[132:135], v[156:159]
    v_add_f32 v100, 1.0, v100
    v_mfma_f32_16x16x32_bf16 v[156:159], a[8:11], a[164:167], v[156:159]
    ds_read_b64_tr_b16 a[0:1], v10 offset:28800
    v_exp_f32 v103, v103
    v_add_f32 v101, 1.0, v101
    v_mfma_f32_16x16x32_bf16 v[156:159], a[12:15], a[180:183], v[156:159]
    ds_read_b64_tr_b16 a[2:3], v10 offset:32384
    v_exp_f32 v104, v104
    v_add_f32 v102, 1.0, v102
    v_mfma_f32_16x16x32_bf16 v[152:155], a[12:15], a[176:179], v[152:155]
    ds_read_b64_tr_b16 a[4:5], v10 offset:43136
    v_exp_f32 v105, v105
    v_mfma_f32_16x16x32_bf16 v[152:155], a[8:11], a[160:163], v[152:155]
    ds_read_b64_tr_b16 a[6:7], v10 offset:46720
    v_add_f32 v103, 1.0, v103
    v_exp_f32 v106, v106
    v_mfma_f32_16x16x32_bf16 v[148:151], a[8:11], a[156:159], v[148:151]
    v_add_f32 v104, 1.0, v104
    v_exp_f32 v107, v107
    v_mfma_f32_16x16x32_bf16 v[148:151], a[12:15], a[172:175], v[148:151]
    v_add_f32 v105, 1.0, v105
    v_mfma_f32_16x16x32_bf16 v[144:147], a[12:15], a[168:171], v[144:147]
    v_exp_f32 v108, v108
    v_add_f32 v106, 1.0, v106
    v_mfma_f32_16x16x32_bf16 v[144:147], a[8:11], a[152:155], v[144:147]
    v_exp_f32 v109, v109
    v_add_f32 v107, 1.0, v107
    s_waitcnt lgkmcnt(15)
    v_mfma_f32_16x16x32_bf16 v[160:163], a[16:19], a[120:123], v[160:163]
    ds_read_b64_tr_b16 a[8:9], v10 offset:7296
    v_exp_f32 v110, v110
    v_mfma_f32_16x16x32_bf16 v[160:163], a[20:23], a[136:139], v[160:163]
    ds_read_b64_tr_b16 a[10:11], v10 offset:10880
    v_add_f32 v108, 1.0, v108
    v_exp_f32 v111, v111
    v_mfma_f32_16x16x32_bf16 v[164:167], a[20:23], a[140:143], v[164:167]
    ds_read_b64_tr_b16 a[12:13], v10 offset:21632
    v_add_f32 v109, 1.0, v109
    v_add_f32 v110, 1.0, v110
    v_mfma_f32_16x16x32_bf16 v[164:167], a[16:19], a[124:127], v[164:167]
    ds_read_b64_tr_b16 a[14:15], v10 offset:25216
    v_add_f32 v111, 1.0, v111
    v_rcp_f32 v96, v96
    v_mfma_f32_16x16x32_bf16 v[168:171], a[16:19], a[128:131], v[168:171]
    v_rcp_f32 v97, v97
    v_mfma_f32_16x16x32_bf16 v[168:171], a[20:23], a[144:147], v[168:171]
    v_rcp_f32 v98, v98
    v_mfma_f32_16x16x32_bf16 v[172:175], a[20:23], a[148:151], v[172:175]
    v_rcp_f32 v99, v99
    v_rcp_f32 v100, v100
    v_mfma_f32_16x16x32_bf16 v[172:175], a[16:19], a[132:135], v[172:175]
    v_rcp_f32 v101, v101
    v_mfma_f32_16x16x32_bf16 v[172:175], a[24:27], a[164:167], v[172:175]
    ds_read_b64_tr_b16 a[16:17], v10 offset:35968
    v_rcp_f32 v102, v102
    v_mfma_f32_16x16x32_bf16 v[172:175], a[28:31], a[180:183], v[172:175]
    ds_read_b64_tr_b16 a[18:19], v10 offset:39552
    v_rcp_f32 v103, v103
    v_mfma_f32_16x16x32_bf16 v[168:171], a[28:31], a[176:179], v[168:171]
    ds_read_b64_tr_b16 a[20:21], v10 offset:50304
    v_rcp_f32 v104, v104
    v_mfma_f32_16x16x32_bf16 v[168:171], a[24:27], a[160:163], v[168:171]
    ds_read_b64_tr_b16 a[22:23], v10 offset:53888
    v_rcp_f32 v105, v105
    v_rcp_f32 v106, v106
    v_mfma_f32_16x16x32_bf16 v[164:167], a[24:27], a[156:159], v[164:167]
    v_rcp_f32 v107, v107
    v_mfma_f32_16x16x32_bf16 v[164:167], a[28:31], a[172:175], v[164:167]
    v_rcp_f32 v108, v108
    v_mfma_f32_16x16x32_bf16 v[160:163], a[28:31], a[168:171], v[160:163]
    v_rcp_f32 v109, v109
    v_rcp_f32 v110, v110
    v_mfma_f32_16x16x32_bf16 v[160:163], a[24:27], a[152:155], v[160:163]
    v_rcp_f32 v111, v111
    s_nop 0
    v_pk_mul_f32 v[128:129], v[128:129], v[144:145]
    v_pk_mul_f32 v[130:131], v[130:131], v[146:147]
    v_pk_mul_f32 v[132:133], v[132:133], v[148:149]
    v_pk_mul_f32 v[134:135], v[134:135], v[150:151]
    v_pk_mul_f32 v[128:129], v[128:129], v[96:97]
    v_pk_mul_f32 v[130:131], v[130:131], v[98:99]
    v_pk_mul_f32 v[132:133], v[132:133], v[100:101]
    v_pk_mul_f32 v[134:135], v[134:135], v[102:103]
    v_cvt_pk_bf16_f32 v144, v128, v129
    v_cvt_pk_bf16_f32 v145, v130, v131
    v_cvt_pk_bf16_f32 v148, v132, v133
    v_cvt_pk_bf16_f32 v149, v134, v135
    v_pk_mul_f32 v[136:137], v[136:137], v[152:153]
    v_pk_mul_f32 v[138:139], v[138:139], v[154:155]
    v_pk_mul_f32 v[140:141], v[140:141], v[156:157]
    v_pk_mul_f32 v[142:143], v[142:143], v[158:159]
    v_pk_mul_f32 v[136:137], v[136:137], v[104:105]
    v_pk_mul_f32 v[138:139], v[138:139], v[106:107]
    v_pk_mul_f32 v[140:141], v[140:141], v[108:109]
    v_pk_mul_f32 v[142:143], v[142:143], v[110:111]
    v_cvt_pk_bf16_f32 v152, v136, v137
    v_cvt_pk_bf16_f32 v153, v138, v139
    v_cvt_pk_bf16_f32 v156, v140, v141
    v_cvt_pk_bf16_f32 v157, v142, v143
    v_pk_mul_f32 v[128:129], v[160:161], v[160:161]
    v_pk_mul_f32 v[130:131], v[162:163], v[162:163]
    v_pk_mul_f32 v[132:133], v[164:165], v[164:165]
    v_pk_mul_f32 v[134:135], v[166:167], v[166:167]
    v_pk_fma_f32 v[128:129], v[128:129], s[92:93], v[22:23]
    v_pk_fma_f32 v[130:131], v[130:131], s[92:93], v[22:23]
    v_pk_fma_f32 v[132:133], v[132:133], s[92:93], v[22:23]
    v_pk_fma_f32 v[134:135], v[134:135], s[92:93], v[22:23]
    v_pk_mul_f32 v[128:129], v[128:129], v[160:161]
    v_pk_mul_f32 v[130:131], v[130:131], v[162:163]
    v_pk_mul_f32 v[132:133], v[132:133], v[164:165]
    v_pk_mul_f32 v[134:135], v[134:135], v[166:167]
    v_pk_mul_f32 v[136:137], v[168:169], v[168:169]
    v_pk_mul_f32 v[138:139], v[170:171], v[170:171]
    v_pk_mul_f32 v[140:141], v[172:173], v[172:173]
    v_pk_mul_f32 v[142:143], v[174:175], v[174:175]
    v_pk_fma_f32 v[136:137], v[136:137], s[92:93], v[22:23]
    v_pk_fma_f32 v[138:139], v[138:139], s[92:93], v[22:23]
    v_pk_fma_f32 v[140:141], v[140:141], s[92:93], v[22:23]
    v_pk_fma_f32 v[142:143], v[142:143], s[92:93], v[22:23]
    v_pk_mul_f32 v[136:137], v[136:137], v[168:169]
    v_pk_mul_f32 v[138:139], v[138:139], v[170:171]
    v_pk_mul_f32 v[140:141], v[140:141], v[172:173]
    v_pk_mul_f32 v[142:143], v[142:143], v[174:175]
    s_waitcnt lgkmcnt(15)
    v_mfma_f32_16x16x32_bf16 v[176:179], a[32:35], a[120:123], v[176:179]
    ds_read_b64_tr_b16 a[24:25], v10 offset:160
    v_exp_f32 v128, v128
    v_mfma_f32_16x16x32_bf16 v[176:179], a[36:39], a[136:139], v[176:179]
    ds_read_b64_tr_b16 a[26:27], v10 offset:3744
    v_exp_f32 v129, v129
    v_mfma_f32_16x16x32_bf16 v[180:183], a[36:39], a[140:143], v[180:183]
    ds_read_b64_tr_b16 a[28:29], v10 offset:14496
    v_exp_f32 v130, v130
    v_add_f32 v128, 1.0, v128
    v_mfma_f32_16x16x32_bf16 v[180:183], a[32:35], a[124:127], v[180:183]
    ds_read_b64_tr_b16 a[30:31], v10 offset:18080
    v_exp_f32 v131, v131
    v_add_f32 v129, 1.0, v129
    v_mfma_f32_16x16x32_bf16 v[184:187], a[32:35], a[128:131], v[184:187]
    v_exp_f32 v132, v132
    v_add_f32 v130, 1.0, v130
    v_mfma_f32_16x16x32_bf16 v[184:187], a[36:39], a[144:147], v[184:187]
    v_exp_f32 v133, v133
    v_mfma_f32_16x16x32_bf16 v[188:191], a[36:39], a[148:151], v[188:191]
    v_add_f32 v131, 1.0, v131
    v_exp_f32 v134, v134
    v_mfma_f32_16x16x32_bf16 v[188:191], a[32:35], a[132:135], v[188:191]
    v_add_f32 v132, 1.0, v132
    v_mfma_f32_16x16x32_bf16 v[188:191], a[40:43], a[164:167], v[188:191]
    ds_read_b64_tr_b16 a[32:33], v10 offset:28832
    v_exp_f32 v135, v135
    v_add_f32 v133, 1.0, v133
    v_mfma_f32_16x16x32_bf16 v[188:191], a[44:47], a[180:183], v[188:191]
    ds_read_b64_tr_b16 a[34:35], v10 offset:32416
    v_exp_f32 v136, v136
    v_add_f32 v134, 1.0, v134
    v_mfma_f32_16x16x32_bf16 v[184:187], a[44:47], a[176:179], v[184:187]
    ds_read_b64_tr_b16 a[36:37], v10 offset:43168
    v_exp_f32 v137, v137
    v_mfma_f32_16x16x32_bf16 v[184:187], a[40:43], a[160:163], v[184:187]
    ds_read_b64_tr_b16 a[38:39], v10 offset:46752
    v_add_f32 v135, 1.0, v135
    v_exp_f32 v138, v138
    v_mfma_f32_16x16x32_bf16 v[180:183], a[40:43], a[156:159], v[180:183]
    v_add_f32 v136, 1.0, v136
    v_exp_f32 v139, v139
    v_mfma_f32_16x16x32_bf16 v[180:183], a[44:47], a[172:175], v[180:183]
    v_add_f32 v137, 1.0, v137
    v_mfma_f32_16x16x32_bf16 v[176:179], a[44:47], a[168:171], v[176:179]
    v_exp_f32 v140, v140
    v_add_f32 v138, 1.0, v138
    v_mfma_f32_16x16x32_bf16 v[176:179], a[40:43], a[152:155], v[176:179]
    v_exp_f32 v141, v141
    v_add_f32 v139, 1.0, v139
    s_waitcnt lgkmcnt(15)
    v_mfma_f32_16x16x32_bf16 v[192:195], a[48:51], a[120:123], v[192:195]
    ds_read_b64_tr_b16 a[40:41], v10 offset:7328
    v_exp_f32 v142, v142
    v_mfma_f32_16x16x32_bf16 v[192:195], a[52:55], a[136:139], v[192:195]
    ds_read_b64_tr_b16 a[42:43], v10 offset:10912
    v_add_f32 v140, 1.0, v140
    v_exp_f32 v143, v143
    v_mfma_f32_16x16x32_bf16 v[196:199], a[52:55], a[140:143], v[196:199]
    ds_read_b64_tr_b16 a[44:45], v10 offset:21664
    v_add_f32 v141, 1.0, v141
    v_add_f32 v142, 1.0, v142
    v_mfma_f32_16x16x32_bf16 v[196:199], a[48:51], a[124:127], v[196:199]
    ds_read_b64_tr_b16 a[46:47], v10 offset:25248
    v_add_f32 v143, 1.0, v143
    v_rcp_f32 v128, v128
    v_mfma_f32_16x16x32_bf16 v[200:203], a[48:51], a[128:131], v[200:203]
    v_rcp_f32 v129, v129
    v_mfma_f32_16x16x32_bf16 v[200:203], a[52:55], a[144:147], v[200:203]
    v_rcp_f32 v130, v130
    v_mfma_f32_16x16x32_bf16 v[204:207], a[52:55], a[148:151], v[204:207]
    v_rcp_f32 v131, v131
    v_rcp_f32 v132, v132
    v_mfma_f32_16x16x32_bf16 v[204:207], a[48:51], a[132:135], v[204:207]
    v_rcp_f32 v133, v133
    v_mfma_f32_16x16x32_bf16 v[204:207], a[0:3], a[164:167], v[204:207]
    ds_read_b64_tr_b16 a[48:49], v10 offset:36000
    v_rcp_f32 v134, v134
    v_mfma_f32_16x16x32_bf16 v[204:207], a[4:7], a[180:183], v[204:207]
    ds_read_b64_tr_b16 a[50:51], v10 offset:39584
    v_rcp_f32 v135, v135
    v_mfma_f32_16x16x32_bf16 v[200:203], a[4:7], a[176:179], v[200:203]
    ds_read_b64_tr_b16 a[52:53], v10 offset:50336
    v_rcp_f32 v136, v136
    v_mfma_f32_16x16x32_bf16 v[200:203], a[0:3], a[160:163], v[200:203]
    ds_read_b64_tr_b16 a[54:55], v10 offset:53920
    v_rcp_f32 v137, v137
    v_rcp_f32 v138, v138
    v_mfma_f32_16x16x32_bf16 v[196:199], a[0:3], a[156:159], v[196:199]
    v_rcp_f32 v139, v139
    v_mfma_f32_16x16x32_bf16 v[196:199], a[4:7], a[172:175], v[196:199]
    v_rcp_f32 v140, v140
    v_mfma_f32_16x16x32_bf16 v[192:195], a[4:7], a[168:171], v[192:195]
    v_rcp_f32 v141, v141
    v_rcp_f32 v142, v142
    v_mfma_f32_16x16x32_bf16 v[192:195], a[0:3], a[152:155], v[192:195]
    v_rcp_f32 v143, v143
    s_nop 0
    v_pk_mul_f32 v[160:161], v[160:161], v[176:177]
    v_pk_mul_f32 v[162:163], v[162:163], v[178:179]
    v_pk_mul_f32 v[164:165], v[164:165], v[180:181]
    v_pk_mul_f32 v[166:167], v[166:167], v[182:183]
    v_pk_mul_f32 v[160:161], v[160:161], v[128:129]
    v_pk_mul_f32 v[162:163], v[162:163], v[130:131]
    v_pk_mul_f32 v[164:165], v[164:165], v[132:133]
    v_pk_mul_f32 v[166:167], v[166:167], v[134:135]
    v_cvt_pk_bf16_f32 v146, v160, v161
    v_cvt_pk_bf16_f32 v147, v162, v163
    v_cvt_pk_bf16_f32 v150, v164, v165
    v_cvt_pk_bf16_f32 v151, v166, v167
    v_pk_mul_f32 v[168:169], v[168:169], v[184:185]
    v_pk_mul_f32 v[170:171], v[170:171], v[186:187]
    v_pk_mul_f32 v[172:173], v[172:173], v[188:189]
    v_pk_mul_f32 v[174:175], v[174:175], v[190:191]
    v_pk_mul_f32 v[168:169], v[168:169], v[136:137]
    v_pk_mul_f32 v[170:171], v[170:171], v[138:139]
    v_pk_mul_f32 v[172:173], v[172:173], v[140:141]
    v_pk_mul_f32 v[174:175], v[174:175], v[142:143]
    v_cvt_pk_bf16_f32 v154, v168, v169
    v_cvt_pk_bf16_f32 v155, v170, v171
    v_cvt_pk_bf16_f32 v158, v172, v173
    v_cvt_pk_bf16_f32 v159, v174, v175
    buffer_store_dwordx4 v[144:147], v1, s[88:91], s32 offen offset:2048 sc1
    buffer_store_dwordx4 v[148:151], v1, s[88:91], s32 offen offset:3072 sc1
    buffer_store_dwordx4 v[152:155], v1, s[88:91], s33 offen offset:2048 sc1
    buffer_store_dwordx4 v[156:159], v1, s[88:91], s33 offen offset:3072 sc1
    v_pk_mul_f32 v[160:161], v[192:193], v[192:193]
    v_pk_mul_f32 v[162:163], v[194:195], v[194:195]
    v_pk_mul_f32 v[164:165], v[196:197], v[196:197]
    v_pk_mul_f32 v[166:167], v[198:199], v[198:199]
    v_pk_fma_f32 v[160:161], v[160:161], s[92:93], v[22:23]
    v_pk_fma_f32 v[162:163], v[162:163], s[92:93], v[22:23]
    v_pk_fma_f32 v[164:165], v[164:165], s[92:93], v[22:23]
    v_pk_fma_f32 v[166:167], v[166:167], s[92:93], v[22:23]
    v_pk_mul_f32 v[160:161], v[160:161], v[192:193]
    v_pk_mul_f32 v[162:163], v[162:163], v[194:195]
    v_pk_mul_f32 v[164:165], v[164:165], v[196:197]
    v_pk_mul_f32 v[166:167], v[166:167], v[198:199]
    v_pk_mul_f32 v[168:169], v[200:201], v[200:201]
    v_pk_mul_f32 v[170:171], v[202:203], v[202:203]
    v_pk_mul_f32 v[172:173], v[204:205], v[204:205]
    v_pk_mul_f32 v[174:175], v[206:207], v[206:207]
    v_pk_fma_f32 v[168:169], v[168:169], s[92:93], v[22:23]
    v_pk_fma_f32 v[170:171], v[170:171], s[92:93], v[22:23]
    v_pk_fma_f32 v[172:173], v[172:173], s[92:93], v[22:23]
    v_pk_fma_f32 v[174:175], v[174:175], s[92:93], v[22:23]
    v_pk_mul_f32 v[168:169], v[168:169], v[200:201]
    v_pk_mul_f32 v[170:171], v[170:171], v[202:203]
    v_pk_mul_f32 v[172:173], v[172:173], v[204:205]
    v_pk_mul_f32 v[174:175], v[174:175], v[206:207]
    s_waitcnt lgkmcnt(15)
    v_mfma_f32_16x16x32_bf16 v[208:211], a[8:11], a[120:123], v[208:211]
    v_exp_f32 v160, v160
    v_mfma_f32_16x16x32_bf16 v[208:211], a[12:15], a[136:139], v[208:211]
    v_exp_f32 v161, v161
    v_mfma_f32_16x16x32_bf16 v[212:215], a[12:15], a[140:143], v[212:215]
    v_exp_f32 v162, v162
    v_add_f32 v160, 1.0, v160
    v_mfma_f32_16x16x32_bf16 v[212:215], a[8:11], a[124:127], v[212:215]
    v_exp_f32 v163, v163
    v_add_f32 v161, 1.0, v161
    v_mfma_f32_16x16x32_bf16 v[216:219], a[8:11], a[128:131], v[216:219]
    v_exp_f32 v164, v164
    v_add_f32 v162, 1.0, v162
    v_mfma_f32_16x16x32_bf16 v[216:219], a[12:15], a[144:147], v[216:219]
    v_exp_f32 v165, v165
    v_mfma_f32_16x16x32_bf16 v[220:223], a[12:15], a[148:151], v[220:223]
    v_add_f32 v163, 1.0, v163
    v_exp_f32 v166, v166
    v_mfma_f32_16x16x32_bf16 v[220:223], a[8:11], a[132:135], v[220:223]
    v_add_f32 v164, 1.0, v164
    v_mfma_f32_16x16x32_bf16 v[220:223], a[16:19], a[164:167], v[220:223]
    v_exp_f32 v167, v167
    v_add_f32 v165, 1.0, v165
    v_mfma_f32_16x16x32_bf16 v[220:223], a[20:23], a[180:183], v[220:223]
    v_exp_f32 v168, v168
    v_add_f32 v166, 1.0, v166
    v_mfma_f32_16x16x32_bf16 v[216:219], a[20:23], a[176:179], v[216:219]
    v_exp_f32 v169, v169
    v_add_f32 v167, 1.0, v167
    v_mfma_f32_16x16x32_bf16 v[216:219], a[16:19], a[160:163], v[216:219]
    v_exp_f32 v170, v170
    v_mfma_f32_16x16x32_bf16 v[212:215], a[16:19], a[156:159], v[212:215]
    v_add_f32 v168, 1.0, v168
    v_exp_f32 v171, v171
    v_mfma_f32_16x16x32_bf16 v[212:215], a[20:23], a[172:175], v[212:215]
    v_add_f32 v169, 1.0, v169
    v_mfma_f32_16x16x32_bf16 v[208:211], a[20:23], a[168:171], v[208:211]
    v_exp_f32 v172, v172
    v_add_f32 v170, 1.0, v170
    v_mfma_f32_16x16x32_bf16 v[208:211], a[16:19], a[152:155], v[208:211]
    v_exp_f32 v173, v173
    v_add_f32 v171, 1.0, v171
    s_waitcnt lgkmcnt(8)
    v_mfma_f32_16x16x32_bf16 v[224:227], a[24:27], a[120:123], v[224:227]
    v_exp_f32 v174, v174
    v_add_f32 v172, 1.0, v172
    v_mfma_f32_16x16x32_bf16 v[224:227], a[28:31], a[136:139], v[224:227]
    v_exp_f32 v175, v175
    v_mfma_f32_16x16x32_bf16 v[228:231], a[28:31], a[140:143], v[228:231]
    v_add_f32 v173, 1.0, v173
    v_add_f32 v174, 1.0, v174
    v_add_f32 v175, 1.0, v175
    v_mfma_f32_16x16x32_bf16 v[228:231], a[24:27], a[124:127], v[228:231]
    v_rcp_f32 v160, v160
    v_mfma_f32_16x16x32_bf16 v[232:235], a[24:27], a[128:131], v[232:235]
    v_rcp_f32 v161, v161
    v_mfma_f32_16x16x32_bf16 v[232:235], a[28:31], a[144:147], v[232:235]
    v_rcp_f32 v162, v162
    v_mfma_f32_16x16x32_bf16 v[236:239], a[28:31], a[148:151], v[236:239]
    v_rcp_f32 v163, v163
    v_rcp_f32 v164, v164
    v_mfma_f32_16x16x32_bf16 v[236:239], a[24:27], a[132:135], v[236:239]
    v_rcp_f32 v165, v165
    v_mfma_f32_16x16x32_bf16 v[236:239], a[32:35], a[164:167], v[236:239]
    v_rcp_f32 v166, v166
    v_mfma_f32_16x16x32_bf16 v[236:239], a[36:39], a[180:183], v[236:239]
    v_rcp_f32 v167, v167
    v_mfma_f32_16x16x32_bf16 v[232:235], a[36:39], a[176:179], v[232:235]
    v_rcp_f32 v168, v168
    v_rcp_f32 v169, v169
    v_mfma_f32_16x16x32_bf16 v[232:235], a[32:35], a[160:163], v[232:235]
    v_rcp_f32 v170, v170
    v_mfma_f32_16x16x32_bf16 v[228:231], a[32:35], a[156:159], v[228:231]
    v_rcp_f32 v171, v171
    v_mfma_f32_16x16x32_bf16 v[228:231], a[36:39], a[172:175], v[228:231]
    v_rcp_f32 v172, v172
    v_mfma_f32_16x16x32_bf16 v[224:227], a[36:39], a[168:171], v[224:227]
    v_rcp_f32 v173, v173
    v_rcp_f32 v174, v174
    v_mfma_f32_16x16x32_bf16 v[224:227], a[32:35], a[152:155], v[224:227]
    v_rcp_f32 v175, v175
    s_nop 0
    v_pk_mul_f32 v[192:193], v[192:193], v[208:209]
    v_pk_mul_f32 v[194:195], v[194:195], v[210:211]
    v_pk_mul_f32 v[196:197], v[196:197], v[212:213]
    v_pk_mul_f32 v[198:199], v[198:199], v[214:215]
    v_pk_mul_f32 v[192:193], v[192:193], v[160:161]
    v_pk_mul_f32 v[194:195], v[194:195], v[162:163]
    v_pk_mul_f32 v[196:197], v[196:197], v[164:165]
    v_pk_mul_f32 v[198:199], v[198:199], v[166:167]
    v_cvt_pk_bf16_f32 v208, v192, v193
    v_cvt_pk_bf16_f32 v209, v194, v195
    v_cvt_pk_bf16_f32 v212, v196, v197
    v_cvt_pk_bf16_f32 v213, v198, v199
    v_pk_mul_f32 v[200:201], v[200:201], v[216:217]
    v_pk_mul_f32 v[202:203], v[202:203], v[218:219]
    v_pk_mul_f32 v[204:205], v[204:205], v[220:221]
    v_pk_mul_f32 v[206:207], v[206:207], v[222:223]
    v_pk_mul_f32 v[200:201], v[200:201], v[168:169]
    v_pk_mul_f32 v[202:203], v[202:203], v[170:171]
    v_pk_mul_f32 v[204:205], v[204:205], v[172:173]
    v_pk_mul_f32 v[206:207], v[206:207], v[174:175]
    v_cvt_pk_bf16_f32 v216, v200, v201
    v_cvt_pk_bf16_f32 v217, v202, v203
    v_cvt_pk_bf16_f32 v220, v204, v205
    v_cvt_pk_bf16_f32 v221, v206, v207
    v_pk_mul_f32 v[192:193], v[224:225], v[224:225]
    v_pk_mul_f32 v[194:195], v[226:227], v[226:227]
    v_pk_mul_f32 v[196:197], v[228:229], v[228:229]
    v_pk_mul_f32 v[198:199], v[230:231], v[230:231]
    v_pk_fma_f32 v[192:193], v[192:193], s[92:93], v[22:23]
    v_pk_fma_f32 v[194:195], v[194:195], s[92:93], v[22:23]
    v_pk_fma_f32 v[196:197], v[196:197], s[92:93], v[22:23]
    v_pk_fma_f32 v[198:199], v[198:199], s[92:93], v[22:23]
    v_pk_mul_f32 v[192:193], v[192:193], v[224:225]
    v_pk_mul_f32 v[194:195], v[194:195], v[226:227]
    v_pk_mul_f32 v[196:197], v[196:197], v[228:229]
    v_pk_mul_f32 v[198:199], v[198:199], v[230:231]
    v_pk_mul_f32 v[200:201], v[232:233], v[232:233]
    v_pk_mul_f32 v[202:203], v[234:235], v[234:235]
    v_pk_mul_f32 v[204:205], v[236:237], v[236:237]
    v_pk_mul_f32 v[206:207], v[238:239], v[238:239]
    v_pk_fma_f32 v[200:201], v[200:201], s[92:93], v[22:23]
    v_pk_fma_f32 v[202:203], v[202:203], s[92:93], v[22:23]
    v_pk_fma_f32 v[204:205], v[204:205], s[92:93], v[22:23]
    v_pk_fma_f32 v[206:207], v[206:207], s[92:93], v[22:23]
    v_pk_mul_f32 v[200:201], v[200:201], v[232:233]
    v_pk_mul_f32 v[202:203], v[202:203], v[234:235]
    v_pk_mul_f32 v[204:205], v[204:205], v[236:237]
    v_pk_mul_f32 v[206:207], v[206:207], v[238:239]
    s_waitcnt lgkmcnt(0)
    v_mfma_f32_16x16x32_bf16 v[240:243], a[40:43], a[120:123], v[240:243]
    v_exp_f32 v192, v192
    v_mfma_f32_16x16x32_bf16 v[240:243], a[44:47], a[136:139], v[240:243]
    v_exp_f32 v193, v193
    v_mfma_f32_16x16x32_bf16 v[244:247], a[44:47], a[140:143], v[244:247]
    v_exp_f32 v194, v194
    v_mfma_f32_16x16x32_bf16 v[244:247], a[40:43], a[124:127], v[244:247]
    v_add_f32 v192, 1.0, v192
    v_mfma_f32_16x16x32_bf16 v[248:251], a[40:43], a[128:131], v[248:251]
    v_exp_f32 v195, v195
    v_add_f32 v193, 1.0, v193
    v_mfma_f32_16x16x32_bf16 v[248:251], a[44:47], a[144:147], v[248:251]
    v_exp_f32 v196, v196
    v_mfma_f32_16x16x32_bf16 v[252:255], a[44:47], a[148:151], v[252:255]
    v_add_f32 v194, 1.0, v194
    v_mfma_f32_16x16x32_bf16 v[252:255], a[40:43], a[132:135], v[252:255]
    v_exp_f32 v197, v197
    v_add_f32 v195, 1.0, v195
    v_mfma_f32_16x16x32_bf16 v[252:255], a[48:51], a[164:167], v[252:255]
    v_exp_f32 v198, v198
    v_mfma_f32_16x16x32_bf16 v[252:255], a[52:55], a[180:183], v[252:255]
    v_add_f32 v196, 1.0, v196
    v_mfma_f32_16x16x32_bf16 v[248:251], a[52:55], a[176:179], v[248:251]
    v_exp_f32 v199, v199
    v_add_f32 v197, 1.0, v197
    v_mfma_f32_16x16x32_bf16 v[248:251], a[48:51], a[160:163], v[248:251]
    v_exp_f32 v200, v200
    v_mfma_f32_16x16x32_bf16 v[244:247], a[48:51], a[156:159], v[244:247]
    v_add_f32 v198, 1.0, v198
    v_mfma_f32_16x16x32_bf16 v[244:247], a[52:55], a[172:175], v[244:247]
    v_exp_f32 v201, v201
    v_add_f32 v199, 1.0, v199
    v_mfma_f32_16x16x32_bf16 v[240:243], a[52:55], a[168:171], v[240:243]
    v_exp_f32 v202, v202
    v_mfma_f32_16x16x32_bf16 v[240:243], a[48:51], a[152:155], v[240:243]
    v_add_f32 v200, 1.0, v200
    v_exp_f32 v203, v203
    v_add_f32 v201, 1.0, v201
    v_exp_f32 v204, v204
    v_add_f32 v202, 1.0, v202
    v_exp_f32 v205, v205
    v_add_f32 v203, 1.0, v203
    v_exp_f32 v206, v206
    v_add_f32 v204, 1.0, v204
    v_exp_f32 v207, v207
    v_add_f32 v205, 1.0, v205
    v_add_f32 v206, 1.0, v206
    v_add_f32 v207, 1.0, v207
    v_rcp_f32 v192, v192
    v_rcp_f32 v193, v193
    v_rcp_f32 v194, v194
    v_rcp_f32 v195, v195
    v_rcp_f32 v196, v196
    v_rcp_f32 v197, v197
    v_rcp_f32 v198, v198
    v_rcp_f32 v199, v199
    v_rcp_f32 v200, v200
    v_rcp_f32 v201, v201
    v_rcp_f32 v202, v202
    v_rcp_f32 v203, v203
    v_rcp_f32 v204, v204
    v_rcp_f32 v205, v205
    v_rcp_f32 v206, v206
    v_rcp_f32 v207, v207
    s_nop 0
    v_pk_mul_f32 v[224:225], v[224:225], v[240:241]
    v_pk_mul_f32 v[226:227], v[226:227], v[242:243]
    v_pk_mul_f32 v[228:229], v[228:229], v[244:245]
    v_pk_mul_f32 v[230:231], v[230:231], v[246:247]
    v_pk_mul_f32 v[224:225], v[224:225], v[192:193]
    v_pk_mul_f32 v[226:227], v[226:227], v[194:195]
    v_pk_mul_f32 v[228:229], v[228:229], v[196:197]
    v_pk_mul_f32 v[230:231], v[230:231], v[198:199]
    v_cvt_pk_bf16_f32 v210, v224, v225
    v_cvt_pk_bf16_f32 v211, v226, v227
    v_cvt_pk_bf16_f32 v214, v228, v229
    v_cvt_pk_bf16_f32 v215, v230, v231
    v_pk_mul_f32 v[232:233], v[232:233], v[248:249]
    v_pk_mul_f32 v[234:235], v[234:235], v[250:251]
    v_pk_mul_f32 v[236:237], v[236:237], v[252:253]
    v_pk_mul_f32 v[238:239], v[238:239], v[254:255]
    v_pk_mul_f32 v[232:233], v[232:233], v[200:201]
    v_pk_mul_f32 v[234:235], v[234:235], v[202:203]
    v_pk_mul_f32 v[236:237], v[236:237], v[204:205]
    v_pk_mul_f32 v[238:239], v[238:239], v[206:207]
    v_cvt_pk_bf16_f32 v218, v232, v233
    v_cvt_pk_bf16_f32 v219, v234, v235
    v_cvt_pk_bf16_f32 v222, v236, v237
    v_cvt_pk_bf16_f32 v223, v238, v239
    buffer_store_dwordx4 v[208:211], v1, s[88:91], s34 offen offset:0 sc1
    buffer_store_dwordx4 v[212:215], v1, s[88:91], s34 offen offset:1024 sc1
    buffer_store_dwordx4 v[216:219], v1, s[88:91], s35 offen offset:0 sc1
    buffer_store_dwordx4 v[220:223], v1, s[88:91], s35 offen offset:1024 sc1
    s_mul_i32 s23, s96, 768
    s_lshl_b32 s30, s20, 5
    s_add_u32 s23, s23, s30
    s_add_u32 s23, s23, s21
    s_add_u32 s97, s23, 256
    s_add_u32 s80, s16, 28385280
    s_addc_u32 s81, s17, 0
    s_mov_b32 s82, 2048
    s_mov_b32 s83, 0x20000
    v_and_b32 v28, 15, v0
    v_lshlrev_b32 v28, 7, v28
    buffer_load_dword v29, v28, s[80:83], 0 offen sc1
    s_cmp_lg_u32 s96, 0
    s_cbranch_scc1 Lg2f
Lg2m:
    s_and_b32 s18, s2, 7
    s_lshr_b32 s19, s2, 3
    s_and_b32 s27, s18, 1
    s_and_b32 s20, s19, 3
    s_lshr_b32 s22, s18, 1
    s_lshl_b32 s22, s22, 2
    s_add_u32 s20, s20, s22
    s_lshr_b32 s21, s19, 2
    v_lshlrev_b32 v1, 4, v0
    s_lshl_b32 s22, s20, 2
    s_add_u32 s22, s22, s3
    s_lshl_b32 s26, s3, 12
    s_mul_i32 s24, s27, 114688
    s_mul_i32 s25, s27, 458752
    s_add_u32 s25, s25, s26
    s_mul_i32 s23, s22, 229376
    s_add_u32 s23, s23, 12582912
    s_mul_i32 s30, s21, 917504
    s_add_u32 s30, s30, 46137344
    s_add_u32 s8, s16, s30
    s_addc_u32 s9, s17, 0
    s_mov_b32 s10, 917504
    s_mov_b32 s11, 0x20000
    s_add_u32 s4, s16, s23
    s_addc_u32 s5, s17, 0
    s_mov_b32 s6, 229376
    s_mov_b32 s7, 0x20000
    s_add_u32 s4, s4, s24
    s_addc_u32 s5, s5, 0
    s_mov_b32 s6, 114688
    s_add_u32 s8, s8, s25
    s_addc_u32 s9, s9, 0
    s_mov_b32 s10, 458752
    s_add_u32 s37, s20, s21
    s_and_b32 s37, s37, 3
    s_lshl_b32 s18, 0x11111111, s37
    s_lshl_b32 s19, 0xffffff, s37
    s_cmp_eq_u32 s37, 0
    s_cselect_b32 s19, 0xfffffff, s19
    s_not_b32 s19, s19
    s_mov_b32 s79, 0
    s_bitcmp1_b32 s18, s79
    s_cselect_b32 s78, 3, -1
    s_bitcmp1_b32 s19, s79
    s_cselect_b32 s78, 0, s78
    s_add_u32 s78, s78, s79
    s_add_u32 s79, s79, 1
    s_mov_b32 s37, 1
    s_lshl_b32 s24, s78, 12
    s_lshl_b32 s25, s78, 14
    s_lshl_b32 s23, s27, 12
    v_add_u32 v8, s23, v1
    s_xor_b32 s23, s23, 4096
    v_add_u32 v6, s23, v1
    v_add_u32 v7, 114688, v6
    v_add_u32 v9, 114688, v8
    s_lshr_b32 s36, s22, 1
    s_lshl_b32 s36, s36, 17
    s_and_b32 s23, s22, 1
    s_lshl_b32 s23, s23, 11
    s_add_u32 s36, s36, s23
    s_lshl_b32 s23, s21, 14
    s_add_u32 s36, s36, s23
    s_lshl_b32 s23, s27, 13
    s_add_u32 s72, s36, s23
    s_add_u32 s73, s72, 4096
    s_xor_b32 s74, s72, 8192
    s_add_u32 s75, s74, 4096
    s_mul_i32 s23, s27, 4194304
    s_add_u32 s23, s23, 83886080
    s_add_u32 s32, s16, s23
    s_addc_u32 s33, s17, 0
    s_mov_b32 s34, 4194304
    s_mov_b32 s35, 0x20000
    s_getpc_b64 s[84:85]
Lpf3:
    s_add_u32 s84, s84, (Lg1-Lpf3)&0xffffffff
    s_addc_u32 s85, s85, ((Lg1-Lpf3)>>32)&0xffffffff
    s_lshr_b32 s86, s2, 3
    s_lshl_b32 s86, s86, 2
    s_add_u32 s86, s86, s3
    s_lshl_b32 s86, s86, 10
    v_lshrrev_b32 v23, 3, v0
    v_lshl_add_u32 v23, v23, 7, s86
    v_min_u32 v23, Lg2m-Lg1-4, v23
    v_add_co_u32 v22, vcc, s84, v23
    v_mov_b32 v23, s85
    s_nop 0
    v_addc_co_u32 v23, vcc, 0, v23, vcc
    s_and_b32 s23, s20, 14
    s_add_u32 s23, s23, s27
    s_lshl_b32 s23, s23, 4
    s_add_u32 s23, s23, 256
    s_andn2_b32 s90, s97, 15
    s_lshl_b32 s90, s90, 7
    s_add_u32 s90, s90, 28442624
    s_add_u32 s88, s16, s90
    s_addc_u32 s89, s17, 0
    s_cmp_eq_u32 s3, 0
    s_cselect_b32 s90, 1024, 0
    s_mov_b32 s91, 0x20000
    v_mov_b32 v24, 1
    v_lshlrev_b32 v25, 7, v0
    s_waitcnt vmcnt(0)
    s_barrier
    buffer_atomic_add v24, v25, s[88:91], 0 offen sc1
    s_mov_b32 s94, 1048576
Lg2m_cchk:
    v_cmp_gt_u32 vcc, 64, v29
    s_nop 1
    s_cmp_eq_u64 vcc, 0
    s_cbranch_scc1 Lg2m_cok
    buffer_load_dword v29, v28, s[80:83], 0 offen sc1
    s_waitcnt vmcnt(0)
    s_sub_u32 s94, s94, 1
    s_cbranch_scc0 Lg2m_cchk
Lg2m_cok:
    s_add_u32 m0, s26, 0
    s_nop 0
    buffer_load_dwordx4 v1, s[8:11], s25 offen offset:0 sc1 lds
    buffer_load_dwordx4 v1, s[8:11], s25 offen offset:1024 sc1 lds
    buffer_load_dwordx4 v1, s[8:11], s25 offen offset:2048 sc1 lds
    buffer_load_dwordx4 v1, s[8:11], s25 offen offset:3072 sc1 lds
    s_bitcmp1_b32 s18, s79
    s_cselect_b32 s78, 3, -1
    s_bitcmp1_b32 s19, s79
    s_cselect_b32 s78, 0, s78
    s_add_u32 s78, s78, s79
    s_add_u32 s79, s79, 1
    s_lshl_b32 s25, s78, 14
    s_add_u32 m0, s26, 16384
    s_nop 0
    buffer_load_dwordx4 v1, s[8:11], s25 offen offset:0 sc1 lds
    buffer_load_dwordx4 v1, s[8:11], s25 offen offset:1024 sc1 lds
    buffer_load_dwordx4 v1, s[8:11], s25 offen offset:2048 sc1 lds
    buffer_load_dwordx4 v1, s[8:11], s25 offen offset:3072 sc1 lds
    s_bitcmp1_b32 s18, s79
    s_cselect_b32 s78, 3, -1
    s_bitcmp1_b32 s19, s79
    s_cselect_b32 s78, 0, s78
    s_add_u32 s78, s78, s79
    s_add_u32 s79, s79, 1
    s_lshl_b32 s25, s78, 14
    s_add_u32 m0, s26, 32768
    s_nop 0
    buffer_load_dwordx4 v1, s[8:11], s25 offen offset:0 sc1 lds
    buffer_load_dwordx4 v1, s[8:11], s25 offen offset:1024 sc1 lds
    buffer_load_dwordx4 v1, s[8:11], s25 offen offset:2048 sc1 lds
    buffer_load_dwordx4 v1, s[8:11], s25 offen offset:3072 sc1 lds
    s_lshl_b32 s77, s20, 3
    s_add_u32 s77, s77, s21
    s_cmp_lg_u32 s3, 0
    s_cbranch_scc1 Lw2_join
    s_and_b32 s90, s77, 7
    s_add_u32 s90, s90, s23
    s_lshl_b32 s90, s90, 7
    s_add_u32 s90, s90, 28442624
    s_add_u32 s88, s16, s90
    s_addc_u32 s89, s17, 0
    s_mov_b32 s90, 4
    s_mov_b32 s91, 0x20000
    v_lshlrev_b32 v24, 4, v0
    s_mov_b32 s92, 1048576
Lw2_poll:
    v_mov_b32 v25, 0
    buffer_atomic_or v25, v24, s[88:91], 0 offen sc0 sc1
    s_sub_u32 s92, s92, 1
    s_cbranch_scc1 Lw2_join
    s_waitcnt vmcnt(0)
    v_readfirstlane_b32 vcc_lo, v25
    s_nop 1
    s_cmp_lg_u32 vcc_lo, 16
    s_cbranch_scc1 Lw2_poll
Lw2_join:
    s_waitcnt vmcnt(8)
    s_barrier
    buffer_load_dwordx4 a[0:3], v1, s[4:7], s24 offen offset:0 sc1
    s_bitcmp1_b32 s18, s37
    s_cselect_b32 s78, 3, -1
    buffer_load_dwordx4 a[4:7], v1, s[4:7], s24 offen offset:1024 sc1
    s_bitcmp1_b32 s19, s37
    s_cselect_b32 s78, 0, s78
    buffer_load_dwordx4 a[8:11], v1, s[4:7], s24 offen offset:2048 sc1
    s_add_u32 s78, s78, s37
    s_add_u32 s37, s37, 1
    buffer_load_dwordx4 a[12:15], v1, s[4:7], s24 offen offset:3072 sc1
    s_lshl_b32 s24, s78, 12
    s_lshl_b32 s25, s78, 14
    buffer_load_dwordx4 a[16:19], v1, s[4:7], s24 offen offset:0 sc1
    s_bitcmp1_b32 s18, s37
    s_cselect_b32 s78, 3, -1
    buffer_load_dwordx4 a[20:23], v1, s[4:7], s24 offen offset:1024 sc1
    s_bitcmp1_b32 s19, s37
    s_cselect_b32 s78, 0, s78
    buffer_load_dwordx4 a[24:27], v1, s[4:7], s24 offen offset:2048 sc1
    s_add_u32 s78, s78, s37
    s_add_u32 s37, s37, 1
    buffer_load_dwordx4 a[28:31], v1, s[4:7], s24 offen offset:3072 sc1
    s_lshl_b32 s24, s78, 12
    s_lshl_b32 s25, s78, 14
    buffer_load_dwordx4 a[32:35], v1, s[4:7], s24 offen offset:0 sc1
    s_bitcmp1_b32 s18, s37
    s_cselect_b32 s78, 3, -1
    buffer_load_dwordx4 a[36:39], v1, s[4:7], s24 offen offset:1024 sc1
    s_bitcmp1_b32 s19, s37
    s_cselect_b32 s78, 0, s78
    buffer_load_dwordx4 a[40:43], v1, s[4:7], s24 offen offset:2048 sc1
    s_add_u32 s78, s78, s37
    s_add_u32 s37, s37, 1
    buffer_load_dwordx4 a[44:47], v1, s[4:7], s24 offen offset:3072 sc1
    s_lshl_b32 s24, s78, 12
    s_lshl_b32 s25, s78, 14
    ds_read_b128 v[96:99], v6 offset:0
    ds_read_b128 v[100:103], v6 offset:8192
    ds_read_b128 v[104:107], v6 offset:1024
    ds_read_b128 v[108:111], v6 offset:9216
    ds_read_b128 v[112:115], v6 offset:2048
    ds_read_b128 v[116:119], v6 offset:10240
    ds_read_b128 v[120:123], v6 offset:3072
    ds_read_b128 v[124:127], v6 offset:11264
    ds_read_b128 v[128:131], v8 offset:0
    ds_read_b128 v[132:135], v8 offset:8192
    ds_read_b128 v[136:139], v8 offset:1024
    ds_read_b128 v[140:143], v8 offset:9216
    ds_read_b128 v[144:147], v8 offset:2048
    ds_read_b128 v[148:151], v8 offset:10240
    ds_read_b128 v[152:155], v8 offset:3072
    ds_read_b128 v[156:159], v8 offset:11264
    s_waitcnt vmcnt(8) lgkmcnt(8)
    v_mfma_f32_16x16x32_bf16 v[32:35], v[96:99], a[0:3], 0
    v_mfma_f32_16x16x32_bf16 v[32:35], v[100:103], a[8:11], v[32:35]
    v_mfma_f32_16x16x32_bf16 v[36:39], v[100:103], a[12:15], 0
    v_mfma_f32_16x16x32_bf16 v[36:39], v[96:99], a[4:7], v[36:39]
    s_barrier
    v_mfma_f32_16x16x32_bf16 v[44:47], v[104:107], a[4:7], 0
    ds_read_b128 v[96:99], v6 offset:16384
    s_add_u32 m0, s26, 114688
    v_mfma_f32_16x16x32_bf16 v[44:47], v[108:111], a[12:15], v[44:47]
    buffer_load_dwordx4 v1, s[8:11], s25 offen offset:0 sc1 lds
    v_mfma_f32_16x16x32_bf16 v[40:43], v[108:111], a[8:11], 0
    ds_read_b128 v[100:103], v6 offset:24576
    v_mfma_f32_16x16x32_bf16 v[40:43], v[104:107], a[0:3], v[40:43]
    v_mfma_f32_16x16x32_bf16 v[48:51], v[112:115], a[0:3], 0
    ds_read_b128 v[104:107], v6 offset:17408
    v_mfma_f32_16x16x32_bf16 v[48:51], v[116:119], a[8:11], v[48:51]
    buffer_load_dwordx4 v1, s[8:11], s25 offen offset:1024 sc1 lds
    v_mfma_f32_16x16x32_bf16 v[52:55], v[116:119], a[12:15], 0
    ds_read_b128 v[108:111], v6 offset:25600
    v_mfma_f32_16x16x32_bf16 v[52:55], v[112:115], a[4:7], v[52:55]
    v_mfma_f32_16x16x32_bf16 v[60:63], v[120:123], a[4:7], 0
    ds_read_b128 v[112:115], v6 offset:18432
    v_mfma_f32_16x16x32_bf16 v[60:63], v[124:127], a[12:15], v[60:63]
    buffer_load_dwordx4 v1, s[8:11], s25 offen offset:2048 sc1 lds
    v_mfma_f32_16x16x32_bf16 v[56:59], v[124:127], a[8:11], 0
    ds_read_b128 v[116:119], v6 offset:26624
    v_mfma_f32_16x16x32_bf16 v[56:59], v[120:123], a[0:3], v[56:59]
    s_waitcnt lgkmcnt(6)
    v_mfma_f32_16x16x32_bf16 v[64:67], v[128:131], a[0:3], 0
    ds_read_b128 v[120:123], v6 offset:19456
    v_mfma_f32_16x16x32_bf16 v[64:67], v[132:135], a[8:11], v[64:67]
    buffer_load_dwordx4 v1, s[8:11], s25 offen offset:3072 sc1 lds
    v_mfma_f32_16x16x32_bf16 v[68:71], v[132:135], a[12:15], 0
    ds_read_b128 v[124:127], v6 offset:27648
    v_mfma_f32_16x16x32_bf16 v[68:71], v[128:131], a[4:7], v[68:71]
    v_mfma_f32_16x16x32_bf16 v[76:79], v[136:139], a[4:7], 0
    ds_read_b128 v[128:131], v8 offset:16384
    v_mfma_f32_16x16x32_bf16 v[76:79], v[140:143], a[12:15], v[76:79]
    buffer_load_dwordx4 a[48:51], v1, s[4:7], s24 offen offset:0 sc1
    v_mfma_f32_16x16x32_bf16 v[72:75], v[140:143], a[8:11], 0
    ds_read_b128 v[132:135], v8 offset:24576
    v_mfma_f32_16x16x32_bf16 v[72:75], v[136:139], a[0:3], v[72:75]
    s_bitcmp1_b32 s18, s37
    s_cselect_b32 s78, 3, -1
    v_mfma_f32_16x16x32_bf16 v[80:83], v[144:147], a[0:3], 0
    ds_read_b128 v[136:139], v8 offset:17408
    v_mfma_f32_16x16x32_bf16 v[80:83], v[148:151], a[8:11], v[80:83]
    buffer_load_dwordx4 a[52:55], v1, s[4:7], s24 offen offset:1024 sc1
    v_mfma_f32_16x16x32_bf16 v[84:87], v[148:151], a[12:15], 0
    ds_read_b128 v[140:143], v8 offset:25600
    v_mfma_f32_16x16x32_bf16 v[84:87], v[144:147], a[4:7], v[84:87]
    s_bitcmp1_b32 s19, s37
    s_cselect_b32 s78, 0, s78
    v_mfma_f32_16x16x32_bf16 v[92:95], v[152:155], a[4:7], 0
    ds_read_b128 v[144:147], v8 offset:18432
    v_mfma_f32_16x16x32_bf16 v[92:95], v[156:159], a[12:15], v[92:95]
    buffer_load_dwordx4 a[56:59], v1, s[4:7], s24 offen offset:2048 sc1
    v_mfma_f32_16x16x32_bf16 v[88:91], v[156:159], a[8:11], 0
    ds_read_b128 v[148:151], v8 offset:26624
    v_mfma_f32_16x16x32_bf16 v[88:91], v[152:155], a[0:3], v[88:91]
    s_add_u32 s78, s78, s37
    s_add_u32 s37, s37, 1
    s_waitcnt vmcnt(11) lgkmcnt(6)
    v_mfma_f32_16x16x32_bf16 v[32:35], v[96:99], a[16:19], v[32:35]
    ds_read_b128 v[152:155], v8 offset:19456
    v_mfma_f32_16x16x32_bf16 v[32:35], v[100:103], a[24:27], v[32:35]
    buffer_load_dwordx4 a[60:63], v1, s[4:7], s24 offen offset:3072 sc1
    v_mfma_f32_16x16x32_bf16 v[36:39], v[100:103], a[28:31], v[36:39]
    ds_read_b128 v[156:159], v8 offset:27648
    v_mfma_f32_16x16x32_bf16 v[36:39], v[96:99], a[20:23], v[36:39]
    s_barrier
    s_lshl_b32 s24, s78, 12
    s_lshl_b32 s25, s78, 14
    v_mfma_f32_16x16x32_bf16 v[44:47], v[104:107], a[20:23], v[44:47]
    ds_read_b128 v[96:99], v6 offset:32768
    s_add_u32 m0, s26, 0
    v_mfma_f32_16x16x32_bf16 v[44:47], v[108:111], a[28:31], v[44:47]
    buffer_load_dwordx4 v1, s[8:11], s25 offen offset:0 sc1 lds
    v_mfma_f32_16x16x32_bf16 v[40:43], v[108:111], a[24:27], v[40:43]
    ds_read_b128 v[100:103], v6 offset:40960
    v_mfma_f32_16x16x32_bf16 v[40:43], v[104:107], a[16:19], v[40:43]
    v_mfma_f32_16x16x32_bf16 v[48:51], v[112:115], a[16:19], v[48:51]
    ds_read_b128 v[104:107], v6 offset:33792
    v_mfma_f32_16x16x32_bf16 v[48:51], v[116:119], a[24:27], v[48:51]
    buffer_load_dwordx4 v1, s[8:11], s25 offen offset:1024 sc1 lds
    v_mfma_f32_16x16x32_bf16 v[52:55], v[116:119], a[28:31], v[52:55]
    ds_read_b128 v[108:111], v6 offset:41984
    v_mfma_f32_16x16x32_bf16 v[52:55], v[112:115], a[20:23], v[52:55]
    v_mfma_f32_16x16x32_bf16 v[60:63], v[120:123], a[20:23], v[60:63]
    ds_read_b128 v[112:115], v6 offset:34816
    v_mfma_f32_16x16x32_bf16 v[60:63], v[124:127], a[28:31], v[60:63]
    buffer_load_dwordx4 v1, s[8:11], s25 offen offset:2048 sc1 lds
    v_mfma_f32_16x16x32_bf16 v[56:59], v[124:127], a[24:27], v[56:59]
    ds_read_b128 v[116:119], v6 offset:43008
    v_mfma_f32_16x16x32_bf16 v[56:59], v[120:123], a[16:19], v[56:59]
    s_waitcnt lgkmcnt(6)
    v_mfma_f32_16x16x32_bf16 v[64:67], v[128:131], a[16:19], v[64:67]
    ds_read_b128 v[120:123], v6 offset:35840
    v_mfma_f32_16x16x32_bf16 v[64:67], v[132:135], a[24:27], v[64:67]
    buffer_load_dwordx4 v1, s[8:11], s25 offen offset:3072 sc1 lds
    v_mfma_f32_16x16x32_bf16 v[68:71], v[132:135], a[28:31], v[68:71]
    ds_read_b128 v[124:127], v6 offset:44032
    v_mfma_f32_16x16x32_bf16 v[68:71], v[128:131], a[20:23], v[68:71]
    v_mfma_f32_16x16x32_bf16 v[76:79], v[136:139], a[20:23], v[76:79]
    ds_read_b128 v[128:131], v8 offset:32768
    v_mfma_f32_16x16x32_bf16 v[76:79], v[140:143], a[28:31], v[76:79]
    buffer_load_dwordx4 a[0:3], v1, s[4:7], s24 offen offset:0 sc1
    v_mfma_f32_16x16x32_bf16 v[72:75], v[140:143], a[24:27], v[72:75]
    ds_read_b128 v[132:135], v8 offset:40960
    v_mfma_f32_16x16x32_bf16 v[72:75], v[136:139], a[16:19], v[72:75]
    s_bitcmp1_b32 s18, s37
    s_cselect_b32 s78, 3, -1
    v_mfma_f32_16x16x32_bf16 v[80:83], v[144:147], a[16:19], v[80:83]
    ds_read_b128 v[136:139], v8 offset:33792
    v_mfma_f32_16x16x32_bf16 v[80:83], v[148:151], a[24:27], v[80:83]
    buffer_load_dwordx4 a[4:7], v1, s[4:7], s24 offen offset:1024 sc1
    v_mfma_f32_16x16x32_bf16 v[84:87], v[148:151], a[28:31], v[84:87]
    ds_read_b128 v[140:143], v8 offset:41984
    v_mfma_f32_16x16x32_bf16 v[84:87], v[144:147], a[20:23], v[84:87]
    s_bitcmp1_b32 s19, s37
    s_cselect_b32 s78, 0, s78
    v_mfma_f32_16x16x32_bf16 v[92:95], v[152:155], a[20:23], v[92:95]
    ds_read_b128 v[144:147], v8 offset:34816
    v_mfma_f32_16x16x32_bf16 v[92:95], v[156:159], a[28:31], v[92:95]
    buffer_load_dwordx4 a[8:11], v1, s[4:7], s24 offen offset:2048 sc1
    v_mfma_f32_16x16x32_bf16 v[88:91], v[156:159], a[24:27], v[88:91]
    ds_read_b128 v[148:151], v8 offset:43008
    v_mfma_f32_16x16x32_bf16 v[88:91], v[152:155], a[16:19], v[88:91]
    s_add_u32 s78, s78, s37
    s_add_u32 s37, s37, 1
    s_mov_b32 s76, 5
Lg2m_loop:
    s_waitcnt vmcnt(15) lgkmcnt(6)
    v_mfma_f32_16x16x32_bf16 v[32:35], v[96:99], a[32:35], v[32:35]
    ds_read_b128 v[152:155], v8 offset:35840
    v_mfma_f32_16x16x32_bf16 v[32:35], v[100:103], a[40:43], v[32:35]
    buffer_load_dwordx4 a[12:15], v1, s[4:7], s24 offen offset:3072 sc1
    v_mfma_f32_16x16x32_bf16 v[36:39], v[100:103], a[44:47], v[36:39]
    ds_read_b128 v[156:159], v8 offset:44032
    v_mfma_f32_16x16x32_bf16 v[36:39], v[96:99], a[36:39], v[36:39]
    s_waitcnt vmcnt(12)
    s_barrier
    s_lshl_b32 s24, s78, 12
    s_lshl_b32 s25, s78, 14
    v_mfma_f32_16x16x32_bf16 v[44:47], v[104:107], a[36:39], v[44:47]
    ds_read_b128 v[96:99], v7 offset:0
    s_add_u32 m0, s26, 16384
    v_mfma_f32_16x16x32_bf16 v[44:47], v[108:111], a[44:47], v[44:47]
    buffer_load_dwordx4 v1, s[8:11], s25 offen offset:0 sc1 lds
    v_mfma_f32_16x16x32_bf16 v[40:43], v[108:111], a[40:43], v[40:43]
    ds_read_b128 v[100:103], v7 offset:8192
    v_mfma_f32_16x16x32_bf16 v[40:43], v[104:107], a[32:35], v[40:43]
    v_mfma_f32_16x16x32_bf16 v[48:51], v[112:115], a[32:35], v[48:51]
    ds_read_b128 v[104:107], v7 offset:1024
    v_mfma_f32_16x16x32_bf16 v[48:51], v[116:119], a[40:43], v[48:51]
    buffer_load_dwordx4 v1, s[8:11], s25 offen offset:1024 sc1 lds
    v_mfma_f32_16x16x32_bf16 v[52:55], v[116:119], a[44:47], v[52:55]
    ds_read_b128 v[108:111], v7 offset:9216
    v_mfma_f32_16x16x32_bf16 v[52:55], v[112:115], a[36:39], v[52:55]
    v_mfma_f32_16x16x32_bf16 v[60:63], v[120:123], a[36:39], v[60:63]
    ds_read_b128 v[112:115], v7 offset:2048
    v_mfma_f32_16x16x32_bf16 v[60:63], v[124:127], a[44:47], v[60:63]
    buffer_load_dwordx4 v1, s[8:11], s25 offen offset:2048 sc1 lds
    v_mfma_f32_16x16x32_bf16 v[56:59], v[124:127], a[40:43], v[56:59]
    ds_read_b128 v[116:119], v7 offset:10240
    v_mfma_f32_16x16x32_bf16 v[56:59], v[120:123], a[32:35], v[56:59]
    s_waitcnt lgkmcnt(6)
    v_mfma_f32_16x16x32_bf16 v[64:67], v[128:131], a[32:35], v[64:67]
    ds_read_b128 v[120:123], v7 offset:3072
    v_mfma_f32_16x16x32_bf16 v[64:67], v[132:135], a[40:43], v[64:67]
    buffer_load_dwordx4 v1, s[8:11], s25 offen offset:3072 sc1 lds
    v_mfma_f32_16x16x32_bf16 v[68:71], v[132:135], a[44:47], v[68:71]
    ds_read_b128 v[124:127], v7 offset:11264
    v_mfma_f32_16x16x32_bf16 v[68:71], v[128:131], a[36:39], v[68:71]
    v_mfma_f32_16x16x32_bf16 v[76:79], v[136:139], a[36:39], v[76:79]
    ds_read_b128 v[128:131], v9 offset:0
    v_mfma_f32_16x16x32_bf16 v[76:79], v[140:143], a[44:47], v[76:79]
    buffer_load_dwordx4 a[16:19], v1, s[4:7], s24 offen offset:0 sc1
    v_mfma_f32_16x16x32_bf16 v[72:75], v[140:143], a[40:43], v[72:75]
    ds_read_b128 v[132:135], v9 offset:8192
    v_mfma_f32_16x16x32_bf16 v[72:75], v[136:139], a[32:35], v[72:75]
    s_bitcmp1_b32 s18, s37
    s_cselect_b32 s78, 3, -1
    v_mfma_f32_16x16x32_bf16 v[80:83], v[144:147], a[32:35], v[80:83]
    ds_read_b128 v[136:139], v9 offset:1024
    v_mfma_f32_16x16x32_bf16 v[80:83], v[148:151], a[40:43], v[80:83]
    buffer_load_dwordx4 a[20:23], v1, s[4:7], s24 offen offset:1024 sc1
    v_mfma_f32_16x16x32_bf16 v[84:87], v[148:151], a[44:47], v[84:87]
    ds_read_b128 v[140:143], v9 offset:9216
    v_mfma_f32_16x16x32_bf16 v[84:87], v[144:147], a[36:39], v[84:87]
    s_bitcmp1_b32 s19, s37
    s_cselect_b32 s78, 0, s78
    v_mfma_f32_16x16x32_bf16 v[92:95], v[152:155], a[36:39], v[92:95]
    ds_read_b128 v[144:147], v9 offset:2048
    v_mfma_f32_16x16x32_bf16 v[92:95], v[156:159], a[44:47], v[92:95]
    buffer_load_dwordx4 a[24:27], v1, s[4:7], s24 offen offset:2048 sc1
    v_mfma_f32_16x16x32_bf16 v[88:91], v[156:159], a[40:43], v[88:91]
    ds_read_b128 v[148:151], v9 offset:10240
    v_mfma_f32_16x16x32_bf16 v[88:91], v[152:155], a[32:35], v[88:91]
    s_add_u32 s78, s78, s37
    s_add_u32 s37, s37, 1
    s_waitcnt vmcnt(15) lgkmcnt(6)
    v_mfma_f32_16x16x32_bf16 v[32:35], v[96:99], a[48:51], v[32:35]
    ds_read_b128 v[152:155], v9 offset:3072
    v_mfma_f32_16x16x32_bf16 v[32:35], v[100:103], a[56:59], v[32:35]
    buffer_load_dwordx4 a[28:31], v1, s[4:7], s24 offen offset:3072 sc1
    v_mfma_f32_16x16x32_bf16 v[36:39], v[100:103], a[60:63], v[36:39]
    ds_read_b128 v[156:159], v9 offset:11264
    v_mfma_f32_16x16x32_bf16 v[36:39], v[96:99], a[52:55], v[36:39]
    s_waitcnt vmcnt(12)
    s_barrier
    s_lshl_b32 s24, s78, 12
    s_lshl_b32 s25, s78, 14
    v_mfma_f32_16x16x32_bf16 v[44:47], v[104:107], a[52:55], v[44:47]
    ds_read_b128 v[96:99], v6 offset:0
    s_add_u32 m0, s26, 32768
    v_mfma_f32_16x16x32_bf16 v[44:47], v[108:111], a[60:63], v[44:47]
    buffer_load_dwordx4 v1, s[8:11], s25 offen offset:0 sc1 lds
    v_mfma_f32_16x16x32_bf16 v[40:43], v[108:111], a[56:59], v[40:43]
    ds_read_b128 v[100:103], v6 offset:8192
    v_mfma_f32_16x16x32_bf16 v[40:43], v[104:107], a[48:51], v[40:43]
    v_mfma_f32_16x16x32_bf16 v[48:51], v[112:115], a[48:51], v[48:51]
    ds_read_b128 v[104:107], v6 offset:1024
    v_mfma_f32_16x16x32_bf16 v[48:51], v[116:119], a[56:59], v[48:51]
    buffer_load_dwordx4 v1, s[8:11], s25 offen offset:1024 sc1 lds
    v_mfma_f32_16x16x32_bf16 v[52:55], v[116:119], a[60:63], v[52:55]
    ds_read_b128 v[108:111], v6 offset:9216
    v_mfma_f32_16x16x32_bf16 v[52:55], v[112:115], a[52:55], v[52:55]
    v_mfma_f32_16x16x32_bf16 v[60:63], v[120:123], a[52:55], v[60:63]
    ds_read_b128 v[112:115], v6 offset:2048
    v_mfma_f32_16x16x32_bf16 v[60:63], v[124:127], a[60:63], v[60:63]
    buffer_load_dwordx4 v1, s[8:11], s25 offen offset:2048 sc1 lds
    v_mfma_f32_16x16x32_bf16 v[56:59], v[124:127], a[56:59], v[56:59]
    ds_read_b128 v[116:119], v6 offset:10240
    v_mfma_f32_16x16x32_bf16 v[56:59], v[120:123], a[48:51], v[56:59]
    s_waitcnt lgkmcnt(6)
    v_mfma_f32_16x16x32_bf16 v[64:67], v[128:131], a[48:51], v[64:67]
    ds_read_b128 v[120:123], v6 offset:3072
    v_mfma_f32_16x16x32_bf16 v[64:67], v[132:135], a[56:59], v[64:67]
    buffer_load_dwordx4 v1, s[8:11], s25 offen offset:3072 sc1 lds
    v_mfma_f32_16x16x32_bf16 v[68:71], v[132:135], a[60:63], v[68:71]
    ds_read_b128 v[124:127], v6 offset:11264
    v_mfma_f32_16x16x32_bf16 v[68:71], v[128:131], a[52:55], v[68:71]
    v_mfma_f32_16x16x32_bf16 v[76:79], v[136:139], a[52:55], v[76:79]
    ds_read_b128 v[128:131], v8 offset:0
    v_mfma_f32_16x16x32_bf16 v[76:79], v[140:143], a[60:63], v[76:79]
    buffer_load_dwordx4 a[32:35], v1, s[4:7], s24 offen offset:0 sc1
    v_mfma_f32_16x16x32_bf16 v[72:75], v[140:143], a[56:59], v[72:75]
    ds_read_b128 v[132:135], v8 offset:8192
    v_mfma_f32_16x16x32_bf16 v[72:75], v[136:139], a[48:51], v[72:75]
    s_bitcmp1_b32 s18, s37
    s_cselect_b32 s78, 3, -1
    v_mfma_f32_16x16x32_bf16 v[80:83], v[144:147], a[48:51], v[80:83]
    ds_read_b128 v[136:139], v8 offset:1024
    v_mfma_f32_16x16x32_bf16 v[80:83], v[148:151], a[56:59], v[80:83]
    buffer_load_dwordx4 a[36:39], v1, s[4:7], s24 offen offset:1024 sc1
    v_mfma_f32_16x16x32_bf16 v[84:87], v[148:151], a[60:63], v[84:87]
    ds_read_b128 v[140:143], v8 offset:9216
    v_mfma_f32_16x16x32_bf16 v[84:87], v[144:147], a[52:55], v[84:87]
    s_bitcmp1_b32 s19, s37
    s_cselect_b32 s78, 0, s78
    v_mfma_f32_16x16x32_bf16 v[92:95], v[152:155], a[52:55], v[92:95]
    ds_read_b128 v[144:147], v8 offset:2048
    v_mfma_f32_16x16x32_bf16 v[92:95], v[156:159], a[60:63], v[92:95]
    buffer_load_dwordx4 a[40:43], v1, s[4:7], s24 offen offset:2048 sc1
    v_mfma_f32_16x16x32_bf16 v[88:91], v[156:159], a[56:59], v[88:91]
    ds_read_b128 v[148:151], v8 offset:10240
    v_mfma_f32_16x16x32_bf16 v[88:91], v[152:155], a[48:51], v[88:91]
    s_add_u32 s78, s78, s37
    s_add_u32 s37, s37, 1
    s_waitcnt vmcnt(15) lgkmcnt(6)
    v_mfma_f32_16x16x32_bf16 v[32:35], v[96:99], a[0:3], v[32:35]
    ds_read_b128 v[152:155], v8 offset:3072
    v_mfma_f32_16x16x32_bf16 v[32:35], v[100:103], a[8:11], v[32:35]
    buffer_load_dwordx4 a[44:47], v1, s[4:7], s24 offen offset:3072 sc1
    v_mfma_f32_16x16x32_bf16 v[36:39], v[100:103], a[12:15], v[36:39]
    ds_read_b128 v[156:159], v8 offset:11264
    v_mfma_f32_16x16x32_bf16 v[36:39], v[96:99], a[4:7], v[36:39]
    s_waitcnt vmcnt(12)
    s_barrier
    s_lshl_b32 s24, s78, 12
    s_lshl_b32 s25, s78, 14
    v_mfma_f32_16x16x32_bf16 v[44:47], v[104:107], a[4:7], v[44:47]
    ds_read_b128 v[96:99], v6 offset:16384
    s_add_u32 m0, s26, 114688
    v_mfma_f32_16x16x32_bf16 v[44:47], v[108:111], a[12:15], v[44:47]
    buffer_load_dwordx4 v1, s[8:11], s25 offen offset:0 sc1 lds
    v_mfma_f32_16x16x32_bf16 v[40:43], v[108:111], a[8:11], v[40:43]
    ds_read_b128 v[100:103], v6 offset:24576
    v_mfma_f32_16x16x32_bf16 v[40:43], v[104:107], a[0:3], v[40:43]
    v_mfma_f32_16x16x32_bf16 v[48:51], v[112:115], a[0:3], v[48:51]
    ds_read_b128 v[104:107], v6 offset:17408
    v_mfma_f32_16x16x32_bf16 v[48:51], v[116:119], a[8:11], v[48:51]
    buffer_load_dwordx4 v1, s[8:11], s25 offen offset:1024 sc1 lds
    v_mfma_f32_16x16x32_bf16 v[52:55], v[116:119], a[12:15], v[52:55]
    ds_read_b128 v[108:111], v6 offset:25600
    v_mfma_f32_16x16x32_bf16 v[52:55], v[112:115], a[4:7], v[52:55]
    v_mfma_f32_16x16x32_bf16 v[60:63], v[120:123], a[4:7], v[60:63]
    ds_read_b128 v[112:115], v6 offset:18432
    v_mfma_f32_16x16x32_bf16 v[60:63], v[124:127], a[12:15], v[60:63]
    buffer_load_dwordx4 v1, s[8:11], s25 offen offset:2048 sc1 lds
    v_mfma_f32_16x16x32_bf16 v[56:59], v[124:127], a[8:11], v[56:59]
    ds_read_b128 v[116:119], v6 offset:26624
    v_mfma_f32_16x16x32_bf16 v[56:59], v[120:123], a[0:3], v[56:59]
    s_waitcnt lgkmcnt(6)
    v_mfma_f32_16x16x32_bf16 v[64:67], v[128:131], a[0:3], v[64:67]
    ds_read_b128 v[120:123], v6 offset:19456
    v_mfma_f32_16x16x32_bf16 v[64:67], v[132:135], a[8:11], v[64:67]
    buffer_load_dwordx4 v1, s[8:11], s25 offen offset:3072 sc1 lds
    v_mfma_f32_16x16x32_bf16 v[68:71], v[132:135], a[12:15], v[68:71]
    ds_read_b128 v[124:127], v6 offset:27648
    v_mfma_f32_16x16x32_bf16 v[68:71], v[128:131], a[4:7], v[68:71]
    v_mfma_f32_16x16x32_bf16 v[76:79], v[136:139], a[4:7], v[76:79]
    ds_read_b128 v[128:131], v8 offset:16384
    v_mfma_f32_16x16x32_bf16 v[76:79], v[140:143], a[12:15], v[76:79]
    buffer_load_dwordx4 a[48:51], v1, s[4:7], s24 offen offset:0 sc1
    v_mfma_f32_16x16x32_bf16 v[72:75], v[140:143], a[8:11], v[72:75]
    ds_read_b128 v[132:135], v8 offset:24576
    v_mfma_f32_16x16x32_bf16 v[72:75], v[136:139], a[0:3], v[72:75]
    s_bitcmp1_b32 s18, s37
    s_cselect_b32 s78, 3, -1
    v_mfma_f32_16x16x32_bf16 v[80:83], v[144:147], a[0:3], v[80:83]
    ds_read_b128 v[136:139], v8 offset:17408
    v_mfma_f32_16x16x32_bf16 v[80:83], v[148:151], a[8:11], v[80:83]
    buffer_load_dwordx4 a[52:55], v1, s[4:7], s24 offen offset:1024 sc1
    v_mfma_f32_16x16x32_bf16 v[84:87], v[148:151], a[12:15], v[84:87]
    ds_read_b128 v[140:143], v8 offset:25600
    v_mfma_f32_16x16x32_bf16 v[84:87], v[144:147], a[4:7], v[84:87]
    s_bitcmp1_b32 s19, s37
    s_cselect_b32 s78, 0, s78
    v_mfma_f32_16x16x32_bf16 v[92:95], v[152:155], a[4:7], v[92:95]
    ds_read_b128 v[144:147], v8 offset:18432
    v_mfma_f32_16x16x32_bf16 v[92:95], v[156:159], a[12:15], v[92:95]
    buffer_load_dwordx4 a[56:59], v1, s[4:7], s24 offen offset:2048 sc1
    v_mfma_f32_16x16x32_bf16 v[88:91], v[156:159], a[8:11], v[88:91]
    ds_read_b128 v[148:151], v8 offset:26624
    v_mfma_f32_16x16x32_bf16 v[88:91], v[152:155], a[0:3], v[88:91]
    s_add_u32 s78, s78, s37
    s_add_u32 s37, s37, 1
    s_waitcnt vmcnt(15) lgkmcnt(6)
    v_mfma_f32_16x16x32_bf16 v[32:35], v[96:99], a[16:19], v[32:35]
    ds_read_b128 v[152:155], v8 offset:19456
    v_mfma_f32_16x16x32_bf16 v[32:35], v[100:103], a[24:27], v[32:35]
    buffer_load_dwordx4 a[60:63], v1, s[4:7], s24 offen offset:3072 sc1
    v_mfma_f32_16x16x32_bf16 v[36:39], v[100:103], a[28:31], v[36:39]
    ds_read_b128 v[156:159], v8 offset:27648
    v_mfma_f32_16x16x32_bf16 v[36:39], v[96:99], a[20:23], v[36:39]
    s_waitcnt vmcnt(12)
    s_barrier
    s_lshl_b32 s24, s78, 12
    s_lshl_b32 s25, s78, 14
    v_mfma_f32_16x16x32_bf16 v[44:47], v[104:107], a[20:23], v[44:47]
    ds_read_b128 v[96:99], v6 offset:32768
    s_add_u32 m0, s26, 0
    v_mfma_f32_16x16x32_bf16 v[44:47], v[108:111], a[28:31], v[44:47]
    buffer_load_dwordx4 v1, s[8:11], s25 offen offset:0 sc1 lds
    v_mfma_f32_16x16x32_bf16 v[40:43], v[108:111], a[24:27], v[40:43]
    ds_read_b128 v[100:103], v6 offset:40960
    v_mfma_f32_16x16x32_bf16 v[40:43], v[104:107], a[16:19], v[40:43]
    v_mfma_f32_16x16x32_bf16 v[48:51], v[112:115], a[16:19], v[48:51]
    ds_read_b128 v[104:107], v6 offset:33792
    v_mfma_f32_16x16x32_bf16 v[48:51], v[116:119], a[24:27], v[48:51]
    buffer_load_dwordx4 v1, s[8:11], s25 offen offset:1024 sc1 lds
    v_mfma_f32_16x16x32_bf16 v[52:55], v[116:119], a[28:31], v[52:55]
    ds_read_b128 v[108:111], v6 offset:41984
    v_mfma_f32_16x16x32_bf16 v[52:55], v[112:115], a[20:23], v[52:55]
    v_mfma_f32_16x16x32_bf16 v[60:63], v[120:123], a[20:23], v[60:63]
    ds_read_b128 v[112:115], v6 offset:34816
    v_mfma_f32_16x16x32_bf16 v[60:63], v[124:127], a[28:31], v[60:63]
    buffer_load_dwordx4 v1, s[8:11], s25 offen offset:2048 sc1 lds
    v_mfma_f32_16x16x32_bf16 v[56:59], v[124:127], a[24:27], v[56:59]
    ds_read_b128 v[116:119], v6 offset:43008
    v_mfma_f32_16x16x32_bf16 v[56:59], v[120:123], a[16:19], v[56:59]
    s_waitcnt lgkmcnt(6)
    v_mfma_f32_16x16x32_bf16 v[64:67], v[128:131], a[16:19], v[64:67]
    ds_read_b128 v[120:123], v6 offset:35840
    v_mfma_f32_16x16x32_bf16 v[64:67], v[132:135], a[24:27], v[64:67]
    buffer_load_dwordx4 v1, s[8:11], s25 offen offset:3072 sc1 lds
    v_mfma_f32_16x16x32_bf16 v[68:71], v[132:135], a[28:31], v[68:71]
    ds_read_b128 v[124:127], v6 offset:44032
    v_mfma_f32_16x16x32_bf16 v[68:71], v[128:131], a[20:23], v[68:71]
    v_mfma_f32_16x16x32_bf16 v[76:79], v[136:139], a[20:23], v[76:79]
    ds_read_b128 v[128:131], v8 offset:32768
    v_mfma_f32_16x16x32_bf16 v[76:79], v[140:143], a[28:31], v[76:79]
    buffer_load_dwordx4 a[0:3], v1, s[4:7], s24 offen offset:0 sc1
    v_mfma_f32_16x16x32_bf16 v[72:75], v[140:143], a[24:27], v[72:75]
    ds_read_b128 v[132:135], v8 offset:40960
    v_mfma_f32_16x16x32_bf16 v[72:75], v[136:139], a[16:19], v[72:75]
    s_bitcmp1_b32 s18, s37
    s_cselect_b32 s78, 3, -1
    v_mfma_f32_16x16x32_bf16 v[80:83], v[144:147], a[16:19], v[80:83]
    ds_read_b128 v[136:139], v8 offset:33792
    v_mfma_f32_16x16x32_bf16 v[80:83], v[148:151], a[24:27], v[80:83]
    buffer_load_dwordx4 a[4:7], v1, s[4:7], s24 offen offset:1024 sc1
    v_mfma_f32_16x16x32_bf16 v[84:87], v[148:151], a[28:31], v[84:87]
    ds_read_b128 v[140:143], v8 offset:41984
    v_mfma_f32_16x16x32_bf16 v[84:87], v[144:147], a[20:23], v[84:87]
    s_bitcmp1_b32 s19, s37
    s_cselect_b32 s78, 0, s78
    v_mfma_f32_16x16x32_bf16 v[92:95], v[152:155], a[20:23], v[92:95]
    ds_read_b128 v[144:147], v8 offset:34816
    v_mfma_f32_16x16x32_bf16 v[92:95], v[156:159], a[28:31], v[92:95]
    buffer_load_dwordx4 a[8:11], v1, s[4:7], s24 offen offset:2048 sc1
    v_mfma_f32_16x16x32_bf16 v[88:91], v[156:159], a[24:27], v[88:91]
    ds_read_b128 v[148:151], v8 offset:43008
    v_mfma_f32_16x16x32_bf16 v[88:91], v[152:155], a[16:19], v[88:91]
    s_add_u32 s78, s78, s37
    s_add_u32 s37, s37, 1
    s_sub_u32 s76, s76, 1
    s_cmp_lg_u32 s76, 0
    s_cbranch_scc1 Lg2m_loop
    s_waitcnt vmcnt(15) lgkmcnt(6)
    v_mfma_f32_16x16x32_bf16 v[32:35], v[96:99], a[32:35], v[32:35]
    ds_read_b128 v[152:155], v8 offset:35840
    v_mfma_f32_16x16x32_bf16 v[32:35], v[100:103], a[40:43], v[32:35]
    buffer_load_dwordx4 a[12:15], v1, s[4:7], s24 offen offset:3072 sc1
    v_mfma_f32_16x16x32_bf16 v[36:39], v[100:103], a[44:47], v[36:39]
    ds_read_b128 v[156:159], v8 offset:44032
    v_mfma_f32_16x16x32_bf16 v[36:39], v[96:99], a[36:39], v[36:39]
    s_waitcnt vmcnt(12)
    s_barrier
    s_lshl_b32 s24, s78, 12
    s_lshl_b32 s25, s78, 14
    v_mfma_f32_16x16x32_bf16 v[44:47], v[104:107], a[36:39], v[44:47]
    ds_read_b128 v[96:99], v7 offset:0
    s_add_u32 m0, s26, 16384
    v_mfma_f32_16x16x32_bf16 v[44:47], v[108:111], a[44:47], v[44:47]
    buffer_load_dwordx4 v1, s[8:11], s25 offen offset:0 sc1 lds
    v_mfma_f32_16x16x32_bf16 v[40:43], v[108:111], a[40:43], v[40:43]
    ds_read_b128 v[100:103], v7 offset:8192
    v_mfma_f32_16x16x32_bf16 v[40:43], v[104:107], a[32:35], v[40:43]
    v_mfma_f32_16x16x32_bf16 v[48:51], v[112:115], a[32:35], v[48:51]
    ds_read_b128 v[104:107], v7 offset:1024
    v_mfma_f32_16x16x32_bf16 v[48:51], v[116:119], a[40:43], v[48:51]
    buffer_load_dwordx4 v1, s[8:11], s25 offen offset:1024 sc1 lds
    v_mfma_f32_16x16x32_bf16 v[52:55], v[116:119], a[44:47], v[52:55]
    ds_read_b128 v[108:111], v7 offset:9216
    v_mfma_f32_16x16x32_bf16 v[52:55], v[112:115], a[36:39], v[52:55]
    v_mfma_f32_16x16x32_bf16 v[60:63], v[120:123], a[36:39], v[60:63]
    ds_read_b128 v[112:115], v7 offset:2048
    v_mfma_f32_16x16x32_bf16 v[60:63], v[124:127], a[44:47], v[60:63]
    buffer_load_dwordx4 v1, s[8:11], s25 offen offset:2048 sc1 lds
    v_mfma_f32_16x16x32_bf16 v[56:59], v[124:127], a[40:43], v[56:59]
    ds_read_b128 v[116:119], v7 offset:10240
    v_mfma_f32_16x16x32_bf16 v[56:59], v[120:123], a[32:35], v[56:59]
    s_waitcnt lgkmcnt(6)
    v_mfma_f32_16x16x32_bf16 v[64:67], v[128:131], a[32:35], v[64:67]
    ds_read_b128 v[120:123], v7 offset:3072
    v_mfma_f32_16x16x32_bf16 v[64:67], v[132:135], a[40:43], v[64:67]
    buffer_load_dwordx4 v1, s[8:11], s25 offen offset:3072 sc1 lds
    v_mfma_f32_16x16x32_bf16 v[68:71], v[132:135], a[44:47], v[68:71]
    ds_read_b128 v[124:127], v7 offset:11264
    v_mfma_f32_16x16x32_bf16 v[68:71], v[128:131], a[36:39], v[68:71]
    v_mfma_f32_16x16x32_bf16 v[76:79], v[136:139], a[36:39], v[76:79]
    ds_read_b128 v[128:131], v9 offset:0
    v_mfma_f32_16x16x32_bf16 v[76:79], v[140:143], a[44:47], v[76:79]
    buffer_load_dwordx4 a[16:19], v1, s[4:7], s24 offen offset:0 sc1
    v_mfma_f32_16x16x32_bf16 v[72:75], v[140:143], a[40:43], v[72:75]
    ds_read_b128 v[132:135], v9 offset:8192
    v_mfma_f32_16x16x32_bf16 v[72:75], v[136:139], a[32:35], v[72:75]
    s_bitcmp1_b32 s18, s37
    s_cselect_b32 s78, 3, -1
    v_mfma_f32_16x16x32_bf16 v[80:83], v[144:147], a[32:35], v[80:83]
    ds_read_b128 v[136:139], v9 offset:1024
    v_mfma_f32_16x16x32_bf16 v[80:83], v[148:151], a[40:43], v[80:83]
    buffer_load_dwordx4 a[20:23], v1, s[4:7], s24 offen offset:1024 sc1
    v_mfma_f32_16x16x32_bf16 v[84:87], v[148:151], a[44:47], v[84:87]
    ds_read_b128 v[140:143], v9 offset:9216
    v_mfma_f32_16x16x32_bf16 v[84:87], v[144:147], a[36:39], v[84:87]
    s_bitcmp1_b32 s19, s37
    s_cselect_b32 s78, 0, s78
    v_mfma_f32_16x16x32_bf16 v[92:95], v[152:155], a[36:39], v[92:95]
    ds_read_b128 v[144:147], v9 offset:2048
    v_mfma_f32_16x16x32_bf16 v[92:95], v[156:159], a[44:47], v[92:95]
    buffer_load_dwordx4 a[24:27], v1, s[4:7], s24 offen offset:2048 sc1
    v_mfma_f32_16x16x32_bf16 v[88:91], v[156:159], a[40:43], v[88:91]
    ds_read_b128 v[148:151], v9 offset:10240
    v_mfma_f32_16x16x32_bf16 v[88:91], v[152:155], a[32:35], v[88:91]
    s_add_u32 s78, s78, s37
    s_add_u32 s37, s37, 1
    s_waitcnt vmcnt(15) lgkmcnt(6)
    v_mfma_f32_16x16x32_bf16 v[32:35], v[96:99], a[48:51], v[32:35]
    ds_read_b128 v[152:155], v9 offset:3072
    v_mfma_f32_16x16x32_bf16 v[32:35], v[100:103], a[56:59], v[32:35]
    buffer_load_dwordx4 a[28:31], v1, s[4:7], s24 offen offset:3072 sc1
    v_mfma_f32_16x16x32_bf16 v[36:39], v[100:103], a[60:63], v[36:39]
    ds_read_b128 v[156:159], v9 offset:11264
    v_mfma_f32_16x16x32_bf16 v[36:39], v[96:99], a[52:55], v[36:39]
    s_waitcnt vmcnt(12)
    s_barrier
    s_lshl_b32 s24, s78, 12
    s_lshl_b32 s25, s78, 14
    v_mfma_f32_16x16x32_bf16 v[44:47], v[104:107], a[52:55], v[44:47]
    ds_read_b128 v[96:99], v6 offset:0
    s_add_u32 m0, s26, 32768
    v_mfma_f32_16x16x32_bf16 v[44:47], v[108:111], a[60:63], v[44:47]
    buffer_load_dwordx4 v1, s[8:11], s25 offen offset:0 sc1 lds
    v_mfma_f32_16x16x32_bf16 v[40:43], v[108:111], a[56:59], v[40:43]
    ds_read_b128 v[100:103], v6 offset:8192
    v_mfma_f32_16x16x32_bf16 v[40:43], v[104:107], a[48:51], v[40:43]
    v_mfma_f32_16x16x32_bf16 v[48:51], v[112:115], a[48:51], v[48:51]
    ds_read_b128 v[104:107], v6 offset:1024
    v_mfma_f32_16x16x32_bf16 v[48:51], v[116:119], a[56:59], v[48:51]
    buffer_load_dwordx4 v1, s[8:11], s25 offen offset:1024 sc1 lds
    v_mfma_f32_16x16x32_bf16 v[52:55], v[116:119], a[60:63], v[52:55]
    ds_read_b128 v[108:111], v6 offset:9216
    v_mfma_f32_16x16x32_bf16 v[52:55], v[112:115], a[52:55], v[52:55]
    v_mfma_f32_16x16x32_bf16 v[60:63], v[120:123], a[52:55], v[60:63]
    ds_read_b128 v[112:115], v6 offset:2048
    v_mfma_f32_16x16x32_bf16 v[60:63], v[124:127], a[60:63], v[60:63]
    buffer_load_dwordx4 v1, s[8:11], s25 offen offset:2048 sc1 lds
    v_mfma_f32_16x16x32_bf16 v[56:59], v[124:127], a[56:59], v[56:59]
    ds_read_b128 v[116:119], v6 offset:10240
    v_mfma_f32_16x16x32_bf16 v[56:59], v[120:123], a[48:51], v[56:59]
    s_waitcnt lgkmcnt(6)
    v_mfma_f32_16x16x32_bf16 v[64:67], v[128:131], a[48:51], v[64:67]
    ds_read_b128 v[120:123], v6 offset:3072
    v_mfma_f32_16x16x32_bf16 v[64:67], v[132:135], a[56:59], v[64:67]
    buffer_load_dwordx4 v1, s[8:11], s25 offen offset:3072 sc1 lds
    v_mfma_f32_16x16x32_bf16 v[68:71], v[132:135], a[60:63], v[68:71]
    ds_read_b128 v[124:127], v6 offset:11264
    v_mfma_f32_16x16x32_bf16 v[68:71], v[128:131], a[52:55], v[68:71]
    v_mfma_f32_16x16x32_bf16 v[76:79], v[136:139], a[52:55], v[76:79]
    ds_read_b128 v[128:131], v8 offset:0
    v_mfma_f32_16x16x32_bf16 v[76:79], v[140:143], a[60:63], v[76:79]
    buffer_load_dwordx4 a[32:35], v1, s[4:7], s24 offen offset:0 sc1
    v_mfma_f32_16x16x32_bf16 v[72:75], v[140:143], a[56:59], v[72:75]
    ds_read_b128 v[132:135], v8 offset:8192
    v_mfma_f32_16x16x32_bf16 v[72:75], v[136:139], a[48:51], v[72:75]
    s_bitcmp1_b32 s18, s37
    s_cselect_b32 s78, 3, -1
    v_mfma_f32_16x16x32_bf16 v[80:83], v[144:147], a[48:51], v[80:83]
    ds_read_b128 v[136:139], v8 offset:1024
    v_mfma_f32_16x16x32_bf16 v[80:83], v[148:151], a[56:59], v[80:83]
    buffer_load_dwordx4 a[36:39], v1, s[4:7], s24 offen offset:1024 sc1
    v_mfma_f32_16x16x32_bf16 v[84:87], v[148:151], a[60:63], v[84:87]
    ds_read_b128 v[140:143], v8 offset:9216
    v_mfma_f32_16x16x32_bf16 v[84:87], v[144:147], a[52:55], v[84:87]
    s_bitcmp1_b32 s19, s37
    s_cselect_b32 s78, 0, s78
    v_mfma_f32_16x16x32_bf16 v[92:95], v[152:155], a[52:55], v[92:95]
    ds_read_b128 v[144:147], v8 offset:2048
    v_mfma_f32_16x16x32_bf16 v[92:95], v[156:159], a[60:63], v[92:95]
    buffer_load_dwordx4 a[40:43], v1, s[4:7], s24 offen offset:2048 sc1
    v_mfma_f32_16x16x32_bf16 v[88:91], v[156:159], a[56:59], v[88:91]
    ds_read_b128 v[148:151], v8 offset:10240
    v_mfma_f32_16x16x32_bf16 v[88:91], v[152:155], a[48:51], v[88:91]
    s_add_u32 s78, s78, s37
    s_add_u32 s37, s37, 1
    s_waitcnt vmcnt(15) lgkmcnt(6)
    v_mfma_f32_16x16x32_bf16 v[32:35], v[96:99], a[0:3], v[32:35]
    ds_read_b128 v[152:155], v8 offset:3072
    v_mfma_f32_16x16x32_bf16 v[32:35], v[100:103], a[8:11], v[32:35]
    buffer_load_dwordx4 a[44:47], v1, s[4:7], s24 offen offset:3072 sc1
    v_mfma_f32_16x16x32_bf16 v[36:39], v[100:103], a[12:15], v[36:39]
    ds_read_b128 v[156:159], v8 offset:11264
    v_mfma_f32_16x16x32_bf16 v[36:39], v[96:99], a[4:7], v[36:39]
    s_waitcnt vmcnt(12)
    s_barrier
    s_lshl_b32 s24, s78, 12
    s_lshl_b32 s25, s78, 14
    v_mfma_f32_16x16x32_bf16 v[44:47], v[104:107], a[4:7], v[44:47]
    ds_read_b128 v[96:99], v6 offset:16384
    s_add_u32 m0, s26, 114688
    v_mfma_f32_16x16x32_bf16 v[44:47], v[108:111], a[12:15], v[44:47]
    buffer_load_dwordx4 v1, s[8:11], s25 offen offset:0 sc1 lds
    v_mfma_f32_16x16x32_bf16 v[40:43], v[108:111], a[8:11], v[40:43]
    ds_read_b128 v[100:103], v6 offset:24576
    v_mfma_f32_16x16x32_bf16 v[40:43], v[104:107], a[0:3], v[40:43]
    v_mfma_f32_16x16x32_bf16 v[48:51], v[112:115], a[0:3], v[48:51]
    ds_read_b128 v[104:107], v6 offset:17408
    v_mfma_f32_16x16x32_bf16 v[48:51], v[116:119], a[8:11], v[48:51]
    buffer_load_dwordx4 v1, s[8:11], s25 offen offset:1024 sc1 lds
    v_mfma_f32_16x16x32_bf16 v[52:55], v[116:119], a[12:15], v[52:55]
    ds_read_b128 v[108:111], v6 offset:25600
    v_mfma_f32_16x16x32_bf16 v[52:55], v[112:115], a[4:7], v[52:55]
    v_mfma_f32_16x16x32_bf16 v[60:63], v[120:123], a[4:7], v[60:63]
    ds_read_b128 v[112:115], v6 offset:18432
    v_mfma_f32_16x16x32_bf16 v[60:63], v[124:127], a[12:15], v[60:63]
    buffer_load_dwordx4 v1, s[8:11], s25 offen offset:2048 sc1 lds
    v_mfma_f32_16x16x32_bf16 v[56:59], v[124:127], a[8:11], v[56:59]
    ds_read_b128 v[116:119], v6 offset:26624
    v_mfma_f32_16x16x32_bf16 v[56:59], v[120:123], a[0:3], v[56:59]
    s_waitcnt lgkmcnt(6)
    v_mfma_f32_16x16x32_bf16 v[64:67], v[128:131], a[0:3], v[64:67]
    ds_read_b128 v[120:123], v6 offset:19456
    v_mfma_f32_16x16x32_bf16 v[64:67], v[132:135], a[8:11], v[64:67]
    buffer_load_dwordx4 v1, s[8:11], s25 offen offset:3072 sc1 lds
    v_mfma_f32_16x16x32_bf16 v[68:71], v[132:135], a[12:15], v[68:71]
    ds_read_b128 v[124:127], v6 offset:27648
    v_mfma_f32_16x16x32_bf16 v[68:71], v[128:131], a[4:7], v[68:71]
    v_mfma_f32_16x16x32_bf16 v[76:79], v[136:139], a[4:7], v[76:79]
    ds_read_b128 v[128:131], v8 offset:16384
    v_mfma_f32_16x16x32_bf16 v[76:79], v[140:143], a[12:15], v[76:79]
    buffer_load_dwordx4 a[48:51], v1, s[4:7], s24 offen offset:0 sc1
    v_mfma_f32_16x16x32_bf16 v[72:75], v[140:143], a[8:11], v[72:75]
    ds_read_b128 v[132:135], v8 offset:24576
    v_mfma_f32_16x16x32_bf16 v[72:75], v[136:139], a[0:3], v[72:75]
    s_bitcmp1_b32 s18, s37
    s_cselect_b32 s78, 3, -1
    v_mfma_f32_16x16x32_bf16 v[80:83], v[144:147], a[0:3], v[80:83]
    ds_read_b128 v[136:139], v8 offset:17408
    v_mfma_f32_16x16x32_bf16 v[80:83], v[148:151], a[8:11], v[80:83]
    buffer_load_dwordx4 a[52:55], v1, s[4:7], s24 offen offset:1024 sc1
    v_mfma_f32_16x16x32_bf16 v[84:87], v[148:151], a[12:15], v[84:87]
    ds_read_b128 v[140:143], v8 offset:25600
    v_mfma_f32_16x16x32_bf16 v[84:87], v[144:147], a[4:7], v[84:87]
    s_bitcmp1_b32 s19, s37
    s_cselect_b32 s78, 0, s78
    v_mfma_f32_16x16x32_bf16 v[92:95], v[152:155], a[4:7], v[92:95]
    ds_read_b128 v[144:147], v8 offset:18432
    v_mfma_f32_16x16x32_bf16 v[92:95], v[156:159], a[12:15], v[92:95]
    buffer_load_dwordx4 a[56:59], v1, s[4:7], s24 offen offset:2048 sc1
    v_mfma_f32_16x16x32_bf16 v[88:91], v[156:159], a[8:11], v[88:91]
    ds_read_b128 v[148:151], v8 offset:26624
    v_mfma_f32_16x16x32_bf16 v[88:91], v[152:155], a[0:3], v[88:91]
    s_add_u32 s78, s78, s37
    s_add_u32 s37, s37, 1
    s_waitcnt vmcnt(15) lgkmcnt(6)
    v_mfma_f32_16x16x32_bf16 v[32:35], v[96:99], a[16:19], v[32:35]
    ds_read_b128 v[152:155], v8 offset:19456
    v_mfma_f32_16x16x32_bf16 v[32:35], v[100:103], a[24:27], v[32:35]
    buffer_load_dwordx4 a[60:63], v1, s[4:7], s24 offen offset:3072 sc1
    v_mfma_f32_16x16x32_bf16 v[36:39], v[100:103], a[28:31], v[36:39]
    ds_read_b128 v[156:159], v8 offset:27648
    v_mfma_f32_16x16x32_bf16 v[36:39], v[96:99], a[20:23], v[36:39]
    s_waitcnt vmcnt(12)
    s_barrier
    s_lshl_b32 s24, s78, 12
    s_lshl_b32 s25, s78, 14
    v_mfma_f32_16x16x32_bf16 v[44:47], v[104:107], a[20:23], v[44:47]
    ds_read_b128 v[96:99], v6 offset:32768
    v_mfma_f32_16x16x32_bf16 v[44:47], v[108:111], a[28:31], v[44:47]
    global_load_dword v23, v[22:23], off
    v_mfma_f32_16x16x32_bf16 v[40:43], v[108:111], a[24:27], v[40:43]
    ds_read_b128 v[100:103], v6 offset:40960
    v_mfma_f32_16x16x32_bf16 v[40:43], v[104:107], a[16:19], v[40:43]
    v_mfma_f32_16x16x32_bf16 v[48:51], v[112:115], a[16:19], v[48:51]
    ds_read_b128 v[104:107], v6 offset:33792
    v_mfma_f32_16x16x32_bf16 v[48:51], v[116:119], a[24:27], v[48:51]
    v_mfma_f32_16x16x32_bf16 v[52:55], v[116:119], a[28:31], v[52:55]
    ds_read_b128 v[108:111], v6 offset:41984
    v_mfma_f32_16x16x32_bf16 v[52:55], v[112:115], a[20:23], v[52:55]
    s_waitcnt vmcnt(5)
    s_barrier
    v_mfma_f32_16x16x32_bf16 v[60:63], v[120:123], a[20:23], v[60:63]
    ds_read_b128 v[112:115], v7 offset:0
    v_mfma_f32_16x16x32_bf16 v[60:63], v[124:127], a[28:31], v[60:63]
    v_mfma_f32_16x16x32_bf16 v[56:59], v[124:127], a[24:27], v[56:59]
    ds_read_b128 v[116:119], v7 offset:8192
    v_mfma_f32_16x16x32_bf16 v[56:59], v[120:123], a[16:19], v[56:59]
    s_waitcnt lgkmcnt(6)
    v_mfma_f32_16x16x32_bf16 v[64:67], v[128:131], a[16:19], v[64:67]
    ds_read_b128 v[120:123], v7 offset:1024
    v_mfma_f32_16x16x32_bf16 v[64:67], v[132:135], a[24:27], v[64:67]
    v_mfma_f32_16x16x32_bf16 v[68:71], v[132:135], a[28:31], v[68:71]
    ds_read_b128 v[124:127], v7 offset:9216
    v_mfma_f32_16x16x32_bf16 v[68:71], v[128:131], a[20:23], v[68:71]
    v_mfma_f32_16x16x32_bf16 v[76:79], v[136:139], a[20:23], v[76:79]
    ds_read_b128 v[128:131], v6 offset:34816
    v_mfma_f32_16x16x32_bf16 v[76:79], v[140:143], a[28:31], v[76:79]
    v_mfma_f32_16x16x32_bf16 v[72:75], v[140:143], a[24:27], v[72:75]
    ds_read_b128 v[132:135], v6 offset:43008
    v_mfma_f32_16x16x32_bf16 v[72:75], v[136:139], a[16:19], v[72:75]
    v_mfma_f32_16x16x32_bf16 v[80:83], v[144:147], a[16:19], v[80:83]
    ds_read_b128 v[136:139], v6 offset:35840
    v_mfma_f32_16x16x32_bf16 v[80:83], v[148:151], a[24:27], v[80:83]
    v_mfma_f32_16x16x32_bf16 v[84:87], v[148:151], a[28:31], v[84:87]
    ds_read_b128 v[140:143], v6 offset:44032
    v_mfma_f32_16x16x32_bf16 v[84:87], v[144:147], a[20:23], v[84:87]
    v_mfma_f32_16x16x32_bf16 v[92:95], v[152:155], a[20:23], v[92:95]
    ds_read_b128 v[144:147], v7 offset:2048
    v_mfma_f32_16x16x32_bf16 v[92:95], v[156:159], a[28:31], v[92:95]
    v_mfma_f32_16x16x32_bf16 v[88:91], v[156:159], a[24:27], v[88:91]
    ds_read_b128 v[148:151], v7 offset:10240
    v_mfma_f32_16x16x32_bf16 v[88:91], v[152:155], a[16:19], v[88:91]
    s_waitcnt lgkmcnt(6)
    v_mfma_f32_16x16x32_bf16 v[32:35], v[96:99], a[32:35], v[32:35]
    ds_read_b128 v[152:155], v7 offset:3072
    v_mfma_f32_16x16x32_bf16 v[32:35], v[100:103], a[40:43], v[32:35]
    v_mfma_f32_16x16x32_bf16 v[36:39], v[100:103], a[44:47], v[36:39]
    ds_read_b128 v[156:159], v7 offset:11264
    v_mfma_f32_16x16x32_bf16 v[36:39], v[96:99], a[36:39], v[36:39]
    v_mfma_f32_16x16x32_bf16 v[44:47], v[104:107], a[36:39], v[44:47]
    ds_read_b128 v[96:99], v8 offset:32768
    v_mfma_f32_16x16x32_bf16 v[44:47], v[108:111], a[44:47], v[44:47]
    v_mfma_f32_16x16x32_bf16 v[40:43], v[108:111], a[40:43], v[40:43]
    ds_read_b128 v[100:103], v8 offset:40960
    v_mfma_f32_16x16x32_bf16 v[40:43], v[104:107], a[32:35], v[40:43]
    s_waitcnt vmcnt(1)
    v_mfma_f32_16x16x32_bf16 v[32:35], v[112:115], a[48:51], v[32:35]
    ds_read_b128 v[104:107], v8 offset:33792
    v_mfma_f32_16x16x32_bf16 v[32:35], v[116:119], a[56:59], v[32:35]
    v_mfma_f32_16x16x32_bf16 v[36:39], v[116:119], a[60:63], v[36:39]
    ds_read_b128 v[108:111], v8 offset:41984
    v_mfma_f32_16x16x32_bf16 v[36:39], v[112:115], a[52:55], v[36:39]
    v_mfma_f32_16x16x32_bf16 v[44:47], v[120:123], a[52:55], v[44:47]
    ds_read_b128 v[112:115], v9 offset:0
    v_mfma_f32_16x16x32_bf16 v[44:47], v[124:127], a[60:63], v[44:47]
    v_mfma_f32_16x16x32_bf16 v[40:43], v[124:127], a[56:59], v[40:43]
    ds_read_b128 v[116:119], v9 offset:8192
    v_mfma_f32_16x16x32_bf16 v[40:43], v[120:123], a[48:51], v[40:43]
    s_waitcnt lgkmcnt(6)
    v_mfma_f32_16x16x32_bf16 v[48:51], v[128:131], a[32:35], v[48:51]
    ds_read_b128 v[120:123], v9 offset:1024
    v_mfma_f32_16x16x32_bf16 v[48:51], v[132:135], a[40:43], v[48:51]
    v_mfma_f32_16x16x32_bf16 v[52:55], v[132:135], a[44:47], v[52:55]
    ds_read_b128 v[124:127], v9 offset:9216
    v_mfma_f32_16x16x32_bf16 v[52:55], v[128:131], a[36:39], v[52:55]
    v_mfma_f32_16x16x32_bf16 v[60:63], v[136:139], a[36:39], v[60:63]
    ds_read_b128 v[128:131], v8 offset:34816
    v_mfma_f32_16x16x32_bf16 v[60:63], v[140:143], a[44:47], v[60:63]
    v_mfma_f32_16x16x32_bf16 v[56:59], v[140:143], a[40:43], v[56:59]
    ds_read_b128 v[132:135], v8 offset:43008
    v_mfma_f32_16x16x32_bf16 v[56:59], v[136:139], a[32:35], v[56:59]
    v_cvt_pk_bf16_f32 v192, v32, v33
    v_cvt_pk_bf16_f32 v193, v34, v35
    v_mfma_f32_16x16x32_bf16 v[48:51], v[144:147], a[48:51], v[48:51]
    ds_read_b128 v[136:139], v8 offset:35840
    v_cvt_pk_bf16_f32 v194, v40, v41
    v_cvt_pk_bf16_f32 v195, v42, v43
    v_mfma_f32_16x16x32_bf16 v[48:51], v[148:151], a[56:59], v[48:51]
    buffer_store_dwordx4 v[192:195], v1, s[32:35], s74 offen offset:0 sc1
    v_cvt_pk_bf16_f32 v196, v36, v37
    v_mfma_f32_16x16x32_bf16 v[52:55], v[148:151], a[60:63], v[52:55]
    ds_read_b128 v[140:143], v8 offset:44032
    v_cvt_pk_bf16_f32 v197, v38, v39
    v_cvt_pk_bf16_f32 v198, v44, v45
    v_mfma_f32_16x16x32_bf16 v[52:55], v[144:147], a[52:55], v[52:55]
    v_cvt_pk_bf16_f32 v199, v46, v47
    buffer_store_dwordx4 v[196:199], v1, s[32:35], s74 offen offset:1024 sc1
    v_mfma_f32_16x16x32_bf16 v[60:63], v[152:155], a[52:55], v[60:63]
    ds_read_b128 v[144:147], v9 offset:2048
    v_mfma_f32_16x16x32_bf16 v[60:63], v[156:159], a[60:63], v[60:63]
    v_mfma_f32_16x16x32_bf16 v[56:59], v[156:159], a[56:59], v[56:59]
    ds_read_b128 v[148:151], v9 offset:10240
    v_mfma_f32_16x16x32_bf16 v[56:59], v[152:155], a[48:51], v[56:59]
    s_waitcnt lgkmcnt(6)
    v_mfma_f32_16x16x32_bf16 v[64:67], v[96:99], a[32:35], v[64:67]
    ds_read_b128 v[152:155], v9 offset:3072
    v_mfma_f32_16x16x32_bf16 v[64:67], v[100:103], a[40:43], v[64:67]
    v_mfma_f32_16x16x32_bf16 v[68:71], v[100:103], a[44:47], v[68:71]
    ds_read_b128 v[156:159], v9 offset:11264
    v_mfma_f32_16x16x32_bf16 v[68:71], v[96:99], a[36:39], v[68:71]
    v_mfma_f32_16x16x32_bf16 v[76:79], v[104:107], a[36:39], v[76:79]
    v_mfma_f32_16x16x32_bf16 v[76:79], v[108:111], a[44:47], v[76:79]
    v_mfma_f32_16x16x32_bf16 v[72:75], v[108:111], a[40:43], v[72:75]
    v_mfma_f32_16x16x32_bf16 v[72:75], v[104:107], a[32:35], v[72:75]
    v_cvt_pk_bf16_f32 v200, v48, v49
    v_cvt_pk_bf16_f32 v201, v50, v51
    v_mfma_f32_16x16x32_bf16 v[64:67], v[112:115], a[48:51], v[64:67]
    v_cvt_pk_bf16_f32 v202, v56, v57
    v_cvt_pk_bf16_f32 v203, v58, v59
    v_mfma_f32_16x16x32_bf16 v[64:67], v[116:119], a[56:59], v[64:67]
    buffer_store_dwordx4 v[200:203], v1, s[32:35], s75 offen offset:0 sc1
    v_cvt_pk_bf16_f32 v204, v52, v53
    v_mfma_f32_16x16x32_bf16 v[68:71], v[116:119], a[60:63], v[68:71]
    v_cvt_pk_bf16_f32 v205, v54, v55
    v_cvt_pk_bf16_f32 v206, v60, v61
    v_mfma_f32_16x16x32_bf16 v[68:71], v[112:115], a[52:55], v[68:71]
    v_cvt_pk_bf16_f32 v207, v62, v63
    buffer_store_dwordx4 v[204:207], v1, s[32:35], s75 offen offset:1024 sc1
    v_mfma_f32_16x16x32_bf16 v[76:79], v[120:123], a[52:55], v[76:79]
    v_mfma_f32_16x16x32_bf16 v[76:79], v[124:127], a[60:63], v[76:79]
    v_mfma_f32_16x16x32_bf16 v[72:75], v[124:127], a[56:59], v[72:75]
    v_mfma_f32_16x16x32_bf16 v[72:75], v[120:123], a[48:51], v[72:75]
    s_waitcnt lgkmcnt(0)
    v_mfma_f32_16x16x32_bf16 v[80:83], v[128:131], a[32:35], v[80:83]
    v_mfma_f32_16x16x32_bf16 v[80:83], v[132:135], a[40:43], v[80:83]
    v_mfma_f32_16x16x32_bf16 v[84:87], v[132:135], a[44:47], v[84:87]
    v_mfma_f32_16x16x32_bf16 v[84:87], v[128:131], a[36:39], v[84:87]
    v_mfma_f32_16x16x32_bf16 v[92:95], v[136:139], a[36:39], v[92:95]
    v_mfma_f32_16x16x32_bf16 v[92:95], v[140:143], a[44:47], v[92:95]
    v_mfma_f32_16x16x32_bf16 v[88:91], v[140:143], a[40:43], v[88:91]
    v_mfma_f32_16x16x32_bf16 v[88:91], v[136:139], a[32:35], v[88:91]
    v_cvt_pk_bf16_f32 v208, v64, v65
    v_cvt_pk_bf16_f32 v209, v66, v67
    v_mfma_f32_16x16x32_bf16 v[80:83], v[144:147], a[48:51], v[80:83]
    v_cvt_pk_bf16_f32 v210, v72, v73
    v_cvt_pk_bf16_f32 v211, v74, v75
    v_mfma_f32_16x16x32_bf16 v[80:83], v[148:151], a[56:59], v[80:83]
    buffer_store_dwordx4 v[208:211], v1, s[32:35], s72 offen offset:0 sc1
    v_cvt_pk_bf16_f32 v212, v68, v69
    v_mfma_f32_16x16x32_bf16 v[84:87], v[148:151], a[60:63], v[84:87]
    v_cvt_pk_bf16_f32 v213, v70, v71
    v_cvt_pk_bf16_f32 v214, v76, v77
    v_mfma_f32_16x16x32_bf16 v[84:87], v[144:147], a[52:55], v[84:87]
    v_cvt_pk_bf16_f32 v215, v78, v79
    buffer_store_dwordx4 v[212:215], v1, s[32:35], s72 offen offset:1024 sc1
    v_mfma_f32_16x16x32_bf16 v[92:95], v[152:155], a[52:55], v[92:95]
    v_mfma_f32_16x16x32_bf16 v[92:95], v[156:159], a[60:63], v[92:95]
    v_mfma_f32_16x16x32_bf16 v[88:91], v[156:159], a[56:59], v[88:91]
    v_mfma_f32_16x16x32_bf16 v[88:91], v[152:155], a[48:51], v[88:91]
    s_nop 7
    v_cvt_pk_bf16_f32 v216, v80, v81
    v_cvt_pk_bf16_f32 v217, v82, v83
    v_cvt_pk_bf16_f32 v218, v88, v89
    v_cvt_pk_bf16_f32 v219, v90, v91
    buffer_store_dwordx4 v[216:219], v1, s[32:35], s73 offen offset:0 sc1
    v_cvt_pk_bf16_f32 v220, v84, v85
    v_cvt_pk_bf16_f32 v221, v86, v87
    v_cvt_pk_bf16_f32 v222, v92, v93
    v_cvt_pk_bf16_f32 v223, v94, v95
    buffer_store_dwordx4 v[220:223], v1, s[32:35], s73 offen offset:1024 sc1
Lg2m_fin:
    s_lshl_b32 s23, s20, 4
    s_lshl_b32 s30, s21, 1
    s_add_u32 s23, s23, s30
    s_add_u32 s23, s23, s27
    s_add_u32 s97, s23, 512
Lln2:
    s_and_b32 s32, s2, 7
    s_lshl_b32 s32, s32, 5
    s_lshr_b32 s33, s2, 3
    s_add_u32 s32, s32, s33
    v_and_b32 v1, 7, v0
    v_bfe_u32 v2, v0, 3, 1
    v_lshrrev_b32 v3, 4, v0
    v_lshlrev_b32 v4, 12, v2
    v_lshl_add_u32 v4, v3, 8, v4
    v_lshl_add_u32 v4, v1, 4, v4
    s_lshr_b32 s60, s32, 3
    s_lshl_b32 s60, s60, 17
    s_bfe_u32 s26, s32, 0x20001
    s_lshl_b32 s26, s26, 10
    s_add_u32 s60, s60, s26
    s_and_b32 s26, s32, 1
    s_lshl_b32 s26, s26, 7
    s_add_u32 s60, s60, s26
    s_lshl_b32 s26, s3, 15
    s_add_u32 s60, s60, s26
    s_add_u32 s61, s60, 8192
    s_add_u32 s62, s60, 16384
    s_add_u32 s63, s60, 24576
    s_add_u32 s4, s16, 83886080
    s_addc_u32 s5, s17, 0
    s_mov_b32 s6, 4194304
    s_mov_b32 s7, 0x20000
    s_add_u32 s28, s16, 88080384
    s_addc_u32 s29, s17, 0
    s_mov_b32 s30, 4194304
    s_mov_b32 s31, 0x20000
    s_add_u32 s20, s16, 62914560
    s_addc_u32 s21, s17, 0
    s_mov_b32 s22, 4194304
    s_mov_b32 s23, 0x20000
    v_lshrrev_b32 v7, 4, v0
    v_bfe_u32 v8, v0, 2, 2
    v_cmp_eq_u32 vcc, v7, v8
    v_and_b32 v7, 1, v0
    v_lshlrev_b32 v7, 4, v7
    v_mov_b32 v9, 0x3f80
    v_lshlrev_b32 v7, v7, v9
    v_cndmask_b32 v7, 0, v7, vcc
    v_and_b32 v8, 2, v0
    v_cmp_eq_u32 vcc, 0, v8
    v_mov_b32 v12, 0
    v_mov_b32 v13, 0
    v_cndmask_b32 v10, 0, v7, vcc
    v_cndmask_b32 v11, v7, v12, vcc
    v_mov_b32 v14, v10
    v_mov_b32 v15, v11
    v_lshlrev_b32 v6, 5, v1
    v_add_u32 v6, 154112, v6
    s_lshl_b32 s26, s3, 3
    v_add_u32 v5, s26, v6
    s_mov_b32 s27, 0xffff0000
    v_mfma_f32_16x16x32_bf16 v[112:115], v[10:13], a[208:211], 0
    v_mfma_f32_16x16x32_bf16 v[116:119], v[12:15], a[208:211], 0
    v_mfma_f32_16x16x32_bf16 v[120:123], v[10:13], a[212:215], 0
    v_mfma_f32_16x16x32_bf16 v[124:127], v[12:15], a[212:215], 0
    v_mfma_f32_16x16x32_bf16 v[128:131], v[10:13], a[216:219], 0
    v_mfma_f32_16x16x32_bf16 v[132:135], v[12:15], a[216:219], 0
    v_mfma_f32_16x16x32_bf16 v[136:139], v[10:13], a[220:223], 0
    v_mfma_f32_16x16x32_bf16 v[140:143], v[12:15], a[220:223], 0
    s_and_b32 s26, s32, 0xf0
    s_add_u32 s26, s26, 512
    v_mfma_f32_16x16x32_bf16 v[80:83], v[10:13], a[192:195], 0
    v_mfma_f32_16x16x32_bf16 v[84:87], v[12:15], a[192:195], 0
    v_mfma_f32_16x16x32_bf16 v[88:91], v[10:13], a[196:199], 0
    v_mfma_f32_16x16x32_bf16 v[92:95], v[12:15], a[196:199], 0
    v_mfma_f32_16x16x32_bf16 v[96:99], v[10:13], a[200:203], 0
    v_mfma_f32_16x16x32_bf16 v[100:103], v[12:15], a[200:203], 0
    v_mfma_f32_16x16x32_bf16 v[104:107], v[10:13], a[204:207], 0
    v_mfma_f32_16x16x32_bf16 v[108:111], v[12:15], a[204:207], 0
    s_andn2_b32 s82, s97, 3
    s_lshl_b32 s82, s82, 7
    s_add_u32 s82, s82, 28442624
    s_add_u32 s80, s16, s82
    s_addc_u32 s81, s17, 0
    s_cmp_eq_u32 s3, 0
    s_cselect_b32 s82, 512, 0
    s_mov_b32 s83, 0x20000
    v_mov_b32 v146, 1
    v_lshlrev_b32 v147, 7, v0
    s_waitcnt vmcnt(0)
    s_barrier
    buffer_atomic_add v146, v147, s[80:83], 0 offen sc1
    s_lshl_b32 s24, s3, 2
    s_add_u32 s26, s26, s24
    s_and_b32 s90, s32, 3
    s_add_u32 s90, s90, s26
    s_lshl_b32 s90, s90, 7
    s_add_u32 s90, s90, 28442624
    s_add_u32 s88, s16, s90
    s_addc_u32 s89, s17, 0
    s_mov_b32 s90, 4
    s_mov_b32 s91, 0x20000
    v_lshlrev_b32 v144, 4, v0
    s_mov_b32 s92, 1048576
Lw3_poll:
    v_mov_b32 v145, 0
    buffer_atomic_or v145, v144, s[88:91], 0 offen sc0 sc1
    s_sub_u32 s92, s92, 1
    s_cbranch_scc1 Lw3_join
    s_waitcnt vmcnt(0)
    v_readfirstlane_b32 vcc_lo, v145
    s_nop 1
    s_cmp_lg_u32 vcc_lo, 4
    s_cbranch_scc1 Lw3_poll
Lw3_join:
    buffer_load_dwordx4 v[32:35], v4, s[4:7], s60 offen sc1
    buffer_load_dwordx4 v[36:39], v4, s[4:7], s61 offen sc1
    buffer_load_dwordx4 v[40:43], v4, s[4:7], s62 offen sc1
    buffer_load_dwordx4 v[44:47], v4, s[4:7], s63 offen sc1
    buffer_load_dwordx4 v[48:51], v4, s[28:31], s60 offen sc1
    buffer_load_dwordx4 v[52:55], v4, s[28:31], s61 offen sc1
    buffer_load_dwordx4 v[56:59], v4, s[28:31], s62 offen sc1
    buffer_load_dwordx4 v[60:63], v4, s[28:31], s63 offen sc1
    s_waitcnt vmcnt(7)
    v_mfma_f32_16x16x32_bf16 v[80:83], v[10:13], v[32:35], v[80:83]
    v_mfma_f32_16x16x32_bf16 v[84:87], v[12:15], v[32:35], v[84:87]
    s_waitcnt vmcnt(6)
    v_mfma_f32_16x16x32_bf16 v[88:91], v[10:13], v[36:39], v[88:91]
    v_mfma_f32_16x16x32_bf16 v[92:95], v[12:15], v[36:39], v[92:95]
    s_waitcnt vmcnt(5)
    v_mfma_f32_16x16x32_bf16 v[96:99], v[10:13], v[40:43], v[96:99]
    v_mfma_f32_16x16x32_bf16 v[100:103], v[12:15], v[40:43], v[100:103]
    s_waitcnt vmcnt(4)
    v_mfma_f32_16x16x32_bf16 v[104:107], v[10:13], v[44:47], v[104:107]
    v_mfma_f32_16x16x32_bf16 v[108:111], v[12:15], v[44:47], v[108:111]
    s_waitcnt vmcnt(3)
    v_mfma_f32_16x16x32_bf16 v[80:83], v[10:13], v[48:51], v[80:83]
    v_mfma_f32_16x16x32_bf16 v[84:87], v[12:15], v[48:51], v[84:87]
    s_waitcnt vmcnt(2)
    v_mfma_f32_16x16x32_bf16 v[88:91], v[10:13], v[52:55], v[88:91]
    v_mfma_f32_16x16x32_bf16 v[92:95], v[12:15], v[52:55], v[92:95]
    s_waitcnt vmcnt(1)
    v_mfma_f32_16x16x32_bf16 v[96:99], v[10:13], v[56:59], v[96:99]
    v_mfma_f32_16x16x32_bf16 v[100:103], v[12:15], v[56:59], v[100:103]
    s_waitcnt vmcnt(0)
    v_mfma_f32_16x16x32_bf16 v[104:107], v[10:13], v[60:63], v[104:107]
    v_mfma_f32_16x16x32_bf16 v[108:111], v[12:15], v[60:63], v[108:111]
    s_nop 1
    v_pk_add_f32 v[2:3], v[80:81], v[82:83]
    v_pk_mul_f32 v[8:9], v[80:81], v[80:81]
    v_pk_fma_f32 v[8:9], v[82:83], v[82:83], v[8:9]
    v_pk_add_f32 v[2:3], v[2:3], v[84:85]
    v_pk_fma_f32 v[8:9], v[84:85], v[84:85], v[8:9]
    v_pk_add_f32 v[2:3], v[2:3], v[86:87]
    v_pk_fma_f32 v[8:9], v[86:87], v[86:87], v[8:9]
    v_pk_add_f32 v[2:3], v[2:3], v[88:89]
    v_pk_fma_f32 v[8:9], v[88:89], v[88:89], v[8:9]
    v_pk_add_f32 v[2:3], v[2:3], v[90:91]
    v_pk_fma_f32 v[8:9], v[90:91], v[90:91], v[8:9]
    v_pk_add_f32 v[2:3], v[2:3], v[92:93]
    v_pk_fma_f32 v[8:9], v[92:93], v[92:93], v[8:9]
    v_pk_add_f32 v[2:3], v[2:3], v[94:95]
    v_pk_fma_f32 v[8:9], v[94:95], v[94:95], v[8:9]
    v_pk_add_f32 v[2:3], v[2:3], v[96:97]
    v_pk_fma_f32 v[8:9], v[96:97], v[96:97], v[8:9]
    v_pk_add_f32 v[2:3], v[2:3], v[98:99]
    v_pk_fma_f32 v[8:9], v[98:99], v[98:99], v[8:9]
    v_pk_add_f32 v[2:3], v[2:3], v[100:101]
    v_pk_fma_f32 v[8:9], v[100:101], v[100:101], v[8:9]
    v_pk_add_f32 v[2:3], v[2:3], v[102:103]
    v_pk_fma_f32 v[8:9], v[102:103], v[102:103], v[8:9]
    v_pk_add_f32 v[2:3], v[2:3], v[104:105]
    v_pk_fma_f32 v[8:9], v[104:105], v[104:105], v[8:9]
    v_pk_add_f32 v[2:3], v[2:3], v[106:107]
    v_pk_fma_f32 v[8:9], v[106:107], v[106:107], v[8:9]
    v_pk_add_f32 v[2:3], v[2:3], v[108:109]
    v_pk_fma_f32 v[8:9], v[108:109], v[108:109], v[8:9]
    v_pk_add_f32 v[2:3], v[2:3], v[110:111]
    v_pk_fma_f32 v[8:9], v[110:111], v[110:111], v[8:9]
    v_add_f32 v2, v2, v3
    v_add_f32 v3, v8, v9
    s_nop 0
    v_add_f32_dpp v2, v2, v2 row_ror:8 row_mask:0xf bank_mask:0xf
    v_add_f32_dpp v3, v3, v3 row_ror:8 row_mask:0xf bank_mask:0xf
    v_mov_b32 v8, v2
    v_mov_b32 v9, v3
    s_nop 0
    v_permlane16_swap_b32 v2, v8
    v_permlane16_swap_b32 v3, v9
    s_nop 0
    v_pk_add_f32 v[2:3], v[2:3], v[8:9]
    v_mov_b32 v8, v2
    v_mov_b32 v9, v3
    s_nop 0
    v_permlane32_swap_b32 v2, v8
    v_permlane32_swap_b32 v3, v9
    s_nop 0
    v_pk_add_f32 v[2:3], v[2:3], v[8:9]
    ds_write_b64 v5, v[2:3] offset:0
    v_cvt_pk_bf16_f32 v16, v80, v81
    v_cvt_pk_bf16_f32 v17, v82, v83
    v_cvt_pk_bf16_f32 v18, v84, v85
    v_cvt_pk_bf16_f32 v19, v86, v87
    v_cvt_pk_bf16_f32 v20, v88, v89
    v_cvt_pk_bf16_f32 v21, v90, v91
    v_cvt_pk_bf16_f32 v22, v92, v93
    v_cvt_pk_bf16_f32 v23, v94, v95
    v_cvt_pk_bf16_f32 v24, v96, v97
    v_cvt_pk_bf16_f32 v25, v98, v99
    v_cvt_pk_bf16_f32 v26, v100, v101
    v_cvt_pk_bf16_f32 v27, v102, v103
    v_cvt_pk_bf16_f32 v28, v104, v105
    v_cvt_pk_bf16_f32 v29, v106, v107
    v_cvt_pk_bf16_f32 v30, v108, v109
    v_cvt_pk_bf16_f32 v31, v110, v111
    s_waitcnt lgkmcnt(0)
    s_barrier
    ds_read_b128 v[32:35], v6 offset:0
    ds_read_b128 v[36:39], v6 offset:16
    v_mfma_f32_16x16x32_bf16 v[80:83], v[10:13], v[16:19], 0
    v_mfma_f32_16x16x32_bf16 v[84:87], v[12:15], v[16:19], 0
    v_mfma_f32_16x16x32_bf16 v[88:91], v[10:13], v[20:23], 0
    v_mfma_f32_16x16x32_bf16 v[92:95], v[12:15], v[20:23], 0
    v_mfma_f32_16x16x32_bf16 v[96:99], v[10:13], v[24:27], 0
    v_mfma_f32_16x16x32_bf16 v[100:103], v[12:15], v[24:27], 0
    v_mfma_f32_16x16x32_bf16 v[104:107], v[10:13], v[28:31], 0
    v_mfma_f32_16x16x32_bf16 v[108:111], v[12:15], v[28:31], 0
    s_waitcnt lgkmcnt(0)
    v_add_f32 v2, v32, v34
    v_add_f32 v8, v36, v38
    v_add_f32 v3, v33, v35
    v_add_f32 v9, v37, v39
    v_add_f32 v2, v2, v8
    v_add_f32 v3, v3, v9
    v_mul_f32 v8, 0xba800000, v2
    v_mul_f32 v3, 0x3a800000, v3
    v_fma_f32 v3, -v8, v8, v3
    v_max_f32 v3, 0, v3
    v_cvt_pk_bf16_f32 v3, v3, v3
    v_and_b32 v3, s27, v3
    v_add_f32 v3, 0x3727c5ac, v3
    v_cvt_pk_bf16_f32 v3, v3, v3
    v_and_b32 v3, s27, v3
    v_sqrt_f32 v3, v3
    v_cvt_pk_bf16_f32 v8, v8, v8
    v_and_b32 v8, s27, v8
    v_cvt_pk_bf16_f32 v3, v3, v3
    v_and_b32 v3, s27, v3
    v_rcp_f32 v2, v3
    s_nop 0
    v_mov_b32 v3, v2
    v_mul_f32 v8, v8, v2
    v_mov_b32 v9, v8
    v_pk_fma_f32 v[32:33], v[80:81], v[2:3], v[8:9]
    v_pk_fma_f32 v[34:35], v[82:83], v[2:3], v[8:9]
    v_pk_fma_f32 v[36:37], v[84:85], v[2:3], v[8:9]
    v_pk_fma_f32 v[38:39], v[86:87], v[2:3], v[8:9]
    v_pk_fma_f32 v[40:41], v[88:89], v[2:3], v[8:9]
    v_pk_fma_f32 v[42:43], v[90:91], v[2:3], v[8:9]
    v_pk_fma_f32 v[44:45], v[92:93], v[2:3], v[8:9]
    v_pk_fma_f32 v[46:47], v[94:95], v[2:3], v[8:9]
    v_pk_fma_f32 v[48:49], v[96:97], v[2:3], v[8:9]
    v_pk_fma_f32 v[50:51], v[98:99], v[2:3], v[8:9]
    v_pk_fma_f32 v[52:53], v[100:101], v[2:3], v[8:9]
    v_pk_fma_f32 v[54:55], v[102:103], v[2:3], v[8:9]
    v_pk_fma_f32 v[56:57], v[104:105], v[2:3], v[8:9]
    v_pk_fma_f32 v[58:59], v[106:107], v[2:3], v[8:9]
    v_pk_fma_f32 v[60:61], v[108:109], v[2:3], v[8:9]
    v_pk_fma_f32 v[62:63], v[110:111], v[2:3], v[8:9]
    v_pk_fma_f32 v[80:81], v[32:33], v[112:113], v[80:81]
    v_pk_fma_f32 v[82:83], v[34:35], v[114:115], v[82:83]
    v_pk_fma_f32 v[84:85], v[36:37], v[116:117], v[84:85]
    v_pk_fma_f32 v[86:87], v[38:39], v[118:119], v[86:87]
    v_pk_fma_f32 v[88:89], v[40:41], v[120:121], v[88:89]
    v_pk_fma_f32 v[90:91], v[42:43], v[122:123], v[90:91]
    v_pk_fma_f32 v[92:93], v[44:45], v[124:125], v[92:93]
    v_pk_fma_f32 v[94:95], v[46:47], v[126:127], v[94:95]
    v_pk_fma_f32 v[96:97], v[48:49], v[128:129], v[96:97]
    v_pk_fma_f32 v[98:99], v[50:51], v[130:131], v[98:99]
    v_pk_fma_f32 v[100:101], v[52:53], v[132:133], v[100:101]
    v_pk_fma_f32 v[102:103], v[54:55], v[134:135], v[102:103]
    v_pk_fma_f32 v[104:105], v[56:57], v[136:137], v[104:105]
    v_pk_fma_f32 v[106:107], v[58:59], v[138:139], v[106:107]
    v_pk_fma_f32 v[108:109], v[60:61], v[140:141], v[108:109]
    v_pk_fma_f32 v[110:111], v[62:63], v[142:143], v[110:111]
    v_pk_add_f32 v[2:3], v[80:81], v[82:83]
    v_pk_mul_f32 v[8:9], v[80:81], v[80:81]
    v_pk_fma_f32 v[8:9], v[82:83], v[82:83], v[8:9]
    v_pk_add_f32 v[2:3], v[2:3], v[84:85]
    v_pk_fma_f32 v[8:9], v[84:85], v[84:85], v[8:9]
    v_pk_add_f32 v[2:3], v[2:3], v[86:87]
    v_pk_fma_f32 v[8:9], v[86:87], v[86:87], v[8:9]
    v_pk_add_f32 v[2:3], v[2:3], v[88:89]
    v_pk_fma_f32 v[8:9], v[88:89], v[88:89], v[8:9]
    v_pk_add_f32 v[2:3], v[2:3], v[90:91]
    v_pk_fma_f32 v[8:9], v[90:91], v[90:91], v[8:9]
    v_pk_add_f32 v[2:3], v[2:3], v[92:93]
    v_pk_fma_f32 v[8:9], v[92:93], v[92:93], v[8:9]
    v_pk_add_f32 v[2:3], v[2:3], v[94:95]
    v_pk_fma_f32 v[8:9], v[94:95], v[94:95], v[8:9]
    v_pk_add_f32 v[2:3], v[2:3], v[96:97]
    v_pk_fma_f32 v[8:9], v[96:97], v[96:97], v[8:9]
    v_pk_add_f32 v[2:3], v[2:3], v[98:99]
    v_pk_fma_f32 v[8:9], v[98:99], v[98:99], v[8:9]
    v_pk_add_f32 v[2:3], v[2:3], v[100:101]
    v_pk_fma_f32 v[8:9], v[100:101], v[100:101], v[8:9]
    v_pk_add_f32 v[2:3], v[2:3], v[102:103]
    v_pk_fma_f32 v[8:9], v[102:103], v[102:103], v[8:9]
    v_pk_add_f32 v[2:3], v[2:3], v[104:105]
    v_pk_fma_f32 v[8:9], v[104:105], v[104:105], v[8:9]
    v_pk_add_f32 v[2:3], v[2:3], v[106:107]
    v_pk_fma_f32 v[8:9], v[106:107], v[106:107], v[8:9]
    v_pk_add_f32 v[2:3], v[2:3], v[108:109]
    v_pk_fma_f32 v[8:9], v[108:109], v[108:109], v[8:9]
    v_pk_add_f32 v[2:3], v[2:3], v[110:111]
    v_pk_fma_f32 v[8:9], v[110:111], v[110:111], v[8:9]
    v_add_f32 v2, v2, v3
    v_add_f32 v3, v8, v9
    s_nop 0
    v_add_f32_dpp v2, v2, v2 row_ror:8 row_mask:0xf bank_mask:0xf
    v_add_f32_dpp v3, v3, v3 row_ror:8 row_mask:0xf bank_mask:0xf
    v_mov_b32 v8, v2
    v_mov_b32 v9, v3
    s_nop 0
    v_permlane16_swap_b32 v2, v8
    v_permlane16_swap_b32 v3, v9
    s_nop 0
    v_pk_add_f32 v[2:3], v[2:3], v[8:9]
    v_mov_b32 v8, v2
    v_mov_b32 v9, v3
    s_nop 0
    v_permlane32_swap_b32 v2, v8
    v_permlane32_swap_b32 v3, v9
    s_nop 0
    v_pk_add_f32 v[2:3], v[2:3], v[8:9]
    ds_write_b64 v5, v[2:3] offset:256
    v_cvt_pk_bf16_f32 v16, v80, v81
    v_cvt_pk_bf16_f32 v17, v82, v83
    v_cvt_pk_bf16_f32 v18, v84, v85
    v_cvt_pk_bf16_f32 v19, v86, v87
    v_cvt_pk_bf16_f32 v20, v88, v89
    v_cvt_pk_bf16_f32 v21, v90, v91
    v_cvt_pk_bf16_f32 v22, v92, v93
    v_cvt_pk_bf16_f32 v23, v94, v95
    v_cvt_pk_bf16_f32 v24, v96, v97
    v_cvt_pk_bf16_f32 v25, v98, v99
    v_cvt_pk_bf16_f32 v26, v100, v101
    v_cvt_pk_bf16_f32 v27, v102, v103
    v_cvt_pk_bf16_f32 v28, v104, v105
    v_cvt_pk_bf16_f32 v29, v106, v107
    v_cvt_pk_bf16_f32 v30, v108, v109
    v_cvt_pk_bf16_f32 v31, v110, v111
    s_waitcnt lgkmcnt(0)
    s_barrier
    ds_read_b128 v[32:35], v6 offset:256
    ds_read_b128 v[36:39], v6 offset:272
    v_mfma_f32_16x16x32_bf16 v[80:83], v[10:13], v[16:19], 0
    v_mfma_f32_16x16x32_bf16 v[84:87], v[12:15], v[16:19], 0
    v_mfma_f32_16x16x32_bf16 v[88:91], v[10:13], v[20:23], 0
    v_mfma_f32_16x16x32_bf16 v[92:95], v[12:15], v[20:23], 0
    v_mfma_f32_16x16x32_bf16 v[96:99], v[10:13], v[24:27], 0
    v_mfma_f32_16x16x32_bf16 v[100:103], v[12:15], v[24:27], 0
    v_mfma_f32_16x16x32_bf16 v[104:107], v[10:13], v[28:31], 0
    v_mfma_f32_16x16x32_bf16 v[108:111], v[12:15], v[28:31], 0
    s_waitcnt lgkmcnt(0)
    v_add_f32 v2, v32, v34
    v_add_f32 v8, v36, v38
    v_add_f32 v3, v33, v35
    v_add_f32 v9, v37, v39
    v_add_f32 v2, v2, v8
    v_add_f32 v3, v3, v9
    v_mul_f32 v8, 0xba800000, v2
    v_mul_f32 v3, 0x3a800000, v3
    v_fma_f32 v3, -v8, v8, v3
    v_max_f32 v3, 0, v3
    v_cvt_pk_bf16_f32 v3, v3, v3
    v_and_b32 v3, s27, v3
    v_add_f32 v3, 0x3727c5ac, v3
    v_cvt_pk_bf16_f32 v3, v3, v3
    v_and_b32 v3, s27, v3
    v_sqrt_f32 v3, v3
    v_cvt_pk_bf16_f32 v8, v8, v8
    v_and_b32 v8, s27, v8
    v_cvt_pk_bf16_f32 v3, v3, v3
    v_and_b32 v3, s27, v3
    v_rcp_f32 v2, v3
    s_nop 0
    v_mov_b32 v3, v2
    v_mul_f32 v8, v8, v2
    v_mov_b32 v9, v8
    v_pk_fma_f32 v[80:81], v[80:81], v[2:3], v[8:9]
    v_pk_fma_f32 v[82:83], v[82:83], v[2:3], v[8:9]
    v_pk_fma_f32 v[84:85], v[84:85], v[2:3], v[8:9]
    v_pk_fma_f32 v[86:87], v[86:87], v[2:3], v[8:9]
    v_cvt_pk_bf16_f32 v64, v80, v81
    v_cvt_pk_bf16_f32 v65, v82, v83
    v_cvt_pk_bf16_f32 v66, v84, v85
    v_cvt_pk_bf16_f32 v67, v86, v87
    buffer_store_dwordx4 v[64:67], v4, s[20:23], s60 offen sc1
    v_pk_fma_f32 v[88:89], v[88:89], v[2:3], v[8:9]
    v_pk_fma_f32 v[90:91], v[90:91], v[2:3], v[8:9]
    v_pk_fma_f32 v[92:93], v[92:93], v[2:3], v[8:9]
    v_pk_fma_f32 v[94:95], v[94:95], v[2:3], v[8:9]
    v_cvt_pk_bf16_f32 v68, v88, v89
    v_cvt_pk_bf16_f32 v69, v90, v91
    v_cvt_pk_bf16_f32 v70, v92, v93
    v_cvt_pk_bf16_f32 v71, v94, v95
    buffer_store_dwordx4 v[68:71], v4, s[20:23], s61 offen sc1
    v_pk_fma_f32 v[96:97], v[96:97], v[2:3], v[8:9]
    v_pk_fma_f32 v[98:99], v[98:99], v[2:3], v[8:9]
    v_pk_fma_f32 v[100:101], v[100:101], v[2:3], v[8:9]
    v_pk_fma_f32 v[102:103], v[102:103], v[2:3], v[8:9]
    v_cvt_pk_bf16_f32 v72, v96, v97
    v_cvt_pk_bf16_f32 v73, v98, v99
    v_cvt_pk_bf16_f32 v74, v100, v101
    v_cvt_pk_bf16_f32 v75, v102, v103
    buffer_store_dwordx4 v[72:75], v4, s[20:23], s62 offen sc1
    v_pk_fma_f32 v[104:105], v[104:105], v[2:3], v[8:9]
    v_pk_fma_f32 v[106:107], v[106:107], v[2:3], v[8:9]
    v_pk_fma_f32 v[108:109], v[108:109], v[2:3], v[8:9]
    v_pk_fma_f32 v[110:111], v[110:111], v[2:3], v[8:9]
    v_cvt_pk_bf16_f32 v76, v104, v105
    v_cvt_pk_bf16_f32 v77, v106, v107
    v_cvt_pk_bf16_f32 v78, v108, v109
    v_cvt_pk_bf16_f32 v79, v110, v111
    buffer_store_dwordx4 v[76:79], v4, s[20:23], s63 offen sc1
    v_accvgpr_write_b32 a192, v16
    v_accvgpr_write_b32 a193, v17
    v_accvgpr_write_b32 a194, v18
    v_accvgpr_write_b32 a195, v19
    v_accvgpr_write_b32 a196, v20
    v_accvgpr_write_b32 a197, v21
    v_accvgpr_write_b32 a198, v22
    v_accvgpr_write_b32 a199, v23
    v_accvgpr_write_b32 a200, v24
    v_accvgpr_write_b32 a201, v25
    v_accvgpr_write_b32 a202, v26
    v_accvgpr_write_b32 a203, v27
    v_accvgpr_write_b32 a204, v28
    v_accvgpr_write_b32 a205, v29
    v_accvgpr_write_b32 a206, v30
    v_accvgpr_write_b32 a207, v31
    v_add_u32 v17, s60, v4
    s_add_u32 s97, s32, 768
    s_mov_b32 s96, 1
    s_branch Lg1
Lg2f:
    s_and_b32 s18, s2, 7
    s_lshr_b32 s19, s2, 3
    s_and_b32 s27, s18, 1
    s_and_b32 s20, s19, 3
    s_lshr_b32 s22, s18, 1
    s_lshl_b32 s22, s22, 2
    s_add_u32 s20, s20, s22
    s_lshr_b32 s21, s19, 2
    v_lshlrev_b32 v1, 4, v0
    s_lshl_b32 s22, s20, 2
    s_add_u32 s22, s22, s3
    s_lshl_b32 s26, s3, 12
    s_mul_i32 s24, s27, 114688
    s_mul_i32 s25, s27, 458752
    s_add_u32 s25, s25, s26
    s_mul_i32 s23, s22, 229376
    s_add_u32 s23, s23, 67108864
    s_mul_i32 s30, s21, 917504
    s_add_u32 s30, s30, 46137344
    s_add_u32 s8, s16, s30
    s_addc_u32 s9, s17, 0
    s_mov_b32 s10, 917504
    s_mov_b32 s11, 0x20000
    s_add_u32 s4, s16, s23
    s_addc_u32 s5, s17, 0
    s_mov_b32 s6, 229376
    s_mov_b32 s7, 0x20000
    s_add_u32 s4, s4, s24
    s_addc_u32 s5, s5, 0
    s_mov_b32 s6, 114688
    s_add_u32 s8, s8, s25
    s_addc_u32 s9, s9, 0
    s_mov_b32 s10, 458752
    s_add_u32 s37, s20, s21
    s_and_b32 s37, s37, 3
    s_lshl_b32 s18, 0x11111111, s37
    s_lshl_b32 s19, 0xffffff, s37
    s_cmp_eq_u32 s37, 0
    s_cselect_b32 s19, 0xfffffff, s19
    s_not_b32 s19, s19
    s_mov_b32 s79, 0
    s_bitcmp1_b32 s18, s79
    s_cselect_b32 s78, 3, -1
    s_bitcmp1_b32 s19, s79
    s_cselect_b32 s78, 0, s78
    s_add_u32 s78, s78, s79
    s_add_u32 s79, s79, 1
    s_mov_b32 s37, 1
    s_lshl_b32 s24, s78, 12
    s_lshl_b32 s25, s78, 14
    s_lshl_b32 s23, s27, 12
    v_add_u32 v8, s23, v1
    s_xor_b32 s23, s23, 4096
    v_add_u32 v6, s23, v1
    v_add_u32 v7, 65536, v6
    v_add_u32 v9, 65536, v8
    s_lshl_b32 s23, s20, 3
    s_add_u32 s23, s23, s21
    s_lshl_b32 s23, s23, 2
    s_add_u32 s23, s23, s3
    s_lshl_b32 s23, s23, 1
    s_add_u32 s23, s23, s27
    s_lshl_b32 s38, s23, 12
    s_add_u32 s38, s38, 92274688
    s_add_u32 s60, s16, s38
    s_addc_u32 s61, s17, 0
    s_mov_b32 s62, 4096
    s_mov_b32 s63, 0x20000
    s_lshl_b32 s38, s23, 7
    s_add_u32 s38, s38, 28704768
    s_add_u32 s64, s16, s38
    s_addc_u32 s65, s17, 0
    s_mov_b32 s66, 4
    s_mov_b32 s67, 0x20000
    s_xor_b32 s23, s23, 1
    s_lshl_b32 s38, s23, 12
    s_add_u32 s38, s38, 92274688
    s_add_u32 s68, s16, s38
    s_addc_u32 s69, s17, 0
    s_mov_b32 s70, 4096
    s_mov_b32 s71, 0x20000
    s_lshl_b32 s38, s23, 7
    s_add_u32 s38, s38, 28704768
    s_add_u32 s84, s16, s38
    s_addc_u32 s85, s17, 0
    s_mov_b32 s86, 4
    s_mov_b32 s87, 0x20000
    s_xor_b32 s23, s23, 1
    v_mov_b32 v12, 0
    v_mov_b32 v10, 1
    s_lshr_b32 s36, s22, 1
    s_lshl_b32 s36, s36, 17
    s_and_b32 s23, s22, 1
    s_lshl_b32 s23, s23, 11
    s_add_u32 s36, s36, s23
    s_lshl_b32 s23, s21, 14
    s_add_u32 s36, s36, s23
    s_lshl_b32 s23, s27, 13
    s_add_u32 s72, s36, s23
    s_add_u32 s73, s72, 4096
    s_add_u32 s28, s16, 96468992
    s_addc_u32 s29, s17, 0
    s_mov_b32 s30, 4194304
    s_mov_b32 s31, 0x20000
    s_mov_b32 s32, s98
    s_mov_b32 s33, s99
    s_mov_b32 s34, 4194304
    s_mov_b32 s35, 0x20000
    v_lshrrev_b32 v13, 4, v0
    v_bfe_u32 v14, v0, 2, 2
    v_cmp_eq_u32 vcc, v13, v14
    v_and_b32 v13, 1, v0
    v_lshlrev_b32 v13, 4, v13
    v_mov_b32 v15, 0x3f80
    v_lshlrev_b32 v13, v13, v15
    v_cndmask_b32 v13, 0, v13, vcc
    v_and_b32 v14, 2, v0
    v_cmp_eq_u32 vcc, 0, v14
    v_mov_b32 v18, 0
    v_mov_b32 v19, 0
    v_cndmask_b32 v16, 0, v13, vcc
    v_cndmask_b32 v17, v13, v18, vcc
    v_mov_b32 v20, v16
    v_mov_b32 v21, v17
    s_mul_i32 s23, s3, 4608
    s_add_u32 s23, s23, 65536
    v_and_b32 v13, 15, v0
    s_movk_i32 s38, 144
    v_mul_u32_u24 v14, s38, v13
    v_lshrrev_b32 v15, 4, v0
    v_lshl_add_u32 v14, v15, 3, v14
    v_add_u32 v14, s23, v14
    v_lshrrev_b32 v15, 3, v0
    v_and_b32 v13, 7, v0
    v_mul_u32_u24 v2, s38, v15
    v_lshl_add_u32 v2, v13, 4, v2
    v_add_u32 v2, s23, v2
    v_lshlrev_b32 v3, 11, v15
    v_lshl_add_u32 v3, v13, 4, v3
    s_lshl_b32 s36, s22, 16
    s_lshl_b32 s23, s21, 8
    s_add_u32 s36, s36, s23
    s_lshl_b32 s23, s27, 7
    s_add_u32 s36, s36, s23
    s_and_b32 s23, s20, 14
    s_add_u32 s23, s23, s27
    s_lshl_b32 s23, s23, 4
    s_add_u32 s23, s23, 1024
    s_andn2_b32 s90, s97, 15
    s_lshl_b32 s90, s90, 7
    s_add_u32 s90, s90, 28442624
    s_add_u32 s88, s16, s90
    s_addc_u32 s89, s17, 0
    s_cmp_eq_u32 s3, 0
    s_cselect_b32 s90, 1024, 0
    s_mov_b32 s91, 0x20000
    v_mov_b32 v24, 1
    v_lshlrev_b32 v25, 7, v0
    s_waitcnt vmcnt(0)
    s_barrier
    buffer_atomic_add v24, v25, s[88:91], 0 offen sc1
    s_add_u32 m0, s26, 0
    s_nop 0
    buffer_load_dwordx4 v1, s[8:11], s25 offen offset:0 sc1 lds
    buffer_load_dwordx4 v1, s[8:11], s25 offen offset:1024 sc1 lds
    buffer_load_dwordx4 v1, s[8:11], s25 offen offset:2048 sc1 lds
    buffer_load_dwordx4 v1, s[8:11], s25 offen offset:3072 sc1 lds
    s_bitcmp1_b32 s18, s79
    s_cselect_b32 s78, 3, -1
    s_bitcmp1_b32 s19, s79
    s_cselect_b32 s78, 0, s78
    s_add_u32 s78, s78, s79
    s_add_u32 s79, s79, 1
    s_lshl_b32 s25, s78, 14
    s_add_u32 m0, s26, 16384
    s_nop 0
    buffer_load_dwordx4 v1, s[8:11], s25 offen offset:0 sc1 lds
    buffer_load_dwordx4 v1, s[8:11], s25 offen offset:1024 sc1 lds
    buffer_load_dwordx4 v1, s[8:11], s25 offen offset:2048 sc1 lds
    buffer_load_dwordx4 v1, s[8:11], s25 offen offset:3072 sc1 lds
    s_bitcmp1_b32 s18, s79
    s_cselect_b32 s78, 3, -1
    s_bitcmp1_b32 s19, s79
    s_cselect_b32 s78, 0, s78
    s_add_u32 s78, s78, s79
    s_add_u32 s79, s79, 1
    s_lshl_b32 s25, s78, 14
    s_add_u32 m0, s26, 32768
    s_nop 0
    buffer_load_dwordx4 v1, s[8:11], s25 offen offset:0 sc1 lds
    buffer_load_dwordx4 v1, s[8:11], s25 offen offset:1024 sc1 lds
    buffer_load_dwordx4 v1, s[8:11], s25 offen offset:2048 sc1 lds
    buffer_load_dwordx4 v1, s[8:11], s25 offen offset:3072 sc1 lds
    s_lshl_b32 s77, s20, 3
    s_add_u32 s77, s77, s21
    s_cmp_lg_u32 s3, 0
    s_cbranch_scc1 Lw4_join
    s_and_b32 s90, s77, 7
    s_add_u32 s90, s90, s23
    s_lshl_b32 s90, s90, 7
    s_add_u32 s90, s90, 28442624
    s_add_u32 s88, s16, s90
    s_addc_u32 s89, s17, 0
    s_mov_b32 s90, 4
    s_mov_b32 s91, 0x20000
    v_lshlrev_b32 v24, 4, v0
    s_mov_b32 s92, 1048576
Lw4_poll:
    v_mov_b32 v25, 0
    buffer_atomic_or v25, v24, s[88:91], 0 offen sc0 sc1
    s_sub_u32 s92, s92, 1
    s_cbranch_scc1 Lw4_join
    s_waitcnt vmcnt(0)
    v_readfirstlane_b32 vcc_lo, v25
    s_nop 1
    s_cmp_lg_u32 vcc_lo, 16
    s_cbranch_scc1 Lw4_poll
Lw4_join:
    s_waitcnt vmcnt(8)
    s_barrier
    buffer_load_dwordx4 a[0:3], v1, s[4:7], s24 offen offset:0 sc1
    s_bitcmp1_b32 s18, s37
    s_cselect_b32 s78, 3, -1
    buffer_load_dwordx4 a[4:7], v1, s[4:7], s24 offen offset:1024 sc1
    s_bitcmp1_b32 s19, s37
    s_cselect_b32 s78, 0, s78
    buffer_load_dwordx4 a[8:11], v1, s[4:7], s24 offen offset:2048 sc1
    s_add_u32 s78, s78, s37
    s_add_u32 s37, s37, 1
    buffer_load_dwordx4 a[12:15], v1, s[4:7], s24 offen offset:3072 sc1
    s_lshl_b32 s24, s78, 12
    s_lshl_b32 s25, s78, 14
    buffer_load_dwordx4 a[16:19], v1, s[4:7], s24 offen offset:0 sc1
    s_bitcmp1_b32 s18, s37
    s_cselect_b32 s78, 3, -1
    buffer_load_dwordx4 a[20:23], v1, s[4:7], s24 offen offset:1024 sc1
    s_bitcmp1_b32 s19, s37
    s_cselect_b32 s78, 0, s78
    buffer_load_dwordx4 a[24:27], v1, s[4:7], s24 offen offset:2048 sc1
    s_add_u32 s78, s78, s37
    s_add_u32 s37, s37, 1
    buffer_load_dwordx4 a[28:31], v1, s[4:7], s24 offen offset:3072 sc1
    s_lshl_b32 s24, s78, 12
    s_lshl_b32 s25, s78, 14
    buffer_load_dwordx4 a[32:35], v1, s[4:7], s24 offen offset:0 sc1
    s_bitcmp1_b32 s18, s37
    s_cselect_b32 s78, 3, -1
    buffer_load_dwordx4 a[36:39], v1, s[4:7], s24 offen offset:1024 sc1
    s_bitcmp1_b32 s19, s37
    s_cselect_b32 s78, 0, s78
    buffer_load_dwordx4 a[40:43], v1, s[4:7], s24 offen offset:2048 sc1
    s_add_u32 s78, s78, s37
    s_add_u32 s37, s37, 1
    buffer_load_dwordx4 a[44:47], v1, s[4:7], s24 offen offset:3072 sc1
    s_lshl_b32 s24, s78, 12
    s_lshl_b32 s25, s78, 14
    ds_read_b128 v[96:99], v6 offset:0
    ds_read_b128 v[100:103], v6 offset:8192
    ds_read_b128 v[104:107], v6 offset:1024
    ds_read_b128 v[108:111], v6 offset:9216
    ds_read_b128 v[112:115], v6 offset:2048
    ds_read_b128 v[116:119], v6 offset:10240
    ds_read_b128 v[120:123], v6 offset:3072
    ds_read_b128 v[124:127], v6 offset:11264
    ds_read_b128 v[128:131], v8 offset:0
    ds_read_b128 v[132:135], v8 offset:8192
    ds_read_b128 v[136:139], v8 offset:1024
    ds_read_b128 v[140:143], v8 offset:9216
    ds_read_b128 v[144:147], v8 offset:2048
    ds_read_b128 v[148:151], v8 offset:10240
    ds_read_b128 v[152:155], v8 offset:3072
    ds_read_b128 v[156:159], v8 offset:11264
    s_waitcnt vmcnt(8) lgkmcnt(8)
    v_mfma_f32_16x16x32_bf16 v[32:35], v[96:99], a[0:3], 0
    v_mfma_f32_16x16x32_bf16 v[32:35], v[100:103], a[8:11], v[32:35]
    v_mfma_f32_16x16x32_bf16 v[36:39], v[100:103], a[12:15], 0
    v_mfma_f32_16x16x32_bf16 v[36:39], v[96:99], a[4:7], v[36:39]
    s_barrier
    v_mfma_f32_16x16x32_bf16 v[44:47], v[104:107], a[4:7], 0
    ds_read_b128 v[96:99], v6 offset:16384
    s_add_u32 m0, s26, 49152
    v_mfma_f32_16x16x32_bf16 v[44:47], v[108:111], a[12:15], v[44:47]
    buffer_load_dwordx4 v1, s[8:11], s25 offen offset:0 sc1 lds
    v_mfma_f32_16x16x32_bf16 v[40:43], v[108:111], a[8:11], 0
    ds_read_b128 v[100:103], v6 offset:24576
    v_mfma_f32_16x16x32_bf16 v[40:43], v[104:107], a[0:3], v[40:43]
    v_mfma_f32_16x16x32_bf16 v[48:51], v[112:115], a[0:3], 0
    ds_read_b128 v[104:107], v6 offset:17408
    v_mfma_f32_16x16x32_bf16 v[48:51], v[116:119], a[8:11], v[48:51]
    buffer_load_dwordx4 v1, s[8:11], s25 offen offset:1024 sc1 lds
    v_mfma_f32_16x16x32_bf16 v[52:55], v[116:119], a[12:15], 0
    ds_read_b128 v[108:111], v6 offset:25600
    v_mfma_f32_16x16x32_bf16 v[52:55], v[112:115], a[4:7], v[52:55]
    v_mfma_f32_16x16x32_bf16 v[60:63], v[120:123], a[4:7], 0
    ds_read_b128 v[112:115], v6 offset:18432
    v_mfma_f32_16x16x32_bf16 v[60:63], v[124:127], a[12:15], v[60:63]
    buffer_load_dwordx4 v1, s[8:11], s25 offen offset:2048 sc1 lds
    v_mfma_f32_16x16x32_bf16 v[56:59], v[124:127], a[8:11], 0
    ds_read_b128 v[116:119], v6 offset:26624
    v_mfma_f32_16x16x32_bf16 v[56:59], v[120:123], a[0:3], v[56:59]
    s_waitcnt lgkmcnt(6)
    v_mfma_f32_16x16x32_bf16 v[64:67], v[128:131], a[0:3], 0
    ds_read_b128 v[120:123], v6 offset:19456
    v_mfma_f32_16x16x32_bf16 v[64:67], v[132:135], a[8:11], v[64:67]
    buffer_load_dwordx4 v1, s[8:11], s25 offen offset:3072 sc1 lds
    v_mfma_f32_16x16x32_bf16 v[68:71], v[132:135], a[12:15], 0
    ds_read_b128 v[124:127], v6 offset:27648
    v_mfma_f32_16x16x32_bf16 v[68:71], v[128:131], a[4:7], v[68:71]
    v_mfma_f32_16x16x32_bf16 v[76:79], v[136:139], a[4:7], 0
    ds_read_b128 v[128:131], v8 offset:16384
    v_mfma_f32_16x16x32_bf16 v[76:79], v[140:143], a[12:15], v[76:79]
    buffer_load_dwordx4 a[48:51], v1, s[4:7], s24 offen offset:0 sc1
    v_mfma_f32_16x16x32_bf16 v[72:75], v[140:143], a[8:11], 0
    ds_read_b128 v[132:135], v8 offset:24576
    v_mfma_f32_16x16x32_bf16 v[72:75], v[136:139], a[0:3], v[72:75]
    s_bitcmp1_b32 s18, s37
    s_cselect_b32 s78, 3, -1
    v_mfma_f32_16x16x32_bf16 v[80:83], v[144:147], a[0:3], 0
    ds_read_b128 v[136:139], v8 offset:17408
    v_mfma_f32_16x16x32_bf16 v[80:83], v[148:151], a[8:11], v[80:83]
    buffer_load_dwordx4 a[52:55], v1, s[4:7], s24 offen offset:1024 sc1
    v_mfma_f32_16x16x32_bf16 v[84:87], v[148:151], a[12:15], 0
    ds_read_b128 v[140:143], v8 offset:25600
    v_mfma_f32_16x16x32_bf16 v[84:87], v[144:147], a[4:7], v[84:87]
    s_bitcmp1_b32 s19, s37
    s_cselect_b32 s78, 0, s78
    v_mfma_f32_16x16x32_bf16 v[92:95], v[152:155], a[4:7], 0
    ds_read_b128 v[144:147], v8 offset:18432
    v_mfma_f32_16x16x32_bf16 v[92:95], v[156:159], a[12:15], v[92:95]
    buffer_load_dwordx4 a[56:59], v1, s[4:7], s24 offen offset:2048 sc1
    v_mfma_f32_16x16x32_bf16 v[88:91], v[156:159], a[8:11], 0
    ds_read_b128 v[148:151], v8 offset:26624
    v_mfma_f32_16x16x32_bf16 v[88:91], v[152:155], a[0:3], v[88:91]
    s_add_u32 s78, s78, s37
    s_add_u32 s37, s37, 1
    s_waitcnt vmcnt(11) lgkmcnt(6)
    v_mfma_f32_16x16x32_bf16 v[32:35], v[96:99], a[16:19], v[32:35]
    ds_read_b128 v[152:155], v8 offset:19456
    v_mfma_f32_16x16x32_bf16 v[32:35], v[100:103], a[24:27], v[32:35]
    buffer_load_dwordx4 a[60:63], v1, s[4:7], s24 offen offset:3072 sc1
    v_mfma_f32_16x16x32_bf16 v[36:39], v[100:103], a[28:31], v[36:39]
    ds_read_b128 v[156:159], v8 offset:27648
    v_mfma_f32_16x16x32_bf16 v[36:39], v[96:99], a[20:23], v[36:39]
    s_barrier
    s_lshl_b32 s24, s78, 12
    s_lshl_b32 s25, s78, 14
    v_mfma_f32_16x16x32_bf16 v[44:47], v[104:107], a[20:23], v[44:47]
    ds_read_b128 v[96:99], v6 offset:32768
    s_add_u32 m0, s26, 0
    v_mfma_f32_16x16x32_bf16 v[44:47], v[108:111], a[28:31], v[44:47]
    buffer_load_dwordx4 v1, s[8:11], s25 offen offset:0 sc1 lds
    v_mfma_f32_16x16x32_bf16 v[40:43], v[108:111], a[24:27], v[40:43]
    ds_read_b128 v[100:103], v6 offset:40960
    v_mfma_f32_16x16x32_bf16 v[40:43], v[104:107], a[16:19], v[40:43]
    v_mfma_f32_16x16x32_bf16 v[48:51], v[112:115], a[16:19], v[48:51]
    ds_read_b128 v[104:107], v6 offset:33792
    v_mfma_f32_16x16x32_bf16 v[48:51], v[116:119], a[24:27], v[48:51]
    buffer_load_dwordx4 v1, s[8:11], s25 offen offset:1024 sc1 lds
    v_mfma_f32_16x16x32_bf16 v[52:55], v[116:119], a[28:31], v[52:55]
    ds_read_b128 v[108:111], v6 offset:41984
    v_mfma_f32_16x16x32_bf16 v[52:55], v[112:115], a[20:23], v[52:55]
    v_mfma_f32_16x16x32_bf16 v[60:63], v[120:123], a[20:23], v[60:63]
    ds_read_b128 v[112:115], v6 offset:34816
    v_mfma_f32_16x16x32_bf16 v[60:63], v[124:127], a[28:31], v[60:63]
    buffer_load_dwordx4 v1, s[8:11], s25 offen offset:2048 sc1 lds
    v_mfma_f32_16x16x32_bf16 v[56:59], v[124:127], a[24:27], v[56:59]
    ds_read_b128 v[116:119], v6 offset:43008
    v_mfma_f32_16x16x32_bf16 v[56:59], v[120:123], a[16:19], v[56:59]
    s_waitcnt lgkmcnt(6)
    v_mfma_f32_16x16x32_bf16 v[64:67], v[128:131], a[16:19], v[64:67]
    ds_read_b128 v[120:123], v6 offset:35840
    v_mfma_f32_16x16x32_bf16 v[64:67], v[132:135], a[24:27], v[64:67]
    buffer_load_dwordx4 v1, s[8:11], s25 offen offset:3072 sc1 lds
    v_mfma_f32_16x16x32_bf16 v[68:71], v[132:135], a[28:31], v[68:71]
    ds_read_b128 v[124:127], v6 offset:44032
    v_mfma_f32_16x16x32_bf16 v[68:71], v[128:131], a[20:23], v[68:71]
    v_mfma_f32_16x16x32_bf16 v[76:79], v[136:139], a[20:23], v[76:79]
    ds_read_b128 v[128:131], v8 offset:32768
    v_mfma_f32_16x16x32_bf16 v[76:79], v[140:143], a[28:31], v[76:79]
    buffer_load_dwordx4 a[0:3], v1, s[4:7], s24 offen offset:0 sc1
    v_mfma_f32_16x16x32_bf16 v[72:75], v[140:143], a[24:27], v[72:75]
    ds_read_b128 v[132:135], v8 offset:40960
    v_mfma_f32_16x16x32_bf16 v[72:75], v[136:139], a[16:19], v[72:75]
    s_bitcmp1_b32 s18, s37
    s_cselect_b32 s78, 3, -1
    v_mfma_f32_16x16x32_bf16 v[80:83], v[144:147], a[16:19], v[80:83]
    ds_read_b128 v[136:139], v8 offset:33792
    v_mfma_f32_16x16x32_bf16 v[80:83], v[148:151], a[24:27], v[80:83]
    buffer_load_dwordx4 a[4:7], v1, s[4:7], s24 offen offset:1024 sc1
    v_mfma_f32_16x16x32_bf16 v[84:87], v[148:151], a[28:31], v[84:87]
    ds_read_b128 v[140:143], v8 offset:41984
    v_mfma_f32_16x16x32_bf16 v[84:87], v[144:147], a[20:23], v[84:87]
    s_bitcmp1_b32 s19, s37
    s_cselect_b32 s78, 0, s78
    v_mfma_f32_16x16x32_bf16 v[92:95], v[152:155], a[20:23], v[92:95]
    ds_read_b128 v[144:147], v8 offset:34816
    v_mfma_f32_16x16x32_bf16 v[92:95], v[156:159], a[28:31], v[92:95]
    buffer_load_dwordx4 a[8:11], v1, s[4:7], s24 offen offset:2048 sc1
    v_mfma_f32_16x16x32_bf16 v[88:91], v[156:159], a[24:27], v[88:91]
    ds_read_b128 v[148:151], v8 offset:43008
    v_mfma_f32_16x16x32_bf16 v[88:91], v[152:155], a[16:19], v[88:91]
    s_add_u32 s78, s78, s37
    s_add_u32 s37, s37, 1
    s_mov_b32 s76, 5
Lg2f_loop:
    s_waitcnt vmcnt(15) lgkmcnt(6)
    v_mfma_f32_16x16x32_bf16 v[32:35], v[96:99], a[32:35], v[32:35]
    ds_read_b128 v[152:155], v8 offset:35840
    v_mfma_f32_16x16x32_bf16 v[32:35], v[100:103], a[40:43], v[32:35]
    buffer_load_dwordx4 a[12:15], v1, s[4:7], s24 offen offset:3072 sc1
    v_mfma_f32_16x16x32_bf16 v[36:39], v[100:103], a[44:47], v[36:39]
    ds_read_b128 v[156:159], v8 offset:44032
    v_mfma_f32_16x16x32_bf16 v[36:39], v[96:99], a[36:39], v[36:39]
    s_waitcnt vmcnt(12)
    s_barrier
    s_lshl_b32 s24, s78, 12
    s_lshl_b32 s25, s78, 14
    v_mfma_f32_16x16x32_bf16 v[44:47], v[104:107], a[36:39], v[44:47]
    ds_read_b128 v[96:99], v6 offset:49152
    s_add_u32 m0, s26, 16384
    v_mfma_f32_16x16x32_bf16 v[44:47], v[108:111], a[44:47], v[44:47]
    buffer_load_dwordx4 v1, s[8:11], s25 offen offset:0 sc1 lds
    v_mfma_f32_16x16x32_bf16 v[40:43], v[108:111], a[40:43], v[40:43]
    ds_read_b128 v[100:103], v6 offset:57344
    v_mfma_f32_16x16x32_bf16 v[40:43], v[104:107], a[32:35], v[40:43]
    v_mfma_f32_16x16x32_bf16 v[48:51], v[112:115], a[32:35], v[48:51]
    ds_read_b128 v[104:107], v6 offset:50176
    v_mfma_f32_16x16x32_bf16 v[48:51], v[116:119], a[40:43], v[48:51]
    buffer_load_dwordx4 v1, s[8:11], s25 offen offset:1024 sc1 lds
    v_mfma_f32_16x16x32_bf16 v[52:55], v[116:119], a[44:47], v[52:55]
    ds_read_b128 v[108:111], v6 offset:58368
    v_mfma_f32_16x16x32_bf16 v[52:55], v[112:115], a[36:39], v[52:55]
    v_mfma_f32_16x16x32_bf16 v[60:63], v[120:123], a[36:39], v[60:63]
    ds_read_b128 v[112:115], v6 offset:51200
    v_mfma_f32_16x16x32_bf16 v[60:63], v[124:127], a[44:47], v[60:63]
    buffer_load_dwordx4 v1, s[8:11], s25 offen offset:2048 sc1 lds
    v_mfma_f32_16x16x32_bf16 v[56:59], v[124:127], a[40:43], v[56:59]
    ds_read_b128 v[116:119], v6 offset:59392
    v_mfma_f32_16x16x32_bf16 v[56:59], v[120:123], a[32:35], v[56:59]
    s_waitcnt lgkmcnt(6)
    v_mfma_f32_16x16x32_bf16 v[64:67], v[128:131], a[32:35], v[64:67]
    ds_read_b128 v[120:123], v6 offset:52224
    v_mfma_f32_16x16x32_bf16 v[64:67], v[132:135], a[40:43], v[64:67]
    buffer_load_dwordx4 v1, s[8:11], s25 offen offset:3072 sc1 lds
    v_mfma_f32_16x16x32_bf16 v[68:71], v[132:135], a[44:47], v[68:71]
    ds_read_b128 v[124:127], v6 offset:60416
    v_mfma_f32_16x16x32_bf16 v[68:71], v[128:131], a[36:39], v[68:71]
    v_mfma_f32_16x16x32_bf16 v[76:79], v[136:139], a[36:39], v[76:79]
    ds_read_b128 v[128:131], v8 offset:49152
    v_mfma_f32_16x16x32_bf16 v[76:79], v[140:143], a[44:47], v[76:79]
    buffer_load_dwordx4 a[16:19], v1, s[4:7], s24 offen offset:0 sc1
    v_mfma_f32_16x16x32_bf16 v[72:75], v[140:143], a[40:43], v[72:75]
    ds_read_b128 v[132:135], v8 offset:57344
    v_mfma_f32_16x16x32_bf16 v[72:75], v[136:139], a[32:35], v[72:75]
    s_bitcmp1_b32 s18, s37
    s_cselect_b32 s78, 3, -1
    v_mfma_f32_16x16x32_bf16 v[80:83], v[144:147], a[32:35], v[80:83]
    ds_read_b128 v[136:139], v8 offset:50176
    v_mfma_f32_16x16x32_bf16 v[80:83], v[148:151], a[40:43], v[80:83]
    buffer_load_dwordx4 a[20:23], v1, s[4:7], s24 offen offset:1024 sc1
    v_mfma_f32_16x16x32_bf16 v[84:87], v[148:151], a[44:47], v[84:87]
    ds_read_b128 v[140:143], v8 offset:58368
    v_mfma_f32_16x16x32_bf16 v[84:87], v[144:147], a[36:39], v[84:87]
    s_bitcmp1_b32 s19, s37
    s_cselect_b32 s78, 0, s78
    v_mfma_f32_16x16x32_bf16 v[92:95], v[152:155], a[36:39], v[92:95]
    ds_read_b128 v[144:147], v8 offset:51200
    v_mfma_f32_16x16x32_bf16 v[92:95], v[156:159], a[44:47], v[92:95]
    buffer_load_dwordx4 a[24:27], v1, s[4:7], s24 offen offset:2048 sc1
    v_mfma_f32_16x16x32_bf16 v[88:91], v[156:159], a[40:43], v[88:91]
    ds_read_b128 v[148:151], v8 offset:59392
    v_mfma_f32_16x16x32_bf16 v[88:91], v[152:155], a[32:35], v[88:91]
    s_add_u32 s78, s78, s37
    s_add_u32 s37, s37, 1
    s_waitcnt vmcnt(15) lgkmcnt(6)
    v_mfma_f32_16x16x32_bf16 v[32:35], v[96:99], a[48:51], v[32:35]
    ds_read_b128 v[152:155], v8 offset:52224
    v_mfma_f32_16x16x32_bf16 v[32:35], v[100:103], a[56:59], v[32:35]
    buffer_load_dwordx4 a[28:31], v1, s[4:7], s24 offen offset:3072 sc1
    v_mfma_f32_16x16x32_bf16 v[36:39], v[100:103], a[60:63], v[36:39]
    ds_read_b128 v[156:159], v8 offset:60416
    v_mfma_f32_16x16x32_bf16 v[36:39], v[96:99], a[52:55], v[36:39]
    s_waitcnt vmcnt(12)
    s_barrier
    s_lshl_b32 s24, s78, 12
    s_lshl_b32 s25, s78, 14
    v_mfma_f32_16x16x32_bf16 v[44:47], v[104:107], a[52:55], v[44:47]
    ds_read_b128 v[96:99], v6 offset:0
    s_add_u32 m0, s26, 32768
    v_mfma_f32_16x16x32_bf16 v[44:47], v[108:111], a[60:63], v[44:47]
    buffer_load_dwordx4 v1, s[8:11], s25 offen offset:0 sc1 lds
    v_mfma_f32_16x16x32_bf16 v[40:43], v[108:111], a[56:59], v[40:43]
    ds_read_b128 v[100:103], v6 offset:8192
    v_mfma_f32_16x16x32_bf16 v[40:43], v[104:107], a[48:51], v[40:43]
    v_mfma_f32_16x16x32_bf16 v[48:51], v[112:115], a[48:51], v[48:51]
    ds_read_b128 v[104:107], v6 offset:1024
    v_mfma_f32_16x16x32_bf16 v[48:51], v[116:119], a[56:59], v[48:51]
    buffer_load_dwordx4 v1, s[8:11], s25 offen offset:1024 sc1 lds
    v_mfma_f32_16x16x32_bf16 v[52:55], v[116:119], a[60:63], v[52:55]
    ds_read_b128 v[108:111], v6 offset:9216
    v_mfma_f32_16x16x32_bf16 v[52:55], v[112:115], a[52:55], v[52:55]
    v_mfma_f32_16x16x32_bf16 v[60:63], v[120:123], a[52:55], v[60:63]
    ds_read_b128 v[112:115], v6 offset:2048
    v_mfma_f32_16x16x32_bf16 v[60:63], v[124:127], a[60:63], v[60:63]
    buffer_load_dwordx4 v1, s[8:11], s25 offen offset:2048 sc1 lds
    v_mfma_f32_16x16x32_bf16 v[56:59], v[124:127], a[56:59], v[56:59]
    ds_read_b128 v[116:119], v6 offset:10240
    v_mfma_f32_16x16x32_bf16 v[56:59], v[120:123], a[48:51], v[56:59]
    s_waitcnt lgkmcnt(6)
    v_mfma_f32_16x16x32_bf16 v[64:67], v[128:131], a[48:51], v[64:67]
    ds_read_b128 v[120:123], v6 offset:3072
    v_mfma_f32_16x16x32_bf16 v[64:67], v[132:135], a[56:59], v[64:67]
    buffer_load_dwordx4 v1, s[8:11], s25 offen offset:3072 sc1 lds
    v_mfma_f32_16x16x32_bf16 v[68:71], v[132:135], a[60:63], v[68:71]
    ds_read_b128 v[124:127], v6 offset:11264
    v_mfma_f32_16x16x32_bf16 v[68:71], v[128:131], a[52:55], v[68:71]
    v_mfma_f32_16x16x32_bf16 v[76:79], v[136:139], a[52:55], v[76:79]
    ds_read_b128 v[128:131], v8 offset:0
    v_mfma_f32_16x16x32_bf16 v[76:79], v[140:143], a[60:63], v[76:79]
    buffer_load_dwordx4 a[32:35], v1, s[4:7], s24 offen offset:0 sc1
    v_mfma_f32_16x16x32_bf16 v[72:75], v[140:143], a[56:59], v[72:75]
    ds_read_b128 v[132:135], v8 offset:8192
    v_mfma_f32_16x16x32_bf16 v[72:75], v[136:139], a[48:51], v[72:75]
    s_bitcmp1_b32 s18, s37
    s_cselect_b32 s78, 3, -1
    v_mfma_f32_16x16x32_bf16 v[80:83], v[144:147], a[48:51], v[80:83]
    ds_read_b128 v[136:139], v8 offset:1024
    v_mfma_f32_16x16x32_bf16 v[80:83], v[148:151], a[56:59], v[80:83]
    buffer_load_dwordx4 a[36:39], v1, s[4:7], s24 offen offset:1024 sc1
    v_mfma_f32_16x16x32_bf16 v[84:87], v[148:151], a[60:63], v[84:87]
    ds_read_b128 v[140:143], v8 offset:9216
    v_mfma_f32_16x16x32_bf16 v[84:87], v[144:147], a[52:55], v[84:87]
    s_bitcmp1_b32 s19, s37
    s_cselect_b32 s78, 0, s78
    v_mfma_f32_16x16x32_bf16 v[92:95], v[152:155], a[52:55], v[92:95]
    ds_read_b128 v[144:147], v8 offset:2048
    v_mfma_f32_16x16x32_bf16 v[92:95], v[156:159], a[60:63], v[92:95]
    buffer_load_dwordx4 a[40:43], v1, s[4:7], s24 offen offset:2048 sc1
    v_mfma_f32_16x16x32_bf16 v[88:91], v[156:159], a[56:59], v[88:91]
    ds_read_b128 v[148:151], v8 offset:10240
    v_mfma_f32_16x16x32_bf16 v[88:91], v[152:155], a[48:51], v[88:91]
    s_add_u32 s78, s78, s37
    s_add_u32 s37, s37, 1
    s_waitcnt vmcnt(15) lgkmcnt(6)
    v_mfma_f32_16x16x32_bf16 v[32:35], v[96:99], a[0:3], v[32:35]
    ds_read_b128 v[152:155], v8 offset:3072
    v_mfma_f32_16x16x32_bf16 v[32:35], v[100:103], a[8:11], v[32:35]
    buffer_load_dwordx4 a[44:47], v1, s[4:7], s24 offen offset:3072 sc1
    v_mfma_f32_16x16x32_bf16 v[36:39], v[100:103], a[12:15], v[36:39]
    ds_read_b128 v[156:159], v8 offset:11264
    v_mfma_f32_16x16x32_bf16 v[36:39], v[96:99], a[4:7], v[36:39]
    s_waitcnt vmcnt(12)
    s_barrier
    s_lshl_b32 s24, s78, 12
    s_lshl_b32 s25, s78, 14
    v_mfma_f32_16x16x32_bf16 v[44:47], v[104:107], a[4:7], v[44:47]
    ds_read_b128 v[96:99], v6 offset:16384
    s_add_u32 m0, s26, 49152
    v_mfma_f32_16x16x32_bf16 v[44:47], v[108:111], a[12:15], v[44:47]
    buffer_load_dwordx4 v1, s[8:11], s25 offen offset:0 sc1 lds
    v_mfma_f32_16x16x32_bf16 v[40:43], v[108:111], a[8:11], v[40:43]
    ds_read_b128 v[100:103], v6 offset:24576
    v_mfma_f32_16x16x32_bf16 v[40:43], v[104:107], a[0:3], v[40:43]
    v_mfma_f32_16x16x32_bf16 v[48:51], v[112:115], a[0:3], v[48:51]
    ds_read_b128 v[104:107], v6 offset:17408
    v_mfma_f32_16x16x32_bf16 v[48:51], v[116:119], a[8:11], v[48:51]
    buffer_load_dwordx4 v1, s[8:11], s25 offen offset:1024 sc1 lds
    v_mfma_f32_16x16x32_bf16 v[52:55], v[116:119], a[12:15], v[52:55]
    ds_read_b128 v[108:111], v6 offset:25600
    v_mfma_f32_16x16x32_bf16 v[52:55], v[112:115], a[4:7], v[52:55]
    v_mfma_f32_16x16x32_bf16 v[60:63], v[120:123], a[4:7], v[60:63]
    ds_read_b128 v[112:115], v6 offset:18432
    v_mfma_f32_16x16x32_bf16 v[60:63], v[124:127], a[12:15], v[60:63]
    buffer_load_dwordx4 v1, s[8:11], s25 offen offset:2048 sc1 lds
    v_mfma_f32_16x16x32_bf16 v[56:59], v[124:127], a[8:11], v[56:59]
    ds_read_b128 v[116:119], v6 offset:26624
    v_mfma_f32_16x16x32_bf16 v[56:59], v[120:123], a[0:3], v[56:59]
    s_waitcnt lgkmcnt(6)
    v_mfma_f32_16x16x32_bf16 v[64:67], v[128:131], a[0:3], v[64:67]
    ds_read_b128 v[120:123], v6 offset:19456
    v_mfma_f32_16x16x32_bf16 v[64:67], v[132:135], a[8:11], v[64:67]
    buffer_load_dwordx4 v1, s[8:11], s25 offen offset:3072 sc1 lds
    v_mfma_f32_16x16x32_bf16 v[68:71], v[132:135], a[12:15], v[68:71]
    ds_read_b128 v[124:127], v6 offset:27648
    v_mfma_f32_16x16x32_bf16 v[68:71], v[128:131], a[4:7], v[68:71]
    v_mfma_f32_16x16x32_bf16 v[76:79], v[136:139], a[4:7], v[76:79]
    ds_read_b128 v[128:131], v8 offset:16384
    v_mfma_f32_16x16x32_bf16 v[76:79], v[140:143], a[12:15], v[76:79]
    buffer_load_dwordx4 a[48:51], v1, s[4:7], s24 offen offset:0 sc1
    v_mfma_f32_16x16x32_bf16 v[72:75], v[140:143], a[8:11], v[72:75]
    ds_read_b128 v[132:135], v8 offset:24576
    v_mfma_f32_16x16x32_bf16 v[72:75], v[136:139], a[0:3], v[72:75]
    s_bitcmp1_b32 s18, s37
    s_cselect_b32 s78, 3, -1
    v_mfma_f32_16x16x32_bf16 v[80:83], v[144:147], a[0:3], v[80:83]
    ds_read_b128 v[136:139], v8 offset:17408
    v_mfma_f32_16x16x32_bf16 v[80:83], v[148:151], a[8:11], v[80:83]
    buffer_load_dwordx4 a[52:55], v1, s[4:7], s24 offen offset:1024 sc1
    v_mfma_f32_16x16x32_bf16 v[84:87], v[148:151], a[12:15], v[84:87]
    ds_read_b128 v[140:143], v8 offset:25600
    v_mfma_f32_16x16x32_bf16 v[84:87], v[144:147], a[4:7], v[84:87]
    s_bitcmp1_b32 s19, s37
    s_cselect_b32 s78, 0, s78
    v_mfma_f32_16x16x32_bf16 v[92:95], v[152:155], a[4:7], v[92:95]
    ds_read_b128 v[144:147], v8 offset:18432
    v_mfma_f32_16x16x32_bf16 v[92:95], v[156:159], a[12:15], v[92:95]
    buffer_load_dwordx4 a[56:59], v1, s[4:7], s24 offen offset:2048 sc1
    v_mfma_f32_16x16x32_bf16 v[88:91], v[156:159], a[8:11], v[88:91]
    ds_read_b128 v[148:151], v8 offset:26624
    v_mfma_f32_16x16x32_bf16 v[88:91], v[152:155], a[0:3], v[88:91]
    s_add_u32 s78, s78, s37
    s_add_u32 s37, s37, 1
    s_waitcnt vmcnt(15) lgkmcnt(6)
    v_mfma_f32_16x16x32_bf16 v[32:35], v[96:99], a[16:19], v[32:35]
    ds_read_b128 v[152:155], v8 offset:19456
    v_mfma_f32_16x16x32_bf16 v[32:35], v[100:103], a[24:27], v[32:35]
    buffer_load_dwordx4 a[60:63], v1, s[4:7], s24 offen offset:3072 sc1
    v_mfma_f32_16x16x32_bf16 v[36:39], v[100:103], a[28:31], v[36:39]
    ds_read_b128 v[156:159], v8 offset:27648
    v_mfma_f32_16x16x32_bf16 v[36:39], v[96:99], a[20:23], v[36:39]
    s_waitcnt vmcnt(12)
    s_barrier
    s_lshl_b32 s24, s78, 12
    s_lshl_b32 s25, s78, 14
    v_mfma_f32_16x16x32_bf16 v[44:47], v[104:107], a[20:23], v[44:47]
    ds_read_b128 v[96:99], v6 offset:32768
    s_add_u32 m0, s26, 0
    v_mfma_f32_16x16x32_bf16 v[44:47], v[108:111], a[28:31], v[44:47]
    buffer_load_dwordx4 v1, s[8:11], s25 offen offset:0 sc1 lds
    v_mfma_f32_16x16x32_bf16 v[40:43], v[108:111], a[24:27], v[40:43]
    ds_read_b128 v[100:103], v6 offset:40960
    v_mfma_f32_16x16x32_bf16 v[40:43], v[104:107], a[16:19], v[40:43]
    v_mfma_f32_16x16x32_bf16 v[48:51], v[112:115], a[16:19], v[48:51]
    ds_read_b128 v[104:107], v6 offset:33792
    v_mfma_f32_16x16x32_bf16 v[48:51], v[116:119], a[24:27], v[48:51]
    buffer_load_dwordx4 v1, s[8:11], s25 offen offset:1024 sc1 lds
    v_mfma_f32_16x16x32_bf16 v[52:55], v[116:119], a[28:31], v[52:55]
    ds_read_b128 v[108:111], v6 offset:41984
    v_mfma_f32_16x16x32_bf16 v[52:55], v[112:115], a[20:23], v[52:55]
    v_mfma_f32_16x16x32_bf16 v[60:63], v[120:123], a[20:23], v[60:63]
    ds_read_b128 v[112:115], v6 offset:34816
    v_mfma_f32_16x16x32_bf16 v[60:63], v[124:127], a[28:31], v[60:63]
    buffer_load_dwordx4 v1, s[8:11], s25 offen offset:2048 sc1 lds
    v_mfma_f32_16x16x32_bf16 v[56:59], v[124:127], a[24:27], v[56:59]
    ds_read_b128 v[116:119], v6 offset:43008
    v_mfma_f32_16x16x32_bf16 v[56:59], v[120:123], a[16:19], v[56:59]
    s_waitcnt lgkmcnt(6)
    v_mfma_f32_16x16x32_bf16 v[64:67], v[128:131], a[16:19], v[64:67]
    ds_read_b128 v[120:123], v6 offset:35840
    v_mfma_f32_16x16x32_bf16 v[64:67], v[132:135], a[24:27], v[64:67]
    buffer_load_dwordx4 v1, s[8:11], s25 offen offset:3072 sc1 lds
    v_mfma_f32_16x16x32_bf16 v[68:71], v[132:135], a[28:31], v[68:71]
    ds_read_b128 v[124:127], v6 offset:44032
    v_mfma_f32_16x16x32_bf16 v[68:71], v[128:131], a[20:23], v[68:71]
    v_mfma_f32_16x16x32_bf16 v[76:79], v[136:139], a[20:23], v[76:79]
    ds_read_b128 v[128:131], v8 offset:32768
    v_mfma_f32_16x16x32_bf16 v[76:79], v[140:143], a[28:31], v[76:79]
    buffer_load_dwordx4 a[0:3], v1, s[4:7], s24 offen offset:0 sc1
    v_mfma_f32_16x16x32_bf16 v[72:75], v[140:143], a[24:27], v[72:75]
    ds_read_b128 v[132:135], v8 offset:40960
    v_mfma_f32_16x16x32_bf16 v[72:75], v[136:139], a[16:19], v[72:75]
    s_bitcmp1_b32 s18, s37
    s_cselect_b32 s78, 3, -1
    v_mfma_f32_16x16x32_bf16 v[80:83], v[144:147], a[16:19], v[80:83]
    ds_read_b128 v[136:139], v8 offset:33792
    v_mfma_f32_16x16x32_bf16 v[80:83], v[148:151], a[24:27], v[80:83]
    buffer_load_dwordx4 a[4:7], v1, s[4:7], s24 offen offset:1024 sc1
    v_mfma_f32_16x16x32_bf16 v[84:87], v[148:151], a[28:31], v[84:87]
    ds_read_b128 v[140:143], v8 offset:41984
    v_mfma_f32_16x16x32_bf16 v[84:87], v[144:147], a[20:23], v[84:87]
    s_bitcmp1_b32 s19, s37
    s_cselect_b32 s78, 0, s78
    v_mfma_f32_16x16x32_bf16 v[92:95], v[152:155], a[20:23], v[92:95]
    ds_read_b128 v[144:147], v8 offset:34816
    v_mfma_f32_16x16x32_bf16 v[92:95], v[156:159], a[28:31], v[92:95]
    buffer_load_dwordx4 a[8:11], v1, s[4:7], s24 offen offset:2048 sc1
    v_mfma_f32_16x16x32_bf16 v[88:91], v[156:159], a[24:27], v[88:91]
    ds_read_b128 v[148:151], v8 offset:43008
    v_mfma_f32_16x16x32_bf16 v[88:91], v[152:155], a[16:19], v[88:91]
    s_add_u32 s78, s78, s37
    s_add_u32 s37, s37, 1
    s_sub_u32 s76, s76, 1
    s_cmp_lg_u32 s76, 0
    s_cbranch_scc1 Lg2f_loop
    s_waitcnt vmcnt(15) lgkmcnt(6)
    v_mfma_f32_16x16x32_bf16 v[32:35], v[96:99], a[32:35], v[32:35]
    ds_read_b128 v[152:155], v8 offset:35840
    v_mfma_f32_16x16x32_bf16 v[32:35], v[100:103], a[40:43], v[32:35]
    buffer_load_dwordx4 a[12:15], v1, s[4:7], s24 offen offset:3072 sc1
    v_mfma_f32_16x16x32_bf16 v[36:39], v[100:103], a[44:47], v[36:39]
    ds_read_b128 v[156:159], v8 offset:44032
    v_mfma_f32_16x16x32_bf16 v[36:39], v[96:99], a[36:39], v[36:39]
    s_waitcnt vmcnt(12)
    s_barrier
    s_lshl_b32 s24, s78, 12
    s_lshl_b32 s25, s78, 14
    v_mfma_f32_16x16x32_bf16 v[44:47], v[104:107], a[36:39], v[44:47]
    ds_read_b128 v[96:99], v6 offset:49152
    s_add_u32 m0, s26, 16384
    v_mfma_f32_16x16x32_bf16 v[44:47], v[108:111], a[44:47], v[44:47]
    buffer_load_dwordx4 v1, s[8:11], s25 offen offset:0 sc1 lds
    v_mfma_f32_16x16x32_bf16 v[40:43], v[108:111], a[40:43], v[40:43]
    ds_read_b128 v[100:103], v6 offset:57344
    v_mfma_f32_16x16x32_bf16 v[40:43], v[104:107], a[32:35], v[40:43]
    v_mfma_f32_16x16x32_bf16 v[48:51], v[112:115], a[32:35], v[48:51]
    ds_read_b128 v[104:107], v6 offset:50176
    v_mfma_f32_16x16x32_bf16 v[48:51], v[116:119], a[40:43], v[48:51]
    buffer_load_dwordx4 v1, s[8:11], s25 offen offset:1024 sc1 lds
    v_mfma_f32_16x16x32_bf16 v[52:55], v[116:119], a[44:47], v[52:55]
    ds_read_b128 v[108:111], v6 offset:58368
    v_mfma_f32_16x16x32_bf16 v[52:55], v[112:115], a[36:39], v[52:55]
    v_mfma_f32_16x16x32_bf16 v[60:63], v[120:123], a[36:39], v[60:63]
    ds_read_b128 v[112:115], v6 offset:51200
    v_mfma_f32_16x16x32_bf16 v[60:63], v[124:127], a[44:47], v[60:63]
    buffer_load_dwordx4 v1, s[8:11], s25 offen offset:2048 sc1 lds
    v_mfma_f32_16x16x32_bf16 v[56:59], v[124:127], a[40:43], v[56:59]
    ds_read_b128 v[116:119], v6 offset:59392
    v_mfma_f32_16x16x32_bf16 v[56:59], v[120:123], a[32:35], v[56:59]
    s_waitcnt lgkmcnt(6)
    v_mfma_f32_16x16x32_bf16 v[64:67], v[128:131], a[32:35], v[64:67]
    ds_read_b128 v[120:123], v6 offset:52224
    v_mfma_f32_16x16x32_bf16 v[64:67], v[132:135], a[40:43], v[64:67]
    buffer_load_dwordx4 v1, s[8:11], s25 offen offset:3072 sc1 lds
    v_mfma_f32_16x16x32_bf16 v[68:71], v[132:135], a[44:47], v[68:71]
    ds_read_b128 v[124:127], v6 offset:60416
    v_mfma_f32_16x16x32_bf16 v[68:71], v[128:131], a[36:39], v[68:71]
    v_mfma_f32_16x16x32_bf16 v[76:79], v[136:139], a[36:39], v[76:79]
    ds_read_b128 v[128:131], v8 offset:49152
    v_mfma_f32_16x16x32_bf16 v[76:79], v[140:143], a[44:47], v[76:79]
    buffer_load_dwordx4 a[16:19], v1, s[4:7], s24 offen offset:0 sc1
    v_mfma_f32_16x16x32_bf16 v[72:75], v[140:143], a[40:43], v[72:75]
    ds_read_b128 v[132:135], v8 offset:57344
    v_mfma_f32_16x16x32_bf16 v[72:75], v[136:139], a[32:35], v[72:75]
    s_bitcmp1_b32 s18, s37
    s_cselect_b32 s78, 3, -1
    v_mfma_f32_16x16x32_bf16 v[80:83], v[144:147], a[32:35], v[80:83]
    ds_read_b128 v[136:139], v8 offset:50176
    v_mfma_f32_16x16x32_bf16 v[80:83], v[148:151], a[40:43], v[80:83]
    buffer_load_dwordx4 a[20:23], v1, s[4:7], s24 offen offset:1024 sc1
    v_mfma_f32_16x16x32_bf16 v[84:87], v[148:151], a[44:47], v[84:87]
    ds_read_b128 v[140:143], v8 offset:58368
    v_mfma_f32_16x16x32_bf16 v[84:87], v[144:147], a[36:39], v[84:87]
    s_bitcmp1_b32 s19, s37
    s_cselect_b32 s78, 0, s78
    v_mfma_f32_16x16x32_bf16 v[92:95], v[152:155], a[36:39], v[92:95]
    ds_read_b128 v[144:147], v8 offset:51200
    v_mfma_f32_16x16x32_bf16 v[92:95], v[156:159], a[44:47], v[92:95]
    buffer_load_dwordx4 a[24:27], v1, s[4:7], s24 offen offset:2048 sc1
    v_mfma_f32_16x16x32_bf16 v[88:91], v[156:159], a[40:43], v[88:91]
    ds_read_b128 v[148:151], v8 offset:59392
    v_mfma_f32_16x16x32_bf16 v[88:91], v[152:155], a[32:35], v[88:91]
    s_add_u32 s78, s78, s37
    s_add_u32 s37, s37, 1
    s_waitcnt vmcnt(15) lgkmcnt(6)
    buffer_load_dword v29, v28, s[80:83], 0 offen sc1
    v_mfma_f32_16x16x32_bf16 v[32:35], v[96:99], a[48:51], v[32:35]
    ds_read_b128 v[152:155], v8 offset:52224
    v_mfma_f32_16x16x32_bf16 v[32:35], v[100:103], a[56:59], v[32:35]
    buffer_load_dwordx4 a[28:31], v1, s[4:7], s24 offen offset:3072 sc1
    v_mfma_f32_16x16x32_bf16 v[36:39], v[100:103], a[60:63], v[36:39]
    ds_read_b128 v[156:159], v8 offset:60416
    v_mfma_f32_16x16x32_bf16 v[36:39], v[96:99], a[52:55], v[36:39]
    s_waitcnt vmcnt(13)
    s_barrier
    s_lshl_b32 s24, s78, 12
    s_lshl_b32 s25, s78, 14
    v_mfma_f32_16x16x32_bf16 v[44:47], v[104:107], a[52:55], v[44:47]
    ds_read_b128 v[96:99], v6 offset:0
    s_add_u32 m0, s26, 32768
    v_mfma_f32_16x16x32_bf16 v[44:47], v[108:111], a[60:63], v[44:47]
    buffer_load_dwordx4 v1, s[8:11], s25 offen offset:0 sc1 lds
    v_mfma_f32_16x16x32_bf16 v[40:43], v[108:111], a[56:59], v[40:43]
    ds_read_b128 v[100:103], v6 offset:8192
    v_mfma_f32_16x16x32_bf16 v[40:43], v[104:107], a[48:51], v[40:43]
    v_mfma_f32_16x16x32_bf16 v[48:51], v[112:115], a[48:51], v[48:51]
    ds_read_b128 v[104:107], v6 offset:1024
    v_mfma_f32_16x16x32_bf16 v[48:51], v[116:119], a[56:59], v[48:51]
    buffer_load_dwordx4 v1, s[8:11], s25 offen offset:1024 sc1 lds
    v_mfma_f32_16x16x32_bf16 v[52:55], v[116:119], a[60:63], v[52:55]
    ds_read_b128 v[108:111], v6 offset:9216
    v_mfma_f32_16x16x32_bf16 v[52:55], v[112:115], a[52:55], v[52:55]
    v_mfma_f32_16x16x32_bf16 v[60:63], v[120:123], a[52:55], v[60:63]
    ds_read_b128 v[112:115], v6 offset:2048
    v_mfma_f32_16x16x32_bf16 v[60:63], v[124:127], a[60:63], v[60:63]
    buffer_load_dwordx4 v1, s[8:11], s25 offen offset:2048 sc1 lds
    v_mfma_f32_16x16x32_bf16 v[56:59], v[124:127], a[56:59], v[56:59]
    ds_read_b128 v[116:119], v6 offset:10240
    v_mfma_f32_16x16x32_bf16 v[56:59], v[120:123], a[48:51], v[56:59]
    s_waitcnt lgkmcnt(6)
    v_mfma_f32_16x16x32_bf16 v[64:67], v[128:131], a[48:51], v[64:67]
    ds_read_b128 v[120:123], v6 offset:3072
    v_mfma_f32_16x16x32_bf16 v[64:67], v[132:135], a[56:59], v[64:67]
    buffer_load_dwordx4 v1, s[8:11], s25 offen offset:3072 sc1 lds
    v_mfma_f32_16x16x32_bf16 v[68:71], v[132:135], a[60:63], v[68:71]
    ds_read_b128 v[124:127], v6 offset:11264
    v_mfma_f32_16x16x32_bf16 v[68:71], v[128:131], a[52:55], v[68:71]
    v_mfma_f32_16x16x32_bf16 v[76:79], v[136:139], a[52:55], v[76:79]
    ds_read_b128 v[128:131], v8 offset:0
    v_mfma_f32_16x16x32_bf16 v[76:79], v[140:143], a[60:63], v[76:79]
    buffer_load_dwordx4 a[32:35], v1, s[4:7], s24 offen offset:0 sc1
    v_mfma_f32_16x16x32_bf16 v[72:75], v[140:143], a[56:59], v[72:75]
    ds_read_b128 v[132:135], v8 offset:8192
    v_mfma_f32_16x16x32_bf16 v[72:75], v[136:139], a[48:51], v[72:75]
    s_bitcmp1_b32 s18, s37
    s_cselect_b32 s78, 3, -1
    v_mfma_f32_16x16x32_bf16 v[80:83], v[144:147], a[48:51], v[80:83]
    ds_read_b128 v[136:139], v8 offset:1024
    v_mfma_f32_16x16x32_bf16 v[80:83], v[148:151], a[56:59], v[80:83]
    buffer_load_dwordx4 a[36:39], v1, s[4:7], s24 offen offset:1024 sc1
    v_mfma_f32_16x16x32_bf16 v[84:87], v[148:151], a[60:63], v[84:87]
    ds_read_b128 v[140:143], v8 offset:9216
    v_mfma_f32_16x16x32_bf16 v[84:87], v[144:147], a[52:55], v[84:87]
    s_bitcmp1_b32 s19, s37
    s_cselect_b32 s78, 0, s78
    v_mfma_f32_16x16x32_bf16 v[92:95], v[152:155], a[52:55], v[92:95]
    ds_read_b128 v[144:147], v8 offset:2048
    v_mfma_f32_16x16x32_bf16 v[92:95], v[156:159], a[60:63], v[92:95]
    buffer_load_dwordx4 a[40:43], v1, s[4:7], s24 offen offset:2048 sc1
    v_mfma_f32_16x16x32_bf16 v[88:91], v[156:159], a[56:59], v[88:91]
    ds_read_b128 v[148:151], v8 offset:10240
    v_mfma_f32_16x16x32_bf16 v[88:91], v[152:155], a[48:51], v[88:91]
    s_add_u32 s78, s78, s37
    s_add_u32 s37, s37, 1
    s_waitcnt vmcnt(16) lgkmcnt(6)
    v_mfma_f32_16x16x32_bf16 v[32:35], v[96:99], a[0:3], v[32:35]
    ds_read_b128 v[152:155], v8 offset:3072
    v_mfma_f32_16x16x32_bf16 v[32:35], v[100:103], a[8:11], v[32:35]
    buffer_load_dwordx4 a[44:47], v1, s[4:7], s24 offen offset:3072 sc1
    v_mfma_f32_16x16x32_bf16 v[36:39], v[100:103], a[12:15], v[36:39]
    ds_read_b128 v[156:159], v8 offset:11264
    v_mfma_f32_16x16x32_bf16 v[36:39], v[96:99], a[4:7], v[36:39]
    s_waitcnt vmcnt(13)
    s_barrier
    s_lshl_b32 s24, s78, 12
    s_lshl_b32 s25, s78, 14
    v_mfma_f32_16x16x32_bf16 v[44:47], v[104:107], a[4:7], v[44:47]
    ds_read_b128 v[96:99], v6 offset:16384
    s_add_u32 m0, s26, 49152
    v_mfma_f32_16x16x32_bf16 v[44:47], v[108:111], a[12:15], v[44:47]
    buffer_load_dwordx4 v1, s[8:11], s25 offen offset:0 sc1 lds
    v_mfma_f32_16x16x32_bf16 v[40:43], v[108:111], a[8:11], v[40:43]
    ds_read_b128 v[100:103], v6 offset:24576
    v_mfma_f32_16x16x32_bf16 v[40:43], v[104:107], a[0:3], v[40:43]
    v_mfma_f32_16x16x32_bf16 v[48:51], v[112:115], a[0:3], v[48:51]
    ds_read_b128 v[104:107], v6 offset:17408
    v_mfma_f32_16x16x32_bf16 v[48:51], v[116:119], a[8:11], v[48:51]
    buffer_load_dwordx4 v1, s[8:11], s25 offen offset:1024 sc1 lds
    v_mfma_f32_16x16x32_bf16 v[52:55], v[116:119], a[12:15], v[52:55]
    ds_read_b128 v[108:111], v6 offset:25600
    v_mfma_f32_16x16x32_bf16 v[52:55], v[112:115], a[4:7], v[52:55]
    v_mfma_f32_16x16x32_bf16 v[60:63], v[120:123], a[4:7], v[60:63]
    ds_read_b128 v[112:115], v6 offset:18432
    v_mfma_f32_16x16x32_bf16 v[60:63], v[124:127], a[12:15], v[60:63]
    buffer_load_dwordx4 v1, s[8:11], s25 offen offset:2048 sc1 lds
    v_mfma_f32_16x16x32_bf16 v[56:59], v[124:127], a[8:11], v[56:59]
    ds_read_b128 v[116:119], v6 offset:26624
    v_mfma_f32_16x16x32_bf16 v[56:59], v[120:123], a[0:3], v[56:59]
    s_waitcnt lgkmcnt(6)
    v_mfma_f32_16x16x32_bf16 v[64:67], v[128:131], a[0:3], v[64:67]
    ds_read_b128 v[120:123], v6 offset:19456
    v_mfma_f32_16x16x32_bf16 v[64:67], v[132:135], a[8:11], v[64:67]
    buffer_load_dwordx4 v1, s[8:11], s25 offen offset:3072 sc1 lds
    v_mfma_f32_16x16x32_bf16 v[68:71], v[132:135], a[12:15], v[68:71]
    ds_read_b128 v[124:127], v6 offset:27648
    v_mfma_f32_16x16x32_bf16 v[68:71], v[128:131], a[4:7], v[68:71]
    v_mfma_f32_16x16x32_bf16 v[76:79], v[136:139], a[4:7], v[76:79]
    ds_read_b128 v[128:131], v8 offset:16384
    v_mfma_f32_16x16x32_bf16 v[76:79], v[140:143], a[12:15], v[76:79]
    buffer_load_dwordx4 a[48:51], v1, s[4:7], s24 offen offset:0 sc1
    v_mfma_f32_16x16x32_bf16 v[72:75], v[140:143], a[8:11], v[72:75]
    ds_read_b128 v[132:135], v8 offset:24576
    v_mfma_f32_16x16x32_bf16 v[72:75], v[136:139], a[0:3], v[72:75]
    s_bitcmp1_b32 s18, s37
    s_cselect_b32 s78, 3, -1
    v_mfma_f32_16x16x32_bf16 v[80:83], v[144:147], a[0:3], v[80:83]
    ds_read_b128 v[136:139], v8 offset:17408
    v_mfma_f32_16x16x32_bf16 v[80:83], v[148:151], a[8:11], v[80:83]
    buffer_load_dwordx4 a[52:55], v1, s[4:7], s24 offen offset:1024 sc1
    v_mfma_f32_16x16x32_bf16 v[84:87], v[148:151], a[12:15], v[84:87]
    ds_read_b128 v[140:143], v8 offset:25600
    v_mfma_f32_16x16x32_bf16 v[84:87], v[144:147], a[4:7], v[84:87]
    s_bitcmp1_b32 s19, s37
    s_cselect_b32 s78, 0, s78
    v_mfma_f32_16x16x32_bf16 v[92:95], v[152:155], a[4:7], v[92:95]
    ds_read_b128 v[144:147], v8 offset:18432
    v_mfma_f32_16x16x32_bf16 v[92:95], v[156:159], a[12:15], v[92:95]
    buffer_load_dwordx4 a[56:59], v1, s[4:7], s24 offen offset:2048 sc1
    v_mfma_f32_16x16x32_bf16 v[88:91], v[156:159], a[8:11], v[88:91]
    ds_read_b128 v[148:151], v8 offset:26624
    v_mfma_f32_16x16x32_bf16 v[88:91], v[152:155], a[0:3], v[88:91]
    s_add_u32 s78, s78, s37
    s_add_u32 s37, s37, 1
    s_waitcnt vmcnt(15) lgkmcnt(6)
    v_mfma_f32_16x16x32_bf16 v[32:35], v[96:99], a[16:19], v[32:35]
    ds_read_b128 v[152:155], v8 offset:19456
    v_mfma_f32_16x16x32_bf16 v[32:35], v[100:103], a[24:27], v[32:35]
    buffer_load_dwordx4 a[60:63], v1, s[4:7], s24 offen offset:3072 sc1
    v_mfma_f32_16x16x32_bf16 v[36:39], v[100:103], a[28:31], v[36:39]
    ds_read_b128 v[156:159], v8 offset:27648
    v_mfma_f32_16x16x32_bf16 v[36:39], v[96:99], a[20:23], v[36:39]
    s_waitcnt vmcnt(12)
    s_barrier
    s_lshl_b32 s24, s78, 12
    s_lshl_b32 s25, s78, 14
    v_mfma_f32_16x16x32_bf16 v[44:47], v[104:107], a[20:23], v[44:47]
    ds_read_b128 v[96:99], v6 offset:32768
    v_mfma_f32_16x16x32_bf16 v[44:47], v[108:111], a[28:31], v[44:47]
    v_mfma_f32_16x16x32_bf16 v[40:43], v[108:111], a[24:27], v[40:43]
    ds_read_b128 v[100:103], v6 offset:40960
    v_mfma_f32_16x16x32_bf16 v[40:43], v[104:107], a[16:19], v[40:43]
    v_mfma_f32_16x16x32_bf16 v[48:51], v[112:115], a[16:19], v[48:51]
    ds_read_b128 v[104:107], v6 offset:33792
    v_mfma_f32_16x16x32_bf16 v[48:51], v[116:119], a[24:27], v[48:51]
    v_mfma_f32_16x16x32_bf16 v[52:55], v[116:119], a[28:31], v[52:55]
    ds_read_b128 v[108:111], v6 offset:41984
    v_mfma_f32_16x16x32_bf16 v[52:55], v[112:115], a[20:23], v[52:55]
    v_mfma_f32_16x16x32_bf16 v[60:63], v[120:123], a[20:23], v[60:63]
    ds_read_b128 v[112:115], v6 offset:34816
    v_mfma_f32_16x16x32_bf16 v[60:63], v[124:127], a[28:31], v[60:63]
    v_mfma_f32_16x16x32_bf16 v[56:59], v[124:127], a[24:27], v[56:59]
    ds_read_b128 v[116:119], v6 offset:43008
    v_mfma_f32_16x16x32_bf16 v[56:59], v[120:123], a[16:19], v[56:59]
    s_waitcnt lgkmcnt(6)
    s_mov_b32 s94, 1048576
Lg2f_cchk:
    v_cmp_gt_u32 vcc, 128, v29
    s_nop 1
    s_cmp_eq_u64 vcc, 0
    s_cbranch_scc1 Lg2f_cok
    buffer_load_dword v29, v28, s[80:83], 0 offen sc1
    s_waitcnt vmcnt(0)
    s_sub_u32 s94, s94, 1
    s_cbranch_scc0 Lg2f_cchk
Lg2f_cok:
    v_mfma_f32_16x16x32_bf16 v[64:67], v[128:131], a[16:19], v[64:67]
    ds_read_b128 v[120:123], v6 offset:35840
    v_mfma_f32_16x16x32_bf16 v[64:67], v[132:135], a[24:27], v[64:67]
    v_mfma_f32_16x16x32_bf16 v[68:71], v[132:135], a[28:31], v[68:71]
    ds_read_b128 v[124:127], v6 offset:44032
    v_mfma_f32_16x16x32_bf16 v[68:71], v[128:131], a[20:23], v[68:71]
    s_waitcnt vmcnt(4)
    s_barrier
    v_mfma_f32_16x16x32_bf16 v[76:79], v[136:139], a[20:23], v[76:79]
    ds_read_b128 v[128:131], v6 offset:49152
    v_mfma_f32_16x16x32_bf16 v[76:79], v[140:143], a[28:31], v[76:79]
    v_mfma_f32_16x16x32_bf16 v[72:75], v[140:143], a[24:27], v[72:75]
    ds_read_b128 v[132:135], v6 offset:57344
    v_mfma_f32_16x16x32_bf16 v[72:75], v[136:139], a[16:19], v[72:75]
    v_mfma_f32_16x16x32_bf16 v[80:83], v[144:147], a[16:19], v[80:83]
    ds_read_b128 v[136:139], v6 offset:50176
    v_mfma_f32_16x16x32_bf16 v[80:83], v[148:151], a[24:27], v[80:83]
    v_mfma_f32_16x16x32_bf16 v[84:87], v[148:151], a[28:31], v[84:87]
    ds_read_b128 v[140:143], v6 offset:58368
    v_mfma_f32_16x16x32_bf16 v[84:87], v[144:147], a[20:23], v[84:87]
    buffer_load_dwordx4 v[160:163], v1, s[28:31], s72 offen offset:0 sc1
    v_mfma_f32_16x16x32_bf16 v[92:95], v[152:155], a[20:23], v[92:95]
    ds_read_b128 v[144:147], v6 offset:51200
    v_mfma_f32_16x16x32_bf16 v[92:95], v[156:159], a[28:31], v[92:95]
    buffer_load_dwordx4 v[164:167], v1, s[28:31], s72 offen offset:1024 sc1
    v_mfma_f32_16x16x32_bf16 v[88:91], v[156:159], a[24:27], v[88:91]
    ds_read_b128 v[148:151], v6 offset:59392
    v_mfma_f32_16x16x32_bf16 v[88:91], v[152:155], a[16:19], v[88:91]
    buffer_load_dwordx4 v[168:171], v1, s[28:31], s73 offen offset:0 sc1
    s_waitcnt lgkmcnt(6)
    v_mfma_f32_16x16x32_bf16 v[32:35], v[96:99], a[32:35], v[32:35]
    ds_read_b128 v[152:155], v6 offset:52224
    v_mfma_f32_16x16x32_bf16 v[32:35], v[100:103], a[40:43], v[32:35]
    buffer_load_dwordx4 v[172:175], v1, s[28:31], s73 offen offset:1024 sc1
    v_mfma_f32_16x16x32_bf16 v[36:39], v[100:103], a[44:47], v[36:39]
    ds_read_b128 v[156:159], v6 offset:60416
    v_mfma_f32_16x16x32_bf16 v[36:39], v[96:99], a[36:39], v[36:39]
    v_mfma_f32_16x16x32_bf16 v[44:47], v[104:107], a[36:39], v[44:47]
    ds_read_b128 v[96:99], v8 offset:32768
    v_mfma_f32_16x16x32_bf16 v[44:47], v[108:111], a[44:47], v[44:47]
    v_mfma_f32_16x16x32_bf16 v[40:43], v[108:111], a[40:43], v[40:43]
    ds_read_b128 v[100:103], v8 offset:40960
    v_mfma_f32_16x16x32_bf16 v[40:43], v[104:107], a[32:35], v[40:43]
    v_mfma_f32_16x16x32_bf16 v[48:51], v[112:115], a[32:35], v[48:51]
    ds_read_b128 v[104:107], v8 offset:33792
    v_mfma_f32_16x16x32_bf16 v[48:51], v[116:119], a[40:43], v[48:51]
    v_mfma_f32_16x16x32_bf16 v[52:55], v[116:119], a[44:47], v[52:55]
    ds_read_b128 v[108:111], v8 offset:41984
    v_mfma_f32_16x16x32_bf16 v[52:55], v[112:115], a[36:39], v[52:55]
    v_mfma_f32_16x16x32_bf16 v[60:63], v[120:123], a[36:39], v[60:63]
    ds_read_b128 v[112:115], v8 offset:34816
    v_mfma_f32_16x16x32_bf16 v[60:63], v[124:127], a[44:47], v[60:63]
    v_mfma_f32_16x16x32_bf16 v[56:59], v[124:127], a[40:43], v[56:59]
    ds_read_b128 v[116:119], v8 offset:43008
    v_mfma_f32_16x16x32_bf16 v[56:59], v[120:123], a[32:35], v[56:59]
    s_waitcnt vmcnt(4) lgkmcnt(6)
    v_mfma_f32_16x16x32_bf16 v[32:35], v[128:131], a[48:51], v[32:35]
    ds_read_b128 v[120:123], v8 offset:35840
    v_mfma_f32_16x16x32_bf16 v[32:35], v[132:135], a[56:59], v[32:35]
    v_mfma_f32_16x16x32_bf16 v[36:39], v[132:135], a[60:63], v[36:39]
    ds_read_b128 v[124:127], v8 offset:44032
    v_mfma_f32_16x16x32_bf16 v[36:39], v[128:131], a[52:55], v[36:39]
    v_mfma_f32_16x16x32_bf16 v[44:47], v[136:139], a[52:55], v[44:47]
    ds_read_b128 v[128:131], v8 offset:49152
    v_mfma_f32_16x16x32_bf16 v[44:47], v[140:143], a[60:63], v[44:47]
    v_mfma_f32_16x16x32_bf16 v[40:43], v[140:143], a[56:59], v[40:43]
    ds_read_b128 v[132:135], v8 offset:57344
    v_mfma_f32_16x16x32_bf16 v[40:43], v[136:139], a[48:51], v[40:43]
    v_mfma_f32_16x16x32_bf16 v[48:51], v[144:147], a[48:51], v[48:51]
    ds_read_b128 v[136:139], v8 offset:50176
    v_mfma_f32_16x16x32_bf16 v[48:51], v[148:151], a[56:59], v[48:51]
    v_mfma_f32_16x16x32_bf16 v[52:55], v[148:151], a[60:63], v[52:55]
    ds_read_b128 v[140:143], v8 offset:58368
    v_mfma_f32_16x16x32_bf16 v[52:55], v[144:147], a[52:55], v[52:55]
    v_mfma_f32_16x16x32_bf16 v[60:63], v[152:155], a[52:55], v[60:63]
    ds_read_b128 v[144:147], v8 offset:51200
    v_mfma_f32_16x16x32_bf16 v[60:63], v[156:159], a[60:63], v[60:63]
    v_mfma_f32_16x16x32_bf16 v[56:59], v[156:159], a[56:59], v[56:59]
    ds_read_b128 v[148:151], v8 offset:59392
    v_mfma_f32_16x16x32_bf16 v[56:59], v[152:155], a[48:51], v[56:59]
    v_cvt_pk_bf16_f32 v192, v32, v33
    v_cvt_pk_bf16_f32 v193, v34, v35
    s_waitcnt lgkmcnt(6)
    v_mfma_f32_16x16x32_bf16 v[64:67], v[96:99], a[32:35], v[64:67]
    ds_read_b128 v[152:155], v8 offset:52224
    v_cvt_pk_bf16_f32 v194, v40, v41
    v_cvt_pk_bf16_f32 v195, v42, v43
    v_mfma_f32_16x16x32_bf16 v[64:67], v[100:103], a[40:43], v[64:67]
    buffer_store_dwordx4 v[192:195], v1, s[60:63], 0 offen offset:0 sc1
    v_cvt_pk_bf16_f32 v196, v36, v37
    v_mfma_f32_16x16x32_bf16 v[68:71], v[100:103], a[44:47], v[68:71]
    ds_read_b128 v[156:159], v8 offset:60416
    v_cvt_pk_bf16_f32 v197, v38, v39
    v_cvt_pk_bf16_f32 v198, v44, v45
    v_mfma_f32_16x16x32_bf16 v[68:71], v[96:99], a[36:39], v[68:71]
    v_cvt_pk_bf16_f32 v199, v46, v47
    buffer_store_dwordx4 v[196:199], v1, s[60:63], 0 offen offset:1024 sc1
    v_mfma_f32_16x16x32_bf16 v[76:79], v[104:107], a[36:39], v[76:79]
    v_mfma_f32_16x16x32_bf16 v[76:79], v[108:111], a[44:47], v[76:79]
    v_mfma_f32_16x16x32_bf16 v[72:75], v[108:111], a[40:43], v[72:75]
    v_mfma_f32_16x16x32_bf16 v[72:75], v[104:107], a[32:35], v[72:75]
    v_cvt_pk_bf16_f32 v200, v48, v49
    v_cvt_pk_bf16_f32 v201, v50, v51
    v_mfma_f32_16x16x32_bf16 v[80:83], v[112:115], a[32:35], v[80:83]
    v_cvt_pk_bf16_f32 v202, v56, v57
    v_cvt_pk_bf16_f32 v203, v58, v59
    v_mfma_f32_16x16x32_bf16 v[80:83], v[116:119], a[40:43], v[80:83]
    buffer_store_dwordx4 v[200:203], v1, s[60:63], 0 offen offset:2048 sc1
    v_cvt_pk_bf16_f32 v204, v52, v53
    v_mfma_f32_16x16x32_bf16 v[84:87], v[116:119], a[44:47], v[84:87]
    v_cvt_pk_bf16_f32 v205, v54, v55
    v_cvt_pk_bf16_f32 v206, v60, v61
    v_mfma_f32_16x16x32_bf16 v[84:87], v[112:115], a[36:39], v[84:87]
    v_cvt_pk_bf16_f32 v207, v62, v63
    buffer_store_dwordx4 v[204:207], v1, s[60:63], 0 offen offset:3072 sc1
    v_mfma_f32_16x16x32_bf16 v[92:95], v[120:123], a[36:39], v[92:95]
    v_mfma_f32_16x16x32_bf16 v[92:95], v[124:127], a[44:47], v[92:95]
    v_mfma_f32_16x16x32_bf16 v[88:91], v[124:127], a[40:43], v[88:91]
    v_mfma_f32_16x16x32_bf16 v[88:91], v[120:123], a[32:35], v[88:91]
    s_waitcnt lgkmcnt(0)
    v_mfma_f32_16x16x32_bf16 v[64:67], v[128:131], a[48:51], v[64:67]
    v_mfma_f32_16x16x32_bf16 v[64:67], v[132:135], a[56:59], v[64:67]
    v_mfma_f32_16x16x32_bf16 v[68:71], v[132:135], a[60:63], v[68:71]
    v_mfma_f32_16x16x32_bf16 v[68:71], v[128:131], a[52:55], v[68:71]
    v_mfma_f32_16x16x32_bf16 v[76:79], v[136:139], a[52:55], v[76:79]
    v_mfma_f32_16x16x32_bf16 v[76:79], v[140:143], a[60:63], v[76:79]
    v_mfma_f32_16x16x32_bf16 v[72:75], v[140:143], a[56:59], v[72:75]
    v_mfma_f32_16x16x32_bf16 v[72:75], v[136:139], a[48:51], v[72:75]
    v_mfma_f32_16x16x32_bf16 v[80:83], v[144:147], a[48:51], v[80:83]
    v_mfma_f32_16x16x32_bf16 v[80:83], v[148:151], a[56:59], v[80:83]
    v_mfma_f32_16x16x32_bf16 v[84:87], v[148:151], a[60:63], v[84:87]
    v_mfma_f32_16x16x32_bf16 v[84:87], v[144:147], a[52:55], v[84:87]
    v_mfma_f32_16x16x32_bf16 v[92:95], v[152:155], a[52:55], v[92:95]
    v_mfma_f32_16x16x32_bf16 v[92:95], v[156:159], a[60:63], v[92:95]
    v_mfma_f32_16x16x32_bf16 v[88:91], v[156:159], a[56:59], v[88:91]
    v_mfma_f32_16x16x32_bf16 v[88:91], v[152:155], a[48:51], v[88:91]
    s_waitcnt vmcnt(4)
    v_mfma_f32_16x16x32_bf16 v[64:67], v[16:19], v[160:163], v[64:67]
    v_mfma_f32_16x16x32_bf16 v[72:75], v[18:21], v[160:163], v[72:75]
    v_mfma_f32_16x16x32_bf16 v[68:71], v[16:19], v[164:167], v[68:71]
    v_mfma_f32_16x16x32_bf16 v[76:79], v[18:21], v[164:167], v[76:79]
    v_mfma_f32_16x16x32_bf16 v[80:83], v[16:19], v[168:171], v[80:83]
    v_mfma_f32_16x16x32_bf16 v[88:91], v[18:21], v[168:171], v[88:91]
    v_mfma_f32_16x16x32_bf16 v[84:87], v[16:19], v[172:175], v[84:87]
    v_mfma_f32_16x16x32_bf16 v[92:95], v[18:21], v[172:175], v[92:95]
    s_waitcnt vmcnt(0)
    buffer_store_dword v10, v1, s[64:67], 0 offen sc1
    s_mov_b32 s38, 1048576
Lg2f_poll:
    v_mov_b32 v11, 0
    buffer_atomic_or v11, v1, s[84:87], 0 offen sc0 sc1
    s_sub_u32 s38, s38, 1
    s_cbranch_scc1 Lg2f_have
    s_waitcnt vmcnt(0)
    v_readfirstlane_b32 s39, v11
    s_nop 1
    s_cmp_eq_u32 s39, 1
    s_cbranch_scc0 Lg2f_poll
Lg2f_have:
    buffer_load_dwordx4 v[160:163], v1, s[68:71], 0 offen offset:0 sc1
    buffer_load_dwordx4 v[168:171], v1, s[68:71], 0 offen offset:2048 sc1
    buffer_load_dwordx4 v[164:167], v1, s[68:71], 0 offen offset:1024 sc1
    buffer_load_dwordx4 v[172:175], v1, s[68:71], 0 offen offset:3072 sc1
    s_waitcnt vmcnt(3)
    v_mfma_f32_16x16x32_bf16 v[64:67], v[16:19], v[160:163], v[64:67]
    v_mfma_f32_16x16x32_bf16 v[72:75], v[18:21], v[160:163], v[72:75]
    s_waitcnt vmcnt(2)
    v_mfma_f32_16x16x32_bf16 v[80:83], v[16:19], v[168:171], v[80:83]
    v_mfma_f32_16x16x32_bf16 v[88:91], v[18:21], v[168:171], v[88:91]
    s_waitcnt vmcnt(1)
    v_mfma_f32_16x16x32_bf16 v[68:71], v[16:19], v[164:167], v[68:71]
    v_mfma_f32_16x16x32_bf16 v[76:79], v[18:21], v[164:167], v[76:79]
    s_waitcnt vmcnt(0)
    v_mfma_f32_16x16x32_bf16 v[84:87], v[16:19], v[172:175], v[84:87]
    v_mfma_f32_16x16x32_bf16 v[92:95], v[18:21], v[172:175], v[92:95]
    v_cvt_pk_bf16_f32 v112, v64, v65
    v_cvt_pk_bf16_f32 v113, v66, v67
    v_cvt_pk_bf16_f32 v116, v72, v73
    v_cvt_pk_bf16_f32 v117, v74, v75
    v_cvt_pk_bf16_f32 v120, v80, v81
    v_cvt_pk_bf16_f32 v121, v82, v83
    v_cvt_pk_bf16_f32 v124, v88, v89
    v_cvt_pk_bf16_f32 v125, v90, v91
    ds_write_b64 v14, v[112:113] offset:0
    ds_write_b64 v14, v[116:117] offset:32
    ds_write_b64 v14, v[120:121] offset:64
    ds_write_b64 v14, v[124:125] offset:96
    ds_read_b128 v[208:211], v2 offset:0
    ds_read_b128 v[212:215], v2 offset:1152
    v_cvt_pk_bf16_f32 v114, v68, v69
    v_cvt_pk_bf16_f32 v115, v70, v71
    v_cvt_pk_bf16_f32 v118, v76, v77
    v_cvt_pk_bf16_f32 v119, v78, v79
    v_cvt_pk_bf16_f32 v122, v84, v85
    v_cvt_pk_bf16_f32 v123, v86, v87
    v_cvt_pk_bf16_f32 v126, v92, v93
    v_cvt_pk_bf16_f32 v127, v94, v95
    ds_write_b64 v14, v[114:115] offset:2304
    ds_write_b64 v14, v[118:119] offset:2336
    ds_write_b64 v14, v[122:123] offset:2368
    ds_write_b64 v14, v[126:127] offset:2400
    ds_read_b128 v[216:219], v2 offset:2304
    ds_read_b128 v[220:223], v2 offset:3456
    s_waitcnt lgkmcnt(7)
    buffer_store_dwordx4 v[208:211], v3, s[32:35], s36 offen sc1
    s_add_u32 s36, s36, 16384
    s_waitcnt lgkmcnt(6)
    buffer_store_dwordx4 v[212:215], v3, s[32:35], s36 offen sc1
    s_add_u32 s36, s36, 16384
    s_waitcnt lgkmcnt(1)
    buffer_store_dwordx4 v[216:219], v3, s[32:35], s36 offen sc1
    s_add_u32 s36, s36, 16384
    s_waitcnt lgkmcnt(0)
    buffer_store_dwordx4 v[220:223], v3, s[32:35], s36 offen sc1
Lend:
    s_endpgm
.section .rodata,"a"
.p2align 6
.amdhsa_kernel interleave_layers__ssm_conv_h3__glu_gated_geglu__prompt_kernel
  .amdhsa_next_free_vgpr 512
  .amdhsa_next_free_sgpr 102
  .amdhsa_accum_offset 256
  .amdhsa_group_segment_fixed_size 0
  .amdhsa_kernarg_size 104
  .amdhsa_user_sgpr_count 2
  .amdhsa_user_sgpr_kernarg_segment_ptr 1
  .amdhsa_system_sgpr_workgroup_id_x 1
.end_amdhsa_kernel
```
